```python
import torch

def _softmax(x, axis=-1):
    return torch.softmax(x, dim=axis)
def _gelu(x):
    return torch.nn.functional.gelu(x, approximate="tanh")
def _silu(x):
    return torch.nn.functional.silu(x)
def _sigmoid(x):
    return torch.sigmoid(x)
def _layernorm(x, axis=-1, eps=1e-5):
    m = x.mean(dim=axis, keepdim=True)
    v = x.var(dim=axis, keepdim=True, unbiased=False)
    return (x - m) / torch.sqrt(v + eps)
def _scatter_add(tgt, idx, src, axis=0):
    return tgt.clone().index_add_(axis, idx, src)
def _segment_sum(src, seg, n):
    out = torch.zeros((n,) + src.shape[1:], dtype=src.dtype)
    return out.index_add_(0, seg, src)
def _pad(x, pw):
    flat = tuple(v for pair in reversed(pw) for v in pair)
    return torch.nn.functional.pad(x, flat)

kernel_name = 'concat_heads__mha_block_cached__gqa_block_cached__near_ridge'

def setup_inputs():

    _w = (lambda a: (lambda t: t.to(torch.bfloat16) if t.is_floating_point() else t)(torch.as_tensor(a)))
    def _A_setup():
        B, Sq, D = 16, 96, 512
        H, Sk, Dh = 32, 512, 128
        return {
            "x": _w((lambda *s: torch.randn(*s, dtype=torch.bfloat16) * 0.8)(B, Sq, D)),
            "k_cache": _w((lambda *s: torch.randn(*s, dtype=torch.bfloat16) * 0.8)(B, H, Sk, Dh)),
            "v_cache": _w((lambda *s: torch.randn(*s, dtype=torch.bfloat16) * 0.05)(B, H, Sk, Dh)),
            "wq": _w((lambda *s: torch.randn(*s, dtype=torch.bfloat16) * 0.8)(D, H * Dh) * (D ** -0.5)),
            "wo": _w((lambda *s: torch.randn(*s, dtype=torch.bfloat16) * 0.05)(H * Dh, D) * ((H * Dh) ** -0.5)),
        }
    _A_in = _A_setup()

    def _B_setup():
        B, Sq, D = 16, 96, 512
        Hq, Hkv, Sk, Dh = 32, 32, 512, 128
        assert Hq % Hkv == 0, (Hq, Hkv)
        return {
            "x": _w((lambda *s: torch.randn(*s, dtype=torch.bfloat16) * 0.8)(B, Sq, D)),
            "k_cache": _w((lambda *s: torch.randn(*s, dtype=torch.bfloat16) * 0.8)(B, Hkv, Sk, Dh)),
            "v_cache": _w((lambda *s: torch.randn(*s, dtype=torch.bfloat16) * 0.05)(B, Hkv, Sk, Dh)),
            "wq": _w((lambda *s: torch.randn(*s, dtype=torch.bfloat16) * 0.8)(D, Hq * Dh) * (D ** -0.5)),
            "wo": _w((lambda *s: torch.randn(*s, dtype=torch.bfloat16) * 0.05)(Hq * Dh, D) * ((Hq * Dh) ** -0.5)),
        }
    _B_in = _B_setup()

    return {
        "A_x": _A_in["x"],
        "A_k_cache": _A_in["k_cache"],
        "A_v_cache": _A_in["v_cache"],
        "A_wq": _A_in["wq"],
        "A_wo": _A_in["wo"],
        "B_x": _B_in["x"],
        "B_k_cache": _B_in["k_cache"],
        "B_v_cache": _B_in["v_cache"],
        "B_wq": _B_in["wq"],
        "B_wo": _B_in["wo"],
    }

def reference(A_x, A_k_cache, A_v_cache, A_wq, A_wo, B_x, B_k_cache, B_v_cache, B_wq, B_wo):
    def _A_ref(x, k_cache, v_cache, wq, wo):
        B, Sq, D = x.shape
        H, Dh = 32, 128
        q = (lambda x, *d: x.permute(*d))((x @ wq).reshape(B, Sq, H, Dh), 0, 2, 1, 3)
        scores = torch.einsum("bhqd,bhkd->bhqk", q, k_cache) * (Dh ** -0.5)
        p = _softmax(scores, axis=-1)
        o = torch.einsum("bhqk,bhkd->bhqd", p, v_cache)
        return (lambda x, *d: x.permute(*d))(o, 0, 2, 1, 3).reshape(B, Sq, H * Dh) @ wo

    def _B_ref(x, k_cache, v_cache, wq, wo):
        B, Sq, D = x.shape
        Hq, Dh = 32, 128
        Hkv = k_cache.shape[1]
        rep = Hq // Hkv
        q = (lambda x, *d: x.permute(*d))((x @ wq).reshape(B, Sq, Hq, Dh), 0, 2, 1, 3)
        k = (lambda x, n, axis: torch.repeat_interleave(x, n, dim=axis))(k_cache, rep, axis=1)
        v = (lambda x, n, axis: torch.repeat_interleave(x, n, dim=axis))(v_cache, rep, axis=1)
        scores = torch.einsum("bhqd,bhkd->bhqk", q, k) * (Dh ** -0.5)
        p = _softmax(scores, axis=-1)
        o = torch.einsum("bhqk,bhkd->bhqd", p, v)
        return (lambda x, *d: x.permute(*d))(o, 0, 2, 1, 3).reshape(B, Sq, Hq * Dh) @ wo

    a = _A_ref(A_x, A_k_cache, A_v_cache, A_wq, A_wo)
    b = _B_ref(B_x, B_k_cache, B_v_cache, B_wq, B_wo)
    return torch.concatenate([a, b], axis=-1)
```

```asm
; @launch grid=(256,1,1) block=(512,1,1) lds=163840
.amdgcn_target "amdgcn-amd-amdhsa--gfx950"
.text
.globl concat_heads__mha_block_cached__gqa_block_cached__near_ridge_kernel
.p2align 8
.type concat_heads__mha_block_cached__gqa_block_cached__near_ridge_kernel,@function
concat_heads__mha_block_cached__gqa_block_cached__near_ridge_kernel:
  s_cmp_ge_u32 s2, 256
  s_cbranch_scc1 L_k1_end
  s_and_b32 s21, s2, 7
  s_lshr_b32 s22, s2, 3
  s_lshr_b32 s23, s21, 2
  s_mul_i32 s3, s23, 40
  s_add_u32 s4, s0, s3
  s_addc_u32 s5, s1, 0
  s_load_dwordx8 s[8:15], s[4:5], 0
  s_load_dwordx2 s[16:17], s[4:5], 32
  s_load_dwordx2 s[18:19], s[0:1], 96
  v_lshrrev_b32 v1, 6, v0
  v_and_b32 v0, 63, v0
  v_readfirstlane_b32 s20, v1
  s_lshr_b32 s24, s22, 1
  s_and_b32 s25, s22, 1
  s_and_b32 s3, s21, 3
  s_lshl_b32 s3, s3, 1
  s_add_u32 s28, s3, s25
  s_lshl_b32 s26, s28, 2
  s_and_b32 s27, s24, 0
  s_lshl_b32 s27, s27, 2
  s_waitcnt lgkmcnt(0)
  s_cmp_lt_u32 s20, 3
  s_cbranch_scc1 L_roleA
  s_cmp_eq_u32 s20, 3
  s_cbranch_scc1 L_roleLK
  s_cmp_eq_u32 s20, 7
  s_cbranch_scc1 L_roleLV
  s_branch L_roleG
L_roleLK:
  s_mov_b32 s32, s10
  s_and_b32 s33, s11, 0xffff
  s_mov_b32 s34, 0x4000000
  s_mov_b32 s35, 0x20000
  s_mov_b32 s36, s14
  s_and_b32 s37, s15, 0xffff
  s_mov_b32 s38, 0x400000
  s_mov_b32 s39, 0x20000
  s_lshl_b32 s48, s24, 5
  s_add_u32 s48, s48, s26
  s_lshl_b32 s48, s48, 17
  v_and_b32 v1, 15, v0
  v_lshrrev_b32 v2, 4, v0
  v_add_u32 v3, 0, v2
  v_xor_b32 v3, v1, v3
  v_lshlrev_b32 v3, 4, v3
  v_lshl_add_u32 v4, v2, 8, v3
  v_add_u32 v3, 4, v2
  v_xor_b32 v3, v1, v3
  v_lshlrev_b32 v3, 4, v3
  v_lshl_add_u32 v5, v2, 8, v3
  v_add_u32 v3, 8, v2
  v_xor_b32 v3, v1, v3
  v_lshlrev_b32 v3, 4, v3
  v_lshl_add_u32 v6, v2, 8, v3
  v_add_u32 v3, 12, v2
  v_xor_b32 v3, v1, v3
  v_lshlrev_b32 v3, 4, v3
  v_lshl_add_u32 v7, v2, 8, v3
  v_lshlrev_b32 v3, 2, v2
  v_xor_b32 v3, v1, v3
  v_lshlrev_b32 v3, 4, v3
  v_lshlrev_b32 v9, 13, v2
  v_add_u32 v8, v9, v3
  s_mov_b32 s49, 0
  s_mov_b32 s50, 0
  s_add_u32 s52, s27, s50
  s_and_b32 s52, s52, 15
  s_lshl_b32 s52, s52, 18
  s_lshr_b32 s53, s50, 4
  s_add_u32 s53, s53, s26
  s_lshl_b32 s53, s53, 8
  s_add_u32 s52, s52, s53
  s_add_u32 s52, s52, 0
  s_and_b32 s53, s50, 3
  s_lshl_b32 s53, s53, 13
  s_add_u32 s53, s53, 65536
  s_add_u32 m0, s53, 0
  s_nop 0
  buffer_load_dwordx4 v8, s[36:39], s52 offen nt lds
  s_add_u32 m0, s53, 1024
  s_add_u32 s52, s52, 32768
  buffer_load_dwordx4 v8, s[36:39], s52 offen nt lds
  s_add_u32 m0, s53, 2048
  s_add_u32 s52, s52, 32768
  buffer_load_dwordx4 v8, s[36:39], s52 offen nt lds
  s_add_u32 m0, s53, 3072
  s_add_u32 s52, s52, 32768
  buffer_load_dwordx4 v8, s[36:39], s52 offen nt lds
  s_add_u32 s50, s50, 1
  s_add_u32 s52, s27, s50
  s_and_b32 s52, s52, 15
  s_lshl_b32 s52, s52, 18
  s_lshr_b32 s53, s50, 4
  s_add_u32 s53, s53, s26
  s_lshl_b32 s53, s53, 8
  s_add_u32 s52, s52, s53
  s_add_u32 s52, s52, 0
  s_and_b32 s53, s50, 3
  s_lshl_b32 s53, s53, 13
  s_add_u32 s53, s53, 65536
  s_add_u32 m0, s53, 0
  s_nop 0
  buffer_load_dwordx4 v8, s[36:39], s52 offen nt lds
  s_add_u32 m0, s53, 1024
  s_add_u32 s52, s52, 32768
  buffer_load_dwordx4 v8, s[36:39], s52 offen nt lds
  s_add_u32 m0, s53, 2048
  s_add_u32 s52, s52, 32768
  buffer_load_dwordx4 v8, s[36:39], s52 offen nt lds
  s_add_u32 m0, s53, 3072
  s_add_u32 s52, s52, 32768
  buffer_load_dwordx4 v8, s[36:39], s52 offen nt lds
  s_add_u32 s50, s50, 1
  s_add_u32 s52, s27, s50
  s_and_b32 s52, s52, 15
  s_lshl_b32 s52, s52, 18
  s_lshr_b32 s53, s50, 4
  s_add_u32 s53, s53, s26
  s_lshl_b32 s53, s53, 8
  s_add_u32 s52, s52, s53
  s_add_u32 s52, s52, 0
  s_and_b32 s53, s50, 3
  s_lshl_b32 s53, s53, 13
  s_add_u32 s53, s53, 65536
  s_add_u32 m0, s53, 0
  s_nop 0
  buffer_load_dwordx4 v8, s[36:39], s52 offen nt lds
  s_add_u32 m0, s53, 1024
  s_add_u32 s52, s52, 32768
  buffer_load_dwordx4 v8, s[36:39], s52 offen nt lds
  s_add_u32 m0, s53, 2048
  s_add_u32 s52, s52, 32768
  buffer_load_dwordx4 v8, s[36:39], s52 offen nt lds
  s_add_u32 m0, s53, 3072
  s_add_u32 s52, s52, 32768
  buffer_load_dwordx4 v8, s[36:39], s52 offen nt lds
  s_add_u32 s50, s50, 1
  s_add_u32 s52, s27, s50
  s_and_b32 s52, s52, 15
  s_lshl_b32 s52, s52, 18
  s_lshr_b32 s53, s50, 4
  s_add_u32 s53, s53, s26
  s_lshl_b32 s53, s53, 8
  s_add_u32 s52, s52, s53
  s_add_u32 s52, s52, 0
  s_and_b32 s53, s50, 3
  s_lshl_b32 s53, s53, 13
  s_add_u32 s53, s53, 65536
  s_add_u32 m0, s53, 0
  s_nop 0
  buffer_load_dwordx4 v8, s[36:39], s52 offen nt lds
  s_add_u32 m0, s53, 1024
  s_add_u32 s52, s52, 32768
  buffer_load_dwordx4 v8, s[36:39], s52 offen nt lds
  s_add_u32 m0, s53, 2048
  s_add_u32 s52, s52, 32768
  buffer_load_dwordx4 v8, s[36:39], s52 offen nt lds
  s_add_u32 m0, s53, 3072
  s_add_u32 s52, s52, 32768
  buffer_load_dwordx4 v8, s[36:39], s52 offen nt lds
  s_add_u32 s50, s50, 1
  s_waitcnt vmcnt(12)
  s_barrier
  s_waitcnt vmcnt(8)
  s_mov_b32 s51, 9
L_LK_ph0:
  s_barrier
  s_add_u32 s52, s27, s50
  s_and_b32 s52, s52, 15
  s_lshl_b32 s52, s52, 18
  s_lshr_b32 s53, s50, 4
  s_add_u32 s53, s53, s26
  s_lshl_b32 s53, s53, 8
  s_add_u32 s52, s52, s53
  s_add_u32 s52, s52, 0
  s_and_b32 s53, s50, 3
  s_lshl_b32 s53, s53, 13
  s_add_u32 s53, s53, 65536
  s_add_u32 m0, s53, 0
  s_nop 0
  buffer_load_dwordx4 v8, s[36:39], s52 offen nt lds
  s_add_u32 m0, s53, 1024
  s_add_u32 s52, s52, 32768
  buffer_load_dwordx4 v8, s[36:39], s52 offen nt lds
  s_add_u32 m0, s53, 2048
  s_add_u32 s52, s52, 32768
  buffer_load_dwordx4 v8, s[36:39], s52 offen nt lds
  s_add_u32 m0, s53, 3072
  s_add_u32 s52, s52, 32768
  buffer_load_dwordx4 v8, s[36:39], s52 offen nt lds
  s_add_u32 s50, s50, 1
  s_waitcnt vmcnt(8)
  s_sub_u32 s51, s51, 1
  s_cmp_lg_u32 s51, 0
  s_cbranch_scc1 L_LK_ph0
  s_barrier
  s_add_u32 s52, s27, s50
  s_and_b32 s52, s52, 15
  s_lshl_b32 s52, s52, 18
  s_lshr_b32 s53, s50, 4
  s_add_u32 s53, s53, s26
  s_lshl_b32 s53, s53, 8
  s_add_u32 s52, s52, s53
  s_add_u32 s52, s52, 0
  s_and_b32 s53, s50, 3
  s_lshl_b32 s53, s53, 13
  s_add_u32 s53, s53, 65536
  s_add_u32 m0, s53, 0
  s_nop 0
  buffer_load_dwordx4 v8, s[36:39], s52 offen nt lds
  s_add_u32 m0, s53, 1024
  s_add_u32 s52, s52, 32768
  buffer_load_dwordx4 v8, s[36:39], s52 offen nt lds
  s_add_u32 m0, s53, 2048
  s_add_u32 s52, s52, 32768
  buffer_load_dwordx4 v8, s[36:39], s52 offen nt lds
  s_add_u32 m0, s53, 3072
  s_add_u32 s52, s52, 32768
  buffer_load_dwordx4 v8, s[36:39], s52 offen nt lds
  s_add_u32 s50, s50, 1
  s_lshl_b32 s52, s49, 13
  s_add_u32 s52, s52, s48
  s_and_b32 s53, s49, 3
  s_lshl_b32 s53, s53, 13
  s_add_u32 m0, s53, 0
  s_nop 0
  buffer_load_dwordx4 v4, s[32:35], s52 offen nt lds
  buffer_load_dwordx4 v5, s[32:35], s52 offen offset:1024 nt lds
  buffer_load_dwordx4 v6, s[32:35], s52 offen offset:2048 nt lds
  buffer_load_dwordx4 v7, s[32:35], s52 offen offset:3072 nt lds
  s_add_u32 m0, s53, 4096
  s_add_u32 s52, s52, 4096
  buffer_load_dwordx4 v4, s[32:35], s52 offen nt lds
  buffer_load_dwordx4 v5, s[32:35], s52 offen offset:1024 nt lds
  buffer_load_dwordx4 v6, s[32:35], s52 offen offset:2048 nt lds
  buffer_load_dwordx4 v7, s[32:35], s52 offen offset:3072 nt lds
  s_add_u32 s49, s49, 1
  s_waitcnt vmcnt(16)
  s_barrier
  s_add_u32 s52, s27, s50
  s_and_b32 s52, s52, 15
  s_lshl_b32 s52, s52, 18
  s_lshr_b32 s53, s50, 4
  s_add_u32 s53, s53, s26
  s_lshl_b32 s53, s53, 8
  s_add_u32 s52, s52, s53
  s_add_u32 s52, s52, 0
  s_and_b32 s53, s50, 3
  s_lshl_b32 s53, s53, 13
  s_add_u32 s53, s53, 65536
  s_add_u32 m0, s53, 0
  s_nop 0
  buffer_load_dwordx4 v8, s[36:39], s52 offen nt lds
  s_add_u32 m0, s53, 1024
  s_add_u32 s52, s52, 32768
  buffer_load_dwordx4 v8, s[36:39], s52 offen nt lds
  s_add_u32 m0, s53, 2048
  s_add_u32 s52, s52, 32768
  buffer_load_dwordx4 v8, s[36:39], s52 offen nt lds
  s_add_u32 m0, s53, 3072
  s_add_u32 s52, s52, 32768
  buffer_load_dwordx4 v8, s[36:39], s52 offen nt lds
  s_add_u32 s50, s50, 1
  s_waitcnt vmcnt(16)
  s_mov_b32 s51, 3
L_LK_ph3:
  s_barrier
  s_add_u32 s52, s27, s50
  s_and_b32 s52, s52, 15
  s_lshl_b32 s52, s52, 18
  s_lshr_b32 s53, s50, 4
  s_add_u32 s53, s53, s26
  s_lshl_b32 s53, s53, 8
  s_add_u32 s52, s52, s53
  s_add_u32 s52, s52, 0
  s_and_b32 s53, s50, 3
  s_lshl_b32 s53, s53, 13
  s_add_u32 s53, s53, 65536
  s_add_u32 m0, s53, 0
  s_nop 0
  buffer_load_dwordx4 v8, s[36:39], s52 offen nt lds
  s_add_u32 m0, s53, 1024
  s_add_u32 s52, s52, 32768
  buffer_load_dwordx4 v8, s[36:39], s52 offen nt lds
  s_add_u32 m0, s53, 2048
  s_add_u32 s52, s52, 32768
  buffer_load_dwordx4 v8, s[36:39], s52 offen nt lds
  s_add_u32 m0, s53, 3072
  s_add_u32 s52, s52, 32768
  buffer_load_dwordx4 v8, s[36:39], s52 offen nt lds
  s_add_u32 s50, s50, 1
  s_waitcnt vmcnt(8)
  s_sub_u32 s51, s51, 1
  s_cmp_lg_u32 s51, 0
  s_cbranch_scc1 L_LK_ph3
  s_barrier
  s_add_u32 s52, s27, s50
  s_and_b32 s52, s52, 15
  s_lshl_b32 s52, s52, 18
  s_lshr_b32 s53, s50, 4
  s_add_u32 s53, s53, s26
  s_lshl_b32 s53, s53, 8
  s_add_u32 s52, s52, s53
  s_add_u32 s52, s52, 0
  s_and_b32 s53, s50, 3
  s_lshl_b32 s53, s53, 13
  s_add_u32 s53, s53, 65536
  s_add_u32 m0, s53, 0
  s_nop 0
  buffer_load_dwordx4 v8, s[36:39], s52 offen nt lds
  s_add_u32 m0, s53, 1024
  s_add_u32 s52, s52, 32768
  buffer_load_dwordx4 v8, s[36:39], s52 offen nt lds
  s_add_u32 m0, s53, 2048
  s_add_u32 s52, s52, 32768
  buffer_load_dwordx4 v8, s[36:39], s52 offen nt lds
  s_add_u32 m0, s53, 3072
  s_add_u32 s52, s52, 32768
  buffer_load_dwordx4 v8, s[36:39], s52 offen nt lds
  s_add_u32 s50, s50, 1
  s_lshl_b32 s52, s49, 13
  s_add_u32 s52, s52, s48
  s_and_b32 s53, s49, 3
  s_lshl_b32 s53, s53, 13
  s_add_u32 m0, s53, 0
  s_nop 0
  buffer_load_dwordx4 v4, s[32:35], s52 offen nt lds
  buffer_load_dwordx4 v5, s[32:35], s52 offen offset:1024 nt lds
  buffer_load_dwordx4 v6, s[32:35], s52 offen offset:2048 nt lds
  buffer_load_dwordx4 v7, s[32:35], s52 offen offset:3072 nt lds
  s_add_u32 m0, s53, 4096
  s_add_u32 s52, s52, 4096
  buffer_load_dwordx4 v4, s[32:35], s52 offen nt lds
  buffer_load_dwordx4 v5, s[32:35], s52 offen offset:1024 nt lds
  buffer_load_dwordx4 v6, s[32:35], s52 offen offset:2048 nt lds
  buffer_load_dwordx4 v7, s[32:35], s52 offen offset:3072 nt lds
  s_add_u32 s49, s49, 1
  s_waitcnt vmcnt(16)
  s_mov_b32 s51, 45
L_LK_ph5:
  s_barrier
  s_add_u32 s52, s27, s50
  s_and_b32 s52, s52, 15
  s_lshl_b32 s52, s52, 18
  s_lshr_b32 s53, s50, 4
  s_add_u32 s53, s53, s26
  s_lshl_b32 s53, s53, 8
  s_add_u32 s52, s52, s53
  s_add_u32 s52, s52, 0
  s_and_b32 s53, s50, 3
  s_lshl_b32 s53, s53, 13
  s_add_u32 s53, s53, 65536
  s_add_u32 m0, s53, 0
  s_nop 0
  buffer_load_dwordx4 v8, s[36:39], s52 offen nt lds
  s_add_u32 m0, s53, 1024
  s_add_u32 s52, s52, 32768
  buffer_load_dwordx4 v8, s[36:39], s52 offen nt lds
  s_add_u32 m0, s53, 2048
  s_add_u32 s52, s52, 32768
  buffer_load_dwordx4 v8, s[36:39], s52 offen nt lds
  s_add_u32 m0, s53, 3072
  s_add_u32 s52, s52, 32768
  buffer_load_dwordx4 v8, s[36:39], s52 offen nt lds
  s_add_u32 s50, s50, 1
  s_lshl_b32 s52, s49, 13
  s_add_u32 s52, s52, s48
  s_and_b32 s53, s49, 3
  s_lshl_b32 s53, s53, 13
  s_add_u32 m0, s53, 0
  s_nop 0
  buffer_load_dwordx4 v4, s[32:35], s52 offen nt lds
  buffer_load_dwordx4 v5, s[32:35], s52 offen offset:1024 nt lds
  buffer_load_dwordx4 v6, s[32:35], s52 offen offset:2048 nt lds
  buffer_load_dwordx4 v7, s[32:35], s52 offen offset:3072 nt lds
  s_add_u32 m0, s53, 4096
  s_add_u32 s52, s52, 4096
  buffer_load_dwordx4 v4, s[32:35], s52 offen nt lds
  buffer_load_dwordx4 v5, s[32:35], s52 offen offset:1024 nt lds
  buffer_load_dwordx4 v6, s[32:35], s52 offen offset:2048 nt lds
  buffer_load_dwordx4 v7, s[32:35], s52 offen offset:3072 nt lds
  s_add_u32 s49, s49, 1
  s_waitcnt vmcnt(24)
  s_sub_u32 s51, s51, 1
  s_cmp_lg_u32 s51, 0
  s_cbranch_scc1 L_LK_ph5
  s_barrier
  s_lshl_b32 s52, s49, 13
  s_add_u32 s52, s52, s48
  s_and_b32 s53, s49, 3
  s_lshl_b32 s53, s53, 13
  s_add_u32 m0, s53, 0
  s_nop 0
  buffer_load_dwordx4 v4, s[32:35], s52 offen nt lds
  buffer_load_dwordx4 v5, s[32:35], s52 offen offset:1024 nt lds
  buffer_load_dwordx4 v6, s[32:35], s52 offen offset:2048 nt lds
  buffer_load_dwordx4 v7, s[32:35], s52 offen offset:3072 nt lds
  s_add_u32 m0, s53, 4096
  s_add_u32 s52, s52, 4096
  buffer_load_dwordx4 v4, s[32:35], s52 offen nt lds
  buffer_load_dwordx4 v5, s[32:35], s52 offen offset:1024 nt lds
  buffer_load_dwordx4 v6, s[32:35], s52 offen offset:2048 nt lds
  buffer_load_dwordx4 v7, s[32:35], s52 offen offset:3072 nt lds
  s_add_u32 s49, s49, 1
  s_waitcnt vmcnt(20)
  s_mov_b32 s51, 16
L_LK_ph7:
  s_barrier
  s_lshl_b32 s52, s49, 13
  s_add_u32 s52, s52, s48
  s_and_b32 s53, s49, 3
  s_lshl_b32 s53, s53, 13
  s_add_u32 m0, s53, 0
  s_nop 0
  buffer_load_dwordx4 v4, s[32:35], s52 offen nt lds
  buffer_load_dwordx4 v5, s[32:35], s52 offen offset:1024 nt lds
  buffer_load_dwordx4 v6, s[32:35], s52 offen offset:2048 nt lds
  buffer_load_dwordx4 v7, s[32:35], s52 offen offset:3072 nt lds
  s_add_u32 m0, s53, 4096
  s_add_u32 s52, s52, 4096
  buffer_load_dwordx4 v4, s[32:35], s52 offen nt lds
  buffer_load_dwordx4 v5, s[32:35], s52 offen offset:1024 nt lds
  buffer_load_dwordx4 v6, s[32:35], s52 offen offset:2048 nt lds
  buffer_load_dwordx4 v7, s[32:35], s52 offen offset:3072 nt lds
  s_add_u32 s49, s49, 1
  s_waitcnt vmcnt(16)
  s_sub_u32 s51, s51, 1
  s_cmp_lg_u32 s51, 0
  s_cbranch_scc1 L_LK_ph7
  s_barrier
  s_waitcnt vmcnt(8)
  s_barrier
  s_waitcnt vmcnt(0)
  s_branch L_tail_pre
L_roleLV:
  s_mov_b32 s32, s12
  s_and_b32 s33, s13, 0xffff
  s_mov_b32 s34, 0x4000000
  s_mov_b32 s35, 0x20000
  s_mov_b32 s36, s14
  s_and_b32 s37, s15, 0xffff
  s_mov_b32 s38, 0x400000
  s_mov_b32 s39, 0x20000
  s_lshl_b32 s48, s24, 5
  s_add_u32 s48, s48, s26
  s_lshl_b32 s48, s48, 17
  v_and_b32 v1, 15, v0
  v_lshrrev_b32 v2, 4, v0
  v_add_u32 v3, 0, v2
  v_lshlrev_b32 v3, 1, v3
  v_xor_b32 v3, v1, v3
  v_lshlrev_b32 v3, 4, v3
  v_lshl_add_u32 v4, v2, 8, v3
  v_add_u32 v3, 4, v2
  v_lshlrev_b32 v3, 1, v3
  v_xor_b32 v3, v1, v3
  v_lshlrev_b32 v3, 4, v3
  v_lshl_add_u32 v5, v2, 8, v3
  v_add_u32 v3, 0, v2
  v_lshlrev_b32 v3, 1, v3
  v_xor_b32 v3, v1, v3
  v_lshlrev_b32 v3, 4, v3
  v_lshl_add_u32 v6, v2, 8, v3
  v_add_u32 v3, 4, v2
  v_lshlrev_b32 v3, 1, v3
  v_xor_b32 v3, v1, v3
  v_lshlrev_b32 v3, 4, v3
  v_lshl_add_u32 v7, v2, 8, v3
  v_lshlrev_b32 v3, 2, v2
  v_xor_b32 v3, v1, v3
  v_lshlrev_b32 v3, 4, v3
  v_lshlrev_b32 v9, 13, v2
  v_add_u32 v8, v9, v3
  s_mov_b32 s49, 0
  s_mov_b32 s50, 0
  s_add_u32 s52, s27, s50
  s_and_b32 s52, s52, 15
  s_lshl_b32 s52, s52, 18
  s_lshr_b32 s53, s50, 4
  s_add_u32 s53, s53, s26
  s_lshl_b32 s53, s53, 8
  s_add_u32 s52, s52, s53
  s_add_u32 s52, s52, 131072
  s_and_b32 s53, s50, 3
  s_lshl_b32 s53, s53, 13
  s_add_u32 s53, s53, 69632
  s_add_u32 m0, s53, 0
  s_nop 0
  buffer_load_dwordx4 v8, s[36:39], s52 offen nt lds
  s_add_u32 m0, s53, 1024
  s_add_u32 s52, s52, 32768
  buffer_load_dwordx4 v8, s[36:39], s52 offen nt lds
  s_add_u32 m0, s53, 2048
  s_add_u32 s52, s52, 32768
  buffer_load_dwordx4 v8, s[36:39], s52 offen nt lds
  s_add_u32 m0, s53, 3072
  s_add_u32 s52, s52, 32768
  buffer_load_dwordx4 v8, s[36:39], s52 offen nt lds
  s_add_u32 s50, s50, 1
  s_add_u32 s52, s27, s50
  s_and_b32 s52, s52, 15
  s_lshl_b32 s52, s52, 18
  s_lshr_b32 s53, s50, 4
  s_add_u32 s53, s53, s26
  s_lshl_b32 s53, s53, 8
  s_add_u32 s52, s52, s53
  s_add_u32 s52, s52, 131072
  s_and_b32 s53, s50, 3
  s_lshl_b32 s53, s53, 13
  s_add_u32 s53, s53, 69632
  s_add_u32 m0, s53, 0
  s_nop 0
  buffer_load_dwordx4 v8, s[36:39], s52 offen nt lds
  s_add_u32 m0, s53, 1024
  s_add_u32 s52, s52, 32768
  buffer_load_dwordx4 v8, s[36:39], s52 offen nt lds
  s_add_u32 m0, s53, 2048
  s_add_u32 s52, s52, 32768
  buffer_load_dwordx4 v8, s[36:39], s52 offen nt lds
  s_add_u32 m0, s53, 3072
  s_add_u32 s52, s52, 32768
  buffer_load_dwordx4 v8, s[36:39], s52 offen nt lds
  s_add_u32 s50, s50, 1
  s_add_u32 s52, s27, s50
  s_and_b32 s52, s52, 15
  s_lshl_b32 s52, s52, 18
  s_lshr_b32 s53, s50, 4
  s_add_u32 s53, s53, s26
  s_lshl_b32 s53, s53, 8
  s_add_u32 s52, s52, s53
  s_add_u32 s52, s52, 131072
  s_and_b32 s53, s50, 3
  s_lshl_b32 s53, s53, 13
  s_add_u32 s53, s53, 69632
  s_add_u32 m0, s53, 0
  s_nop 0
  buffer_load_dwordx4 v8, s[36:39], s52 offen nt lds
  s_add_u32 m0, s53, 1024
  s_add_u32 s52, s52, 32768
  buffer_load_dwordx4 v8, s[36:39], s52 offen nt lds
  s_add_u32 m0, s53, 2048
  s_add_u32 s52, s52, 32768
  buffer_load_dwordx4 v8, s[36:39], s52 offen nt lds
  s_add_u32 m0, s53, 3072
  s_add_u32 s52, s52, 32768
  buffer_load_dwordx4 v8, s[36:39], s52 offen nt lds
  s_add_u32 s50, s50, 1
  s_add_u32 s52, s27, s50
  s_and_b32 s52, s52, 15
  s_lshl_b32 s52, s52, 18
  s_lshr_b32 s53, s50, 4
  s_add_u32 s53, s53, s26
  s_lshl_b32 s53, s53, 8
  s_add_u32 s52, s52, s53
  s_add_u32 s52, s52, 131072
  s_and_b32 s53, s50, 3
  s_lshl_b32 s53, s53, 13
  s_add_u32 s53, s53, 69632
  s_add_u32 m0, s53, 0
  s_nop 0
  buffer_load_dwordx4 v8, s[36:39], s52 offen nt lds
  s_add_u32 m0, s53, 1024
  s_add_u32 s52, s52, 32768
  buffer_load_dwordx4 v8, s[36:39], s52 offen nt lds
  s_add_u32 m0, s53, 2048
  s_add_u32 s52, s52, 32768
  buffer_load_dwordx4 v8, s[36:39], s52 offen nt lds
  s_add_u32 m0, s53, 3072
  s_add_u32 s52, s52, 32768
  buffer_load_dwordx4 v8, s[36:39], s52 offen nt lds
  s_add_u32 s50, s50, 1
  s_waitcnt vmcnt(12)
  s_barrier
  s_waitcnt vmcnt(8)
  s_mov_b32 s51, 14
L_LV_ph0:
  s_barrier
  s_add_u32 s52, s27, s50
  s_and_b32 s52, s52, 15
  s_lshl_b32 s52, s52, 18
  s_lshr_b32 s53, s50, 4
  s_add_u32 s53, s53, s26
  s_lshl_b32 s53, s53, 8
  s_add_u32 s52, s52, s53
  s_add_u32 s52, s52, 131072
  s_and_b32 s53, s50, 3
  s_lshl_b32 s53, s53, 13
  s_add_u32 s53, s53, 69632
  s_add_u32 m0, s53, 0
  s_nop 0
  buffer_load_dwordx4 v8, s[36:39], s52 offen nt lds
  s_add_u32 m0, s53, 1024
  s_add_u32 s52, s52, 32768
  buffer_load_dwordx4 v8, s[36:39], s52 offen nt lds
  s_add_u32 m0, s53, 2048
  s_add_u32 s52, s52, 32768
  buffer_load_dwordx4 v8, s[36:39], s52 offen nt lds
  s_add_u32 m0, s53, 3072
  s_add_u32 s52, s52, 32768
  buffer_load_dwordx4 v8, s[36:39], s52 offen nt lds
  s_add_u32 s50, s50, 1
  s_waitcnt vmcnt(8)
  s_sub_u32 s51, s51, 1
  s_cmp_lg_u32 s51, 0
  s_cbranch_scc1 L_LV_ph0
  s_barrier
  s_add_u32 s52, s27, s50
  s_and_b32 s52, s52, 15
  s_lshl_b32 s52, s52, 18
  s_lshr_b32 s53, s50, 4
  s_add_u32 s53, s53, s26
  s_lshl_b32 s53, s53, 8
  s_add_u32 s52, s52, s53
  s_add_u32 s52, s52, 131072
  s_and_b32 s53, s50, 3
  s_lshl_b32 s53, s53, 13
  s_add_u32 s53, s53, 69632
  s_add_u32 m0, s53, 0
  s_nop 0
  buffer_load_dwordx4 v8, s[36:39], s52 offen nt lds
  s_add_u32 m0, s53, 1024
  s_add_u32 s52, s52, 32768
  buffer_load_dwordx4 v8, s[36:39], s52 offen nt lds
  s_add_u32 m0, s53, 2048
  s_add_u32 s52, s52, 32768
  buffer_load_dwordx4 v8, s[36:39], s52 offen nt lds
  s_add_u32 m0, s53, 3072
  s_add_u32 s52, s52, 32768
  buffer_load_dwordx4 v8, s[36:39], s52 offen nt lds
  s_add_u32 s50, s50, 1
  s_lshl_b32 s52, s49, 13
  s_add_u32 s52, s52, s48
  s_and_b32 s53, s49, 3
  s_lshl_b32 s53, s53, 13
  s_add_u32 m0, s53, 32768
  s_nop 0
  buffer_load_dwordx4 v4, s[32:35], s52 offen nt lds
  buffer_load_dwordx4 v5, s[32:35], s52 offen offset:1024 nt lds
  buffer_load_dwordx4 v6, s[32:35], s52 offen offset:2048 nt lds
  buffer_load_dwordx4 v7, s[32:35], s52 offen offset:3072 nt lds
  s_add_u32 m0, s53, 36864
  s_add_u32 s52, s52, 4096
  buffer_load_dwordx4 v4, s[32:35], s52 offen nt lds
  buffer_load_dwordx4 v5, s[32:35], s52 offen offset:1024 nt lds
  buffer_load_dwordx4 v6, s[32:35], s52 offen offset:2048 nt lds
  buffer_load_dwordx4 v7, s[32:35], s52 offen offset:3072 nt lds
  s_add_u32 s49, s49, 1
  s_waitcnt vmcnt(16)
  s_mov_b32 s51, 45
L_LV_ph2:
  s_barrier
  s_add_u32 s52, s27, s50
  s_and_b32 s52, s52, 15
  s_lshl_b32 s52, s52, 18
  s_lshr_b32 s53, s50, 4
  s_add_u32 s53, s53, s26
  s_lshl_b32 s53, s53, 8
  s_add_u32 s52, s52, s53
  s_add_u32 s52, s52, 131072
  s_and_b32 s53, s50, 3
  s_lshl_b32 s53, s53, 13
  s_add_u32 s53, s53, 69632
  s_add_u32 m0, s53, 0
  s_nop 0
  buffer_load_dwordx4 v8, s[36:39], s52 offen nt lds
  s_add_u32 m0, s53, 1024
  s_add_u32 s52, s52, 32768
  buffer_load_dwordx4 v8, s[36:39], s52 offen nt lds
  s_add_u32 m0, s53, 2048
  s_add_u32 s52, s52, 32768
  buffer_load_dwordx4 v8, s[36:39], s52 offen nt lds
  s_add_u32 m0, s53, 3072
  s_add_u32 s52, s52, 32768
  buffer_load_dwordx4 v8, s[36:39], s52 offen nt lds
  s_add_u32 s50, s50, 1
  s_lshl_b32 s52, s49, 13
  s_add_u32 s52, s52, s48
  s_and_b32 s53, s49, 3
  s_lshl_b32 s53, s53, 13
  s_add_u32 m0, s53, 32768
  s_nop 0
  buffer_load_dwordx4 v4, s[32:35], s52 offen nt lds
  buffer_load_dwordx4 v5, s[32:35], s52 offen offset:1024 nt lds
  buffer_load_dwordx4 v6, s[32:35], s52 offen offset:2048 nt lds
  buffer_load_dwordx4 v7, s[32:35], s52 offen offset:3072 nt lds
  s_add_u32 m0, s53, 36864
  s_add_u32 s52, s52, 4096
  buffer_load_dwordx4 v4, s[32:35], s52 offen nt lds
  buffer_load_dwordx4 v5, s[32:35], s52 offen offset:1024 nt lds
  buffer_load_dwordx4 v6, s[32:35], s52 offen offset:2048 nt lds
  buffer_load_dwordx4 v7, s[32:35], s52 offen offset:3072 nt lds
  s_add_u32 s49, s49, 1
  s_waitcnt vmcnt(24)
  s_sub_u32 s51, s51, 1
  s_cmp_lg_u32 s51, 0
  s_cbranch_scc1 L_LV_ph2
  s_barrier
  s_lshl_b32 s52, s49, 13
  s_add_u32 s52, s52, s48
  s_and_b32 s53, s49, 3
  s_lshl_b32 s53, s53, 13
  s_add_u32 m0, s53, 32768
  s_nop 0
  buffer_load_dwordx4 v4, s[32:35], s52 offen nt lds
  buffer_load_dwordx4 v5, s[32:35], s52 offen offset:1024 nt lds
  buffer_load_dwordx4 v6, s[32:35], s52 offen offset:2048 nt lds
  buffer_load_dwordx4 v7, s[32:35], s52 offen offset:3072 nt lds
  s_add_u32 m0, s53, 36864
  s_add_u32 s52, s52, 4096
  buffer_load_dwordx4 v4, s[32:35], s52 offen nt lds
  buffer_load_dwordx4 v5, s[32:35], s52 offen offset:1024 nt lds
  buffer_load_dwordx4 v6, s[32:35], s52 offen offset:2048 nt lds
  buffer_load_dwordx4 v7, s[32:35], s52 offen offset:3072 nt lds
  s_add_u32 s49, s49, 1
  s_waitcnt vmcnt(20)
  s_mov_b32 s51, 17
L_LV_ph4:
  s_barrier
  s_lshl_b32 s52, s49, 13
  s_add_u32 s52, s52, s48
  s_and_b32 s53, s49, 3
  s_lshl_b32 s53, s53, 13
  s_add_u32 m0, s53, 32768
  s_nop 0
  buffer_load_dwordx4 v4, s[32:35], s52 offen nt lds
  buffer_load_dwordx4 v5, s[32:35], s52 offen offset:1024 nt lds
  buffer_load_dwordx4 v6, s[32:35], s52 offen offset:2048 nt lds
  buffer_load_dwordx4 v7, s[32:35], s52 offen offset:3072 nt lds
  s_add_u32 m0, s53, 36864
  s_add_u32 s52, s52, 4096
  buffer_load_dwordx4 v4, s[32:35], s52 offen nt lds
  buffer_load_dwordx4 v5, s[32:35], s52 offen offset:1024 nt lds
  buffer_load_dwordx4 v6, s[32:35], s52 offen offset:2048 nt lds
  buffer_load_dwordx4 v7, s[32:35], s52 offen offset:3072 nt lds
  s_add_u32 s49, s49, 1
  s_waitcnt vmcnt(16)
  s_sub_u32 s51, s51, 1
  s_cmp_lg_u32 s51, 0
  s_cbranch_scc1 L_LV_ph4
  s_barrier
  s_waitcnt vmcnt(8)
  s_barrier
  s_waitcnt vmcnt(0)
  s_mov_b32 s54, 2
  s_branch L_tail_mm
L_roleG:
  s_sub_u32 s48, s20, 4
  s_mov_b32 s56, 0x3e0293ee
  s_mov_b32 s57, 0x3e0293ee
  v_mov_b32 v241, v0
  v_lshlrev_b32 v240, 4, v0
  v_and_b32 v1, 15, v0
  v_lshrrev_b32 v2, 4, v0
  v_xor_b32 v3, v1, v2
  v_lshlrev_b32 v1, 8, v1
  v_xor_b32 v2, 0, v3
  v_lshl_add_u32 v228, v2, 4, v1
  v_xor_b32 v2, 4, v3
  v_lshl_add_u32 v229, v2, 4, v1
  v_xor_b32 v2, 8, v3
  v_lshl_add_u32 v230, v2, 4, v1
  v_xor_b32 v2, 12, v3
  v_lshl_add_u32 v231, v2, 4, v1
  s_lshl_b32 s49, s48, 14
  s_add_u32 s49, s49, 98304
  v_add_u32 v228, s49, v228
  v_add_u32 v229, s49, v229
  v_add_u32 v230, s49, v230
  v_add_u32 v231, s49, v231
  v_and_b32 v1, 15, v0
  v_lshrrev_b32 v2, 4, v0
  v_lshrrev_b32 v3, 2, v1
  v_lshl_add_u32 v5, v2, 3, v3
  v_lshlrev_b32 v5, 8, v5
  v_and_b32 v6, 3, v1
  v_lshl_add_u32 v5, v6, 4, v5
  v_add_u32 v5, 65536, v5
  v_xor_b32 v6, 0, v3
  v_lshl_add_u32 v224, v6, 6, v5
  v_xor_b32 v6, 1, v3
  v_lshl_add_u32 v225, v6, 6, v5
  v_xor_b32 v6, 2, v3
  v_lshl_add_u32 v226, v6, 6, v5
  v_xor_b32 v6, 3, v3
  v_lshl_add_u32 v227, v6, 6, v5
  s_barrier
  ds_read_b128 v[0:3], v228 offset:0
  ds_read_b128 v[4:7], v228 offset:4096
  ds_read_b128 v[8:11], v229 offset:0
  ds_read_b128 v[12:15], v229 offset:4096
  ds_read_b128 v[16:19], v230 offset:0
  ds_read_b128 v[20:23], v230 offset:4096
  ds_read_b128 v[24:27], v231 offset:0
  ds_read_b128 v[28:31], v231 offset:4096
  ds_read_b64_tr_b16 v[192:193], v224 offset:0
  ds_read_b64_tr_b16 v[194:195], v224 offset:1024
  ds_read_b64_tr_b16 v[196:197], v224 offset:8
  ds_read_b64_tr_b16 v[198:199], v224 offset:1032
  ds_read_b64_tr_b16 v[200:201], v225 offset:0
  ds_read_b64_tr_b16 v[202:203], v225 offset:1024
  ds_read_b64_tr_b16 v[204:205], v225 offset:8
  ds_read_b64_tr_b16 v[206:207], v225 offset:1032
  ds_read_b64_tr_b16 v[208:209], v226 offset:0
  ds_read_b64_tr_b16 v[210:211], v226 offset:1024
  ds_read_b64_tr_b16 v[212:213], v226 offset:8
  ds_read_b64_tr_b16 v[214:215], v226 offset:1032
  ds_read_b64_tr_b16 v[216:217], v227 offset:0
  ds_read_b64_tr_b16 v[218:219], v227 offset:1024
  ds_read_b64_tr_b16 v[220:221], v227 offset:8
  ds_read_b64_tr_b16 v[222:223], v227 offset:1032
  s_waitcnt lgkmcnt(0)
  s_mov_b32 s51, 0
  s_barrier
  v_mfma_f32_16x16x32_bf16 v[128:131], v[192:195], v[0:3], 0
  v_mfma_f32_16x16x32_bf16 v[136:139], v[192:195], v[4:7], 0
  v_mfma_f32_16x16x32_bf16 v[132:135], v[196:199], v[0:3], 0
  ds_read_b64_tr_b16 v[192:193], v224 offset:8192
  v_mfma_f32_16x16x32_bf16 v[140:143], v[196:199], v[4:7], 0
  ds_read_b64_tr_b16 v[194:195], v224 offset:9216
  v_mfma_f32_16x16x32_bf16 v[144:147], v[200:203], v[0:3], 0
  ds_read_b64_tr_b16 v[196:197], v224 offset:8200
  v_mfma_f32_16x16x32_bf16 v[152:155], v[200:203], v[4:7], 0
  ds_read_b64_tr_b16 v[198:199], v224 offset:9224
  v_mfma_f32_16x16x32_bf16 v[148:151], v[204:207], v[0:3], 0
  ds_read_b64_tr_b16 v[200:201], v225 offset:8192
  v_mfma_f32_16x16x32_bf16 v[156:159], v[204:207], v[4:7], 0
  ds_read_b64_tr_b16 v[202:203], v225 offset:9216
  v_mfma_f32_16x16x32_bf16 v[160:163], v[208:211], v[0:3], 0
  ds_read_b64_tr_b16 v[204:205], v225 offset:8200
  v_mfma_f32_16x16x32_bf16 v[168:171], v[208:211], v[4:7], 0
  ds_read_b64_tr_b16 v[206:207], v225 offset:9224
  v_mfma_f32_16x16x32_bf16 v[164:167], v[212:215], v[0:3], 0
  ds_read_b64_tr_b16 v[208:209], v226 offset:8192
  v_mfma_f32_16x16x32_bf16 v[172:175], v[212:215], v[4:7], 0
  ds_read_b64_tr_b16 v[210:211], v226 offset:9216
  v_mfma_f32_16x16x32_bf16 v[176:179], v[216:219], v[0:3], 0
  ds_read_b64_tr_b16 v[212:213], v226 offset:8200
  v_mfma_f32_16x16x32_bf16 v[184:187], v[216:219], v[4:7], 0
  ds_read_b64_tr_b16 v[214:215], v226 offset:9224
  v_mfma_f32_16x16x32_bf16 v[180:183], v[220:223], v[0:3], 0
  ds_read_b64_tr_b16 v[216:217], v227 offset:8192
  v_mfma_f32_16x16x32_bf16 v[188:191], v[220:223], v[4:7], 0
  ds_read_b64_tr_b16 v[218:219], v227 offset:9216
  ds_read_b64_tr_b16 v[220:221], v227 offset:8200
  ds_read_b64_tr_b16 v[222:223], v227 offset:9224
  s_waitcnt lgkmcnt(0)
  s_barrier
  v_mfma_f32_16x16x32_bf16 v[128:131], v[192:195], v[8:11], v[128:131]
  v_mfma_f32_16x16x32_bf16 v[136:139], v[192:195], v[12:15], v[136:139]
  v_mfma_f32_16x16x32_bf16 v[132:135], v[196:199], v[8:11], v[132:135]
  ds_read_b64_tr_b16 v[192:193], v224 offset:16384
  v_mfma_f32_16x16x32_bf16 v[140:143], v[196:199], v[12:15], v[140:143]
  ds_read_b64_tr_b16 v[194:195], v224 offset:17408
  v_mfma_f32_16x16x32_bf16 v[144:147], v[200:203], v[8:11], v[144:147]
  ds_read_b64_tr_b16 v[196:197], v224 offset:16392
  v_mfma_f32_16x16x32_bf16 v[152:155], v[200:203], v[12:15], v[152:155]
  ds_read_b64_tr_b16 v[198:199], v224 offset:17416
  v_mfma_f32_16x16x32_bf16 v[148:151], v[204:207], v[8:11], v[148:151]
  ds_read_b64_tr_b16 v[200:201], v225 offset:16384
  v_mfma_f32_16x16x32_bf16 v[156:159], v[204:207], v[12:15], v[156:159]
  ds_read_b64_tr_b16 v[202:203], v225 offset:17408
  v_mfma_f32_16x16x32_bf16 v[160:163], v[208:211], v[8:11], v[160:163]
  ds_read_b64_tr_b16 v[204:205], v225 offset:16392
  v_mfma_f32_16x16x32_bf16 v[168:171], v[208:211], v[12:15], v[168:171]
  ds_read_b64_tr_b16 v[206:207], v225 offset:17416
  v_mfma_f32_16x16x32_bf16 v[164:167], v[212:215], v[8:11], v[164:167]
  ds_read_b64_tr_b16 v[208:209], v226 offset:16384
  v_mfma_f32_16x16x32_bf16 v[172:175], v[212:215], v[12:15], v[172:175]
  ds_read_b64_tr_b16 v[210:211], v226 offset:17408
  v_mfma_f32_16x16x32_bf16 v[176:179], v[216:219], v[8:11], v[176:179]
  ds_read_b64_tr_b16 v[212:213], v226 offset:16392
  v_mfma_f32_16x16x32_bf16 v[184:187], v[216:219], v[12:15], v[184:187]
  ds_read_b64_tr_b16 v[214:215], v226 offset:17416
  v_mfma_f32_16x16x32_bf16 v[180:183], v[220:223], v[8:11], v[180:183]
  ds_read_b64_tr_b16 v[216:217], v227 offset:16384
  v_mfma_f32_16x16x32_bf16 v[188:191], v[220:223], v[12:15], v[188:191]
  ds_read_b64_tr_b16 v[218:219], v227 offset:17408
  ds_read_b64_tr_b16 v[220:221], v227 offset:16392
  ds_read_b64_tr_b16 v[222:223], v227 offset:17416
  s_waitcnt lgkmcnt(0)
  s_barrier
  v_mfma_f32_16x16x32_bf16 v[128:131], v[192:195], v[16:19], v[128:131]
  v_mfma_f32_16x16x32_bf16 v[136:139], v[192:195], v[20:23], v[136:139]
  v_mfma_f32_16x16x32_bf16 v[132:135], v[196:199], v[16:19], v[132:135]
  ds_read_b64_tr_b16 v[192:193], v224 offset:24576
  v_mfma_f32_16x16x32_bf16 v[140:143], v[196:199], v[20:23], v[140:143]
  ds_read_b64_tr_b16 v[194:195], v224 offset:25600
  v_mfma_f32_16x16x32_bf16 v[144:147], v[200:203], v[16:19], v[144:147]
  ds_read_b64_tr_b16 v[196:197], v224 offset:24584
  v_mfma_f32_16x16x32_bf16 v[152:155], v[200:203], v[20:23], v[152:155]
  ds_read_b64_tr_b16 v[198:199], v224 offset:25608
  v_mfma_f32_16x16x32_bf16 v[148:151], v[204:207], v[16:19], v[148:151]
  ds_read_b64_tr_b16 v[200:201], v225 offset:24576
  v_mfma_f32_16x16x32_bf16 v[156:159], v[204:207], v[20:23], v[156:159]
  ds_read_b64_tr_b16 v[202:203], v225 offset:25600
  v_mfma_f32_16x16x32_bf16 v[160:163], v[208:211], v[16:19], v[160:163]
  ds_read_b64_tr_b16 v[204:205], v225 offset:24584
  v_mfma_f32_16x16x32_bf16 v[168:171], v[208:211], v[20:23], v[168:171]
  ds_read_b64_tr_b16 v[206:207], v225 offset:25608
  v_mfma_f32_16x16x32_bf16 v[164:167], v[212:215], v[16:19], v[164:167]
  ds_read_b64_tr_b16 v[208:209], v226 offset:24576
  v_mfma_f32_16x16x32_bf16 v[172:175], v[212:215], v[20:23], v[172:175]
  ds_read_b64_tr_b16 v[210:211], v226 offset:25600
  v_mfma_f32_16x16x32_bf16 v[176:179], v[216:219], v[16:19], v[176:179]
  ds_read_b64_tr_b16 v[212:213], v226 offset:24584
  v_mfma_f32_16x16x32_bf16 v[184:187], v[216:219], v[20:23], v[184:187]
  ds_read_b64_tr_b16 v[214:215], v226 offset:25608
  v_mfma_f32_16x16x32_bf16 v[180:183], v[220:223], v[16:19], v[180:183]
  ds_read_b64_tr_b16 v[216:217], v227 offset:24576
  v_mfma_f32_16x16x32_bf16 v[188:191], v[220:223], v[20:23], v[188:191]
  ds_read_b64_tr_b16 v[218:219], v227 offset:25600
  ds_read_b64_tr_b16 v[220:221], v227 offset:24584
  ds_read_b64_tr_b16 v[222:223], v227 offset:25608
  s_waitcnt lgkmcnt(0)
  s_barrier
  v_mfma_f32_16x16x32_bf16 v[128:131], v[192:195], v[24:27], v[128:131]
  v_mfma_f32_16x16x32_bf16 v[136:139], v[192:195], v[28:31], v[136:139]
  v_mfma_f32_16x16x32_bf16 v[132:135], v[196:199], v[24:27], v[132:135]
  ds_read_b64_tr_b16 v[192:193], v224 offset:0
  v_mfma_f32_16x16x32_bf16 v[140:143], v[196:199], v[28:31], v[140:143]
  ds_read_b64_tr_b16 v[194:195], v224 offset:1024
  v_mfma_f32_16x16x32_bf16 v[144:147], v[200:203], v[24:27], v[144:147]
  ds_read_b64_tr_b16 v[196:197], v224 offset:8
  v_mfma_f32_16x16x32_bf16 v[152:155], v[200:203], v[28:31], v[152:155]
  ds_read_b64_tr_b16 v[198:199], v224 offset:1032
  v_mfma_f32_16x16x32_bf16 v[148:151], v[204:207], v[24:27], v[148:151]
  ds_read_b64_tr_b16 v[200:201], v225 offset:0
  v_mfma_f32_16x16x32_bf16 v[156:159], v[204:207], v[28:31], v[156:159]
  ds_read_b64_tr_b16 v[202:203], v225 offset:1024
  v_mfma_f32_16x16x32_bf16 v[160:163], v[208:211], v[24:27], v[160:163]
  ds_read_b64_tr_b16 v[204:205], v225 offset:8
  v_mfma_f32_16x16x32_bf16 v[168:171], v[208:211], v[28:31], v[168:171]
  ds_read_b64_tr_b16 v[206:207], v225 offset:1032
  v_mfma_f32_16x16x32_bf16 v[164:167], v[212:215], v[24:27], v[164:167]
  ds_read_b64_tr_b16 v[208:209], v226 offset:0
  v_mfma_f32_16x16x32_bf16 v[172:175], v[212:215], v[28:31], v[172:175]
  ds_read_b64_tr_b16 v[210:211], v226 offset:1024
  v_mfma_f32_16x16x32_bf16 v[176:179], v[216:219], v[24:27], v[176:179]
  ds_read_b64_tr_b16 v[212:213], v226 offset:8
  v_mfma_f32_16x16x32_bf16 v[184:187], v[216:219], v[28:31], v[184:187]
  ds_read_b64_tr_b16 v[214:215], v226 offset:1032
  v_mfma_f32_16x16x32_bf16 v[180:183], v[220:223], v[24:27], v[180:183]
  ds_read_b64_tr_b16 v[216:217], v227 offset:0
  v_mfma_f32_16x16x32_bf16 v[188:191], v[220:223], v[28:31], v[188:191]
  ds_read_b64_tr_b16 v[218:219], v227 offset:1024
  ds_read_b64_tr_b16 v[220:221], v227 offset:8
  ds_read_b64_tr_b16 v[222:223], v227 offset:1032
  ds_read_b128 v[32:35], v228 offset:8192
  ds_read_b128 v[36:39], v228 offset:12288
  ds_read_b128 v[40:43], v229 offset:8192
  ds_read_b128 v[44:47], v229 offset:12288
  ds_read_b128 v[48:51], v230 offset:8192
  ds_read_b128 v[52:55], v230 offset:12288
  ds_read_b128 v[56:59], v231 offset:8192
  ds_read_b128 v[60:63], v231 offset:12288
  s_waitcnt lgkmcnt(0)
  s_barrier
  v_mfma_f32_16x16x32_bf16 v[128:131], v[192:195], v[32:35], v[128:131]
  v_mfma_f32_16x16x32_bf16 v[136:139], v[192:195], v[36:39], v[136:139]
  v_mfma_f32_16x16x32_bf16 v[132:135], v[196:199], v[32:35], v[132:135]
  ds_read_b64_tr_b16 v[192:193], v224 offset:8192
  v_mfma_f32_16x16x32_bf16 v[140:143], v[196:199], v[36:39], v[140:143]
  ds_read_b64_tr_b16 v[194:195], v224 offset:9216
  v_mfma_f32_16x16x32_bf16 v[144:147], v[200:203], v[32:35], v[144:147]
  ds_read_b64_tr_b16 v[196:197], v224 offset:8200
  v_mfma_f32_16x16x32_bf16 v[152:155], v[200:203], v[36:39], v[152:155]
  ds_read_b64_tr_b16 v[198:199], v224 offset:9224
  v_mfma_f32_16x16x32_bf16 v[148:151], v[204:207], v[32:35], v[148:151]
  ds_read_b64_tr_b16 v[200:201], v225 offset:8192
  v_mfma_f32_16x16x32_bf16 v[156:159], v[204:207], v[36:39], v[156:159]
  ds_read_b64_tr_b16 v[202:203], v225 offset:9216
  v_mfma_f32_16x16x32_bf16 v[160:163], v[208:211], v[32:35], v[160:163]
  ds_read_b64_tr_b16 v[204:205], v225 offset:8200
  v_mfma_f32_16x16x32_bf16 v[168:171], v[208:211], v[36:39], v[168:171]
  ds_read_b64_tr_b16 v[206:207], v225 offset:9224
  v_mfma_f32_16x16x32_bf16 v[164:167], v[212:215], v[32:35], v[164:167]
  ds_read_b64_tr_b16 v[208:209], v226 offset:8192
  v_mfma_f32_16x16x32_bf16 v[172:175], v[212:215], v[36:39], v[172:175]
  ds_read_b64_tr_b16 v[210:211], v226 offset:9216
  v_mfma_f32_16x16x32_bf16 v[176:179], v[216:219], v[32:35], v[176:179]
  ds_read_b64_tr_b16 v[212:213], v226 offset:8200
  v_mfma_f32_16x16x32_bf16 v[184:187], v[216:219], v[36:39], v[184:187]
  ds_read_b64_tr_b16 v[214:215], v226 offset:9224
  v_mfma_f32_16x16x32_bf16 v[180:183], v[220:223], v[32:35], v[180:183]
  ds_read_b64_tr_b16 v[216:217], v227 offset:8192
  v_mfma_f32_16x16x32_bf16 v[188:191], v[220:223], v[36:39], v[188:191]
  ds_read_b64_tr_b16 v[218:219], v227 offset:9216
  ds_read_b64_tr_b16 v[220:221], v227 offset:8200
  ds_read_b64_tr_b16 v[222:223], v227 offset:9224
  s_waitcnt lgkmcnt(0)
  s_barrier
  v_mfma_f32_16x16x32_bf16 v[128:131], v[192:195], v[40:43], v[128:131]
  v_mfma_f32_16x16x32_bf16 v[136:139], v[192:195], v[44:47], v[136:139]
  v_mfma_f32_16x16x32_bf16 v[132:135], v[196:199], v[40:43], v[132:135]
  ds_read_b64_tr_b16 v[192:193], v224 offset:16384
  v_mfma_f32_16x16x32_bf16 v[140:143], v[196:199], v[44:47], v[140:143]
  ds_read_b64_tr_b16 v[194:195], v224 offset:17408
  v_mfma_f32_16x16x32_bf16 v[144:147], v[200:203], v[40:43], v[144:147]
  ds_read_b64_tr_b16 v[196:197], v224 offset:16392
  v_mfma_f32_16x16x32_bf16 v[152:155], v[200:203], v[44:47], v[152:155]
  ds_read_b64_tr_b16 v[198:199], v224 offset:17416
  v_mfma_f32_16x16x32_bf16 v[148:151], v[204:207], v[40:43], v[148:151]
  ds_read_b64_tr_b16 v[200:201], v225 offset:16384
  v_mfma_f32_16x16x32_bf16 v[156:159], v[204:207], v[44:47], v[156:159]
  ds_read_b64_tr_b16 v[202:203], v225 offset:17408
  v_mfma_f32_16x16x32_bf16 v[160:163], v[208:211], v[40:43], v[160:163]
  ds_read_b64_tr_b16 v[204:205], v225 offset:16392
  v_mfma_f32_16x16x32_bf16 v[168:171], v[208:211], v[44:47], v[168:171]
  ds_read_b64_tr_b16 v[206:207], v225 offset:17416
  v_mfma_f32_16x16x32_bf16 v[164:167], v[212:215], v[40:43], v[164:167]
  ds_read_b64_tr_b16 v[208:209], v226 offset:16384
  v_mfma_f32_16x16x32_bf16 v[172:175], v[212:215], v[44:47], v[172:175]
  ds_read_b64_tr_b16 v[210:211], v226 offset:17408
  v_mfma_f32_16x16x32_bf16 v[176:179], v[216:219], v[40:43], v[176:179]
  ds_read_b64_tr_b16 v[212:213], v226 offset:16392
  v_mfma_f32_16x16x32_bf16 v[184:187], v[216:219], v[44:47], v[184:187]
  ds_read_b64_tr_b16 v[214:215], v226 offset:17416
  v_mfma_f32_16x16x32_bf16 v[180:183], v[220:223], v[40:43], v[180:183]
  ds_read_b64_tr_b16 v[216:217], v227 offset:16384
  v_mfma_f32_16x16x32_bf16 v[188:191], v[220:223], v[44:47], v[188:191]
  ds_read_b64_tr_b16 v[218:219], v227 offset:17408
  ds_read_b64_tr_b16 v[220:221], v227 offset:16392
  ds_read_b64_tr_b16 v[222:223], v227 offset:17416
  s_waitcnt lgkmcnt(0)
  s_barrier
  v_mfma_f32_16x16x32_bf16 v[128:131], v[192:195], v[48:51], v[128:131]
  v_mfma_f32_16x16x32_bf16 v[136:139], v[192:195], v[52:55], v[136:139]
  v_mfma_f32_16x16x32_bf16 v[132:135], v[196:199], v[48:51], v[132:135]
  ds_read_b64_tr_b16 v[192:193], v224 offset:24576
  v_mfma_f32_16x16x32_bf16 v[140:143], v[196:199], v[52:55], v[140:143]
  ds_read_b64_tr_b16 v[194:195], v224 offset:25600
  v_mfma_f32_16x16x32_bf16 v[144:147], v[200:203], v[48:51], v[144:147]
  ds_read_b64_tr_b16 v[196:197], v224 offset:24584
  v_mfma_f32_16x16x32_bf16 v[152:155], v[200:203], v[52:55], v[152:155]
  ds_read_b64_tr_b16 v[198:199], v224 offset:25608
  v_mfma_f32_16x16x32_bf16 v[148:151], v[204:207], v[48:51], v[148:151]
  ds_read_b64_tr_b16 v[200:201], v225 offset:24576
  v_mfma_f32_16x16x32_bf16 v[156:159], v[204:207], v[52:55], v[156:159]
  ds_read_b64_tr_b16 v[202:203], v225 offset:25600
  v_mfma_f32_16x16x32_bf16 v[160:163], v[208:211], v[48:51], v[160:163]
  ds_read_b64_tr_b16 v[204:205], v225 offset:24584
  v_mfma_f32_16x16x32_bf16 v[168:171], v[208:211], v[52:55], v[168:171]
  ds_read_b64_tr_b16 v[206:207], v225 offset:25608
  v_mfma_f32_16x16x32_bf16 v[164:167], v[212:215], v[48:51], v[164:167]
  ds_read_b64_tr_b16 v[208:209], v226 offset:24576
  v_mfma_f32_16x16x32_bf16 v[172:175], v[212:215], v[52:55], v[172:175]
  ds_read_b64_tr_b16 v[210:211], v226 offset:25600
  v_mfma_f32_16x16x32_bf16 v[176:179], v[216:219], v[48:51], v[176:179]
  ds_read_b64_tr_b16 v[212:213], v226 offset:24584
  v_mfma_f32_16x16x32_bf16 v[184:187], v[216:219], v[52:55], v[184:187]
  ds_read_b64_tr_b16 v[214:215], v226 offset:25608
  v_mfma_f32_16x16x32_bf16 v[180:183], v[220:223], v[48:51], v[180:183]
  ds_read_b64_tr_b16 v[216:217], v227 offset:24576
  v_mfma_f32_16x16x32_bf16 v[188:191], v[220:223], v[52:55], v[188:191]
  ds_read_b64_tr_b16 v[218:219], v227 offset:25600
  ds_read_b64_tr_b16 v[220:221], v227 offset:24584
  ds_read_b64_tr_b16 v[222:223], v227 offset:25608
  s_waitcnt lgkmcnt(0)
  s_barrier
  v_mfma_f32_16x16x32_bf16 v[128:131], v[192:195], v[56:59], v[128:131]
  v_mfma_f32_16x16x32_bf16 v[136:139], v[192:195], v[60:63], v[136:139]
  v_mfma_f32_16x16x32_bf16 v[132:135], v[196:199], v[56:59], v[132:135]
  ds_read_b64_tr_b16 v[192:193], v224 offset:0
  v_mfma_f32_16x16x32_bf16 v[140:143], v[196:199], v[60:63], v[140:143]
  ds_read_b64_tr_b16 v[194:195], v224 offset:1024
  v_mfma_f32_16x16x32_bf16 v[144:147], v[200:203], v[56:59], v[144:147]
  ds_read_b64_tr_b16 v[196:197], v224 offset:8
  v_mfma_f32_16x16x32_bf16 v[152:155], v[200:203], v[60:63], v[152:155]
  ds_read_b64_tr_b16 v[198:199], v224 offset:1032
  v_mfma_f32_16x16x32_bf16 v[148:151], v[204:207], v[56:59], v[148:151]
  ds_read_b64_tr_b16 v[200:201], v225 offset:0
  v_mfma_f32_16x16x32_bf16 v[156:159], v[204:207], v[60:63], v[156:159]
  ds_read_b64_tr_b16 v[202:203], v225 offset:1024
  v_mfma_f32_16x16x32_bf16 v[160:163], v[208:211], v[56:59], v[160:163]
  ds_read_b64_tr_b16 v[204:205], v225 offset:8
  v_mfma_f32_16x16x32_bf16 v[168:171], v[208:211], v[60:63], v[168:171]
  ds_read_b64_tr_b16 v[206:207], v225 offset:1032
  v_mfma_f32_16x16x32_bf16 v[164:167], v[212:215], v[56:59], v[164:167]
  ds_read_b64_tr_b16 v[208:209], v226 offset:0
  v_mfma_f32_16x16x32_bf16 v[172:175], v[212:215], v[60:63], v[172:175]
  ds_read_b64_tr_b16 v[210:211], v226 offset:1024
  v_mfma_f32_16x16x32_bf16 v[176:179], v[216:219], v[56:59], v[176:179]
  ds_read_b64_tr_b16 v[212:213], v226 offset:8
  v_mfma_f32_16x16x32_bf16 v[184:187], v[216:219], v[60:63], v[184:187]
  ds_read_b64_tr_b16 v[214:215], v226 offset:1032
  v_mfma_f32_16x16x32_bf16 v[180:183], v[220:223], v[56:59], v[180:183]
  ds_read_b64_tr_b16 v[216:217], v227 offset:0
  v_mfma_f32_16x16x32_bf16 v[188:191], v[220:223], v[60:63], v[188:191]
  ds_read_b64_tr_b16 v[218:219], v227 offset:1024
  ds_read_b64_tr_b16 v[220:221], v227 offset:8
  ds_read_b64_tr_b16 v[222:223], v227 offset:1032
  v_subrev_u32 v228, 98304, v228
  v_subrev_u32 v229, 98304, v229
  v_subrev_u32 v230, 98304, v230
  v_subrev_u32 v231, 98304, v231
  ds_read_b128 v[64:67], v228 offset:0
  ds_read_b128 v[68:71], v228 offset:4096
  ds_read_b128 v[72:75], v229 offset:0
  ds_read_b128 v[76:79], v229 offset:4096
  ds_read_b128 v[80:83], v230 offset:0
  ds_read_b128 v[84:87], v230 offset:4096
  ds_read_b128 v[88:91], v231 offset:0
  ds_read_b128 v[92:95], v231 offset:4096
  s_waitcnt lgkmcnt(0)
  s_barrier
  v_mfma_f32_16x16x32_bf16 v[128:131], v[192:195], v[64:67], v[128:131]
  v_mfma_f32_16x16x32_bf16 v[136:139], v[192:195], v[68:71], v[136:139]
  v_mfma_f32_16x16x32_bf16 v[132:135], v[196:199], v[64:67], v[132:135]
  ds_read_b64_tr_b16 v[192:193], v224 offset:8192
  v_mfma_f32_16x16x32_bf16 v[140:143], v[196:199], v[68:71], v[140:143]
  ds_read_b64_tr_b16 v[194:195], v224 offset:9216
  v_mfma_f32_16x16x32_bf16 v[144:147], v[200:203], v[64:67], v[144:147]
  ds_read_b64_tr_b16 v[196:197], v224 offset:8200
  v_mfma_f32_16x16x32_bf16 v[152:155], v[200:203], v[68:71], v[152:155]
  ds_read_b64_tr_b16 v[198:199], v224 offset:9224
  v_mfma_f32_16x16x32_bf16 v[148:151], v[204:207], v[64:67], v[148:151]
  ds_read_b64_tr_b16 v[200:201], v225 offset:8192
  v_mfma_f32_16x16x32_bf16 v[156:159], v[204:207], v[68:71], v[156:159]
  ds_read_b64_tr_b16 v[202:203], v225 offset:9216
  v_mfma_f32_16x16x32_bf16 v[160:163], v[208:211], v[64:67], v[160:163]
  ds_read_b64_tr_b16 v[204:205], v225 offset:8200
  v_mfma_f32_16x16x32_bf16 v[168:171], v[208:211], v[68:71], v[168:171]
  ds_read_b64_tr_b16 v[206:207], v225 offset:9224
  v_mfma_f32_16x16x32_bf16 v[164:167], v[212:215], v[64:67], v[164:167]
  ds_read_b64_tr_b16 v[208:209], v226 offset:8192
  v_mfma_f32_16x16x32_bf16 v[172:175], v[212:215], v[68:71], v[172:175]
  ds_read_b64_tr_b16 v[210:211], v226 offset:9216
  v_mfma_f32_16x16x32_bf16 v[176:179], v[216:219], v[64:67], v[176:179]
  ds_read_b64_tr_b16 v[212:213], v226 offset:8200
  v_mfma_f32_16x16x32_bf16 v[184:187], v[216:219], v[68:71], v[184:187]
  ds_read_b64_tr_b16 v[214:215], v226 offset:9224
  v_mfma_f32_16x16x32_bf16 v[180:183], v[220:223], v[64:67], v[180:183]
  ds_read_b64_tr_b16 v[216:217], v227 offset:8192
  v_mfma_f32_16x16x32_bf16 v[188:191], v[220:223], v[68:71], v[188:191]
  ds_read_b64_tr_b16 v[218:219], v227 offset:9216
  ds_read_b64_tr_b16 v[220:221], v227 offset:8200
  ds_read_b64_tr_b16 v[222:223], v227 offset:9224
  s_waitcnt lgkmcnt(0)
  s_barrier
  v_mfma_f32_16x16x32_bf16 v[128:131], v[192:195], v[72:75], v[128:131]
  v_mfma_f32_16x16x32_bf16 v[136:139], v[192:195], v[76:79], v[136:139]
  v_mfma_f32_16x16x32_bf16 v[132:135], v[196:199], v[72:75], v[132:135]
  ds_read_b64_tr_b16 v[192:193], v224 offset:16384
  v_mfma_f32_16x16x32_bf16 v[140:143], v[196:199], v[76:79], v[140:143]
  ds_read_b64_tr_b16 v[194:195], v224 offset:17408
  v_mfma_f32_16x16x32_bf16 v[144:147], v[200:203], v[72:75], v[144:147]
  ds_read_b64_tr_b16 v[196:197], v224 offset:16392
  v_mfma_f32_16x16x32_bf16 v[152:155], v[200:203], v[76:79], v[152:155]
  ds_read_b64_tr_b16 v[198:199], v224 offset:17416
  v_mfma_f32_16x16x32_bf16 v[148:151], v[204:207], v[72:75], v[148:151]
  ds_read_b64_tr_b16 v[200:201], v225 offset:16384
  v_mfma_f32_16x16x32_bf16 v[156:159], v[204:207], v[76:79], v[156:159]
  ds_read_b64_tr_b16 v[202:203], v225 offset:17408
  v_mfma_f32_16x16x32_bf16 v[160:163], v[208:211], v[72:75], v[160:163]
  ds_read_b64_tr_b16 v[204:205], v225 offset:16392
  v_mfma_f32_16x16x32_bf16 v[168:171], v[208:211], v[76:79], v[168:171]
  ds_read_b64_tr_b16 v[206:207], v225 offset:17416
  v_mfma_f32_16x16x32_bf16 v[164:167], v[212:215], v[72:75], v[164:167]
  ds_read_b64_tr_b16 v[208:209], v226 offset:16384
  v_mfma_f32_16x16x32_bf16 v[172:175], v[212:215], v[76:79], v[172:175]
  ds_read_b64_tr_b16 v[210:211], v226 offset:17408
  v_mfma_f32_16x16x32_bf16 v[176:179], v[216:219], v[72:75], v[176:179]
  ds_read_b64_tr_b16 v[212:213], v226 offset:16392
  v_mfma_f32_16x16x32_bf16 v[184:187], v[216:219], v[76:79], v[184:187]
  ds_read_b64_tr_b16 v[214:215], v226 offset:17416
  v_mfma_f32_16x16x32_bf16 v[180:183], v[220:223], v[72:75], v[180:183]
  ds_read_b64_tr_b16 v[216:217], v227 offset:16384
  v_mfma_f32_16x16x32_bf16 v[188:191], v[220:223], v[76:79], v[188:191]
  ds_read_b64_tr_b16 v[218:219], v227 offset:17408
  ds_read_b64_tr_b16 v[220:221], v227 offset:16392
  ds_read_b64_tr_b16 v[222:223], v227 offset:17416
  s_waitcnt lgkmcnt(0)
  s_barrier
  v_mfma_f32_16x16x32_bf16 v[128:131], v[192:195], v[80:83], v[128:131]
  v_mfma_f32_16x16x32_bf16 v[136:139], v[192:195], v[84:87], v[136:139]
  v_mfma_f32_16x16x32_bf16 v[132:135], v[196:199], v[80:83], v[132:135]
  ds_read_b64_tr_b16 v[192:193], v224 offset:24576
  v_mfma_f32_16x16x32_bf16 v[140:143], v[196:199], v[84:87], v[140:143]
  ds_read_b64_tr_b16 v[194:195], v224 offset:25600
  v_mfma_f32_16x16x32_bf16 v[144:147], v[200:203], v[80:83], v[144:147]
  ds_read_b64_tr_b16 v[196:197], v224 offset:24584
  v_mfma_f32_16x16x32_bf16 v[152:155], v[200:203], v[84:87], v[152:155]
  ds_read_b64_tr_b16 v[198:199], v224 offset:25608
  v_mfma_f32_16x16x32_bf16 v[148:151], v[204:207], v[80:83], v[148:151]
  ds_read_b64_tr_b16 v[200:201], v225 offset:24576
  v_mfma_f32_16x16x32_bf16 v[156:159], v[204:207], v[84:87], v[156:159]
  ds_read_b64_tr_b16 v[202:203], v225 offset:25600
  v_mfma_f32_16x16x32_bf16 v[160:163], v[208:211], v[80:83], v[160:163]
  ds_read_b64_tr_b16 v[204:205], v225 offset:24584
  v_mfma_f32_16x16x32_bf16 v[168:171], v[208:211], v[84:87], v[168:171]
  ds_read_b64_tr_b16 v[206:207], v225 offset:25608
  v_mfma_f32_16x16x32_bf16 v[164:167], v[212:215], v[80:83], v[164:167]
  ds_read_b64_tr_b16 v[208:209], v226 offset:24576
  v_mfma_f32_16x16x32_bf16 v[172:175], v[212:215], v[84:87], v[172:175]
  ds_read_b64_tr_b16 v[210:211], v226 offset:25600
  v_mfma_f32_16x16x32_bf16 v[176:179], v[216:219], v[80:83], v[176:179]
  ds_read_b64_tr_b16 v[212:213], v226 offset:24584
  v_mfma_f32_16x16x32_bf16 v[184:187], v[216:219], v[84:87], v[184:187]
  ds_read_b64_tr_b16 v[214:215], v226 offset:25608
  v_mfma_f32_16x16x32_bf16 v[180:183], v[220:223], v[80:83], v[180:183]
  ds_read_b64_tr_b16 v[216:217], v227 offset:24576
  v_mfma_f32_16x16x32_bf16 v[188:191], v[220:223], v[84:87], v[188:191]
  ds_read_b64_tr_b16 v[218:219], v227 offset:25600
  ds_read_b64_tr_b16 v[220:221], v227 offset:24584
  ds_read_b64_tr_b16 v[222:223], v227 offset:25608
  s_waitcnt lgkmcnt(0)
  s_barrier
  v_mfma_f32_16x16x32_bf16 v[128:131], v[192:195], v[88:91], v[128:131]
  v_mfma_f32_16x16x32_bf16 v[136:139], v[192:195], v[92:95], v[136:139]
  v_mfma_f32_16x16x32_bf16 v[132:135], v[196:199], v[88:91], v[132:135]
  ds_read_b64_tr_b16 v[192:193], v224 offset:0
  v_mfma_f32_16x16x32_bf16 v[140:143], v[196:199], v[92:95], v[140:143]
  ds_read_b64_tr_b16 v[194:195], v224 offset:1024
  v_mfma_f32_16x16x32_bf16 v[144:147], v[200:203], v[88:91], v[144:147]
  ds_read_b64_tr_b16 v[196:197], v224 offset:8
  v_mfma_f32_16x16x32_bf16 v[152:155], v[200:203], v[92:95], v[152:155]
  ds_read_b64_tr_b16 v[198:199], v224 offset:1032
  v_mfma_f32_16x16x32_bf16 v[148:151], v[204:207], v[88:91], v[148:151]
  ds_read_b64_tr_b16 v[200:201], v225 offset:0
  v_mfma_f32_16x16x32_bf16 v[156:159], v[204:207], v[92:95], v[156:159]
  ds_read_b64_tr_b16 v[202:203], v225 offset:1024
  v_mfma_f32_16x16x32_bf16 v[160:163], v[208:211], v[88:91], v[160:163]
  ds_read_b64_tr_b16 v[204:205], v225 offset:8
  v_mfma_f32_16x16x32_bf16 v[168:171], v[208:211], v[92:95], v[168:171]
  ds_read_b64_tr_b16 v[206:207], v225 offset:1032
  v_mfma_f32_16x16x32_bf16 v[164:167], v[212:215], v[88:91], v[164:167]
  ds_read_b64_tr_b16 v[208:209], v226 offset:0
  v_mfma_f32_16x16x32_bf16 v[172:175], v[212:215], v[92:95], v[172:175]
  ds_read_b64_tr_b16 v[210:211], v226 offset:1024
  v_mfma_f32_16x16x32_bf16 v[176:179], v[216:219], v[88:91], v[176:179]
  ds_read_b64_tr_b16 v[212:213], v226 offset:8
  v_mfma_f32_16x16x32_bf16 v[184:187], v[216:219], v[92:95], v[184:187]
  ds_read_b64_tr_b16 v[214:215], v226 offset:1032
  v_mfma_f32_16x16x32_bf16 v[180:183], v[220:223], v[88:91], v[180:183]
  ds_read_b64_tr_b16 v[216:217], v227 offset:0
  v_mfma_f32_16x16x32_bf16 v[188:191], v[220:223], v[92:95], v[188:191]
  ds_read_b64_tr_b16 v[218:219], v227 offset:1024
  ds_read_b64_tr_b16 v[220:221], v227 offset:8
  ds_read_b64_tr_b16 v[222:223], v227 offset:1032
  ds_read_b128 v[96:99], v228 offset:8192
  ds_read_b128 v[100:103], v228 offset:12288
  ds_read_b128 v[104:107], v229 offset:8192
  ds_read_b128 v[108:111], v229 offset:12288
  ds_read_b128 v[112:115], v230 offset:8192
  ds_read_b128 v[116:119], v230 offset:12288
  ds_read_b128 v[120:123], v231 offset:8192
  ds_read_b128 v[124:127], v231 offset:12288
  s_waitcnt lgkmcnt(0)
  s_barrier
  v_mfma_f32_16x16x32_bf16 v[128:131], v[192:195], v[96:99], v[128:131]
  v_mfma_f32_16x16x32_bf16 v[136:139], v[192:195], v[100:103], v[136:139]
  v_mfma_f32_16x16x32_bf16 v[132:135], v[196:199], v[96:99], v[132:135]
  ds_read_b64_tr_b16 v[192:193], v224 offset:8192
  v_mfma_f32_16x16x32_bf16 v[140:143], v[196:199], v[100:103], v[140:143]
  ds_read_b64_tr_b16 v[194:195], v224 offset:9216
  v_mfma_f32_16x16x32_bf16 v[144:147], v[200:203], v[96:99], v[144:147]
  ds_read_b64_tr_b16 v[196:197], v224 offset:8200
  v_mfma_f32_16x16x32_bf16 v[152:155], v[200:203], v[100:103], v[152:155]
  ds_read_b64_tr_b16 v[198:199], v224 offset:9224
  v_mfma_f32_16x16x32_bf16 v[148:151], v[204:207], v[96:99], v[148:151]
  ds_read_b64_tr_b16 v[200:201], v225 offset:8192
  v_mfma_f32_16x16x32_bf16 v[156:159], v[204:207], v[100:103], v[156:159]
  ds_read_b64_tr_b16 v[202:203], v225 offset:9216
  v_mfma_f32_16x16x32_bf16 v[160:163], v[208:211], v[96:99], v[160:163]
  ds_read_b64_tr_b16 v[204:205], v225 offset:8200
  v_mfma_f32_16x16x32_bf16 v[168:171], v[208:211], v[100:103], v[168:171]
  ds_read_b64_tr_b16 v[206:207], v225 offset:9224
  v_mfma_f32_16x16x32_bf16 v[164:167], v[212:215], v[96:99], v[164:167]
  ds_read_b64_tr_b16 v[208:209], v226 offset:8192
  v_mfma_f32_16x16x32_bf16 v[172:175], v[212:215], v[100:103], v[172:175]
  ds_read_b64_tr_b16 v[210:211], v226 offset:9216
  v_mfma_f32_16x16x32_bf16 v[176:179], v[216:219], v[96:99], v[176:179]
  ds_read_b64_tr_b16 v[212:213], v226 offset:8200
  v_mfma_f32_16x16x32_bf16 v[184:187], v[216:219], v[100:103], v[184:187]
  ds_read_b64_tr_b16 v[214:215], v226 offset:9224
  v_mfma_f32_16x16x32_bf16 v[180:183], v[220:223], v[96:99], v[180:183]
  ds_read_b64_tr_b16 v[216:217], v227 offset:8192
  v_mfma_f32_16x16x32_bf16 v[188:191], v[220:223], v[100:103], v[188:191]
  ds_read_b64_tr_b16 v[218:219], v227 offset:9216
  ds_read_b64_tr_b16 v[220:221], v227 offset:8200
  ds_read_b64_tr_b16 v[222:223], v227 offset:9224
  s_waitcnt lgkmcnt(0)
  s_barrier
  v_mfma_f32_16x16x32_bf16 v[128:131], v[192:195], v[104:107], v[128:131]
  v_mfma_f32_16x16x32_bf16 v[136:139], v[192:195], v[108:111], v[136:139]
  v_mfma_f32_16x16x32_bf16 v[132:135], v[196:199], v[104:107], v[132:135]
  ds_read_b64_tr_b16 v[192:193], v224 offset:16384
  v_mfma_f32_16x16x32_bf16 v[140:143], v[196:199], v[108:111], v[140:143]
  ds_read_b64_tr_b16 v[194:195], v224 offset:17408
  v_mfma_f32_16x16x32_bf16 v[144:147], v[200:203], v[104:107], v[144:147]
  ds_read_b64_tr_b16 v[196:197], v224 offset:16392
  v_mfma_f32_16x16x32_bf16 v[152:155], v[200:203], v[108:111], v[152:155]
  ds_read_b64_tr_b16 v[198:199], v224 offset:17416
  v_mfma_f32_16x16x32_bf16 v[148:151], v[204:207], v[104:107], v[148:151]
  ds_read_b64_tr_b16 v[200:201], v225 offset:16384
  v_mfma_f32_16x16x32_bf16 v[156:159], v[204:207], v[108:111], v[156:159]
  ds_read_b64_tr_b16 v[202:203], v225 offset:17408
  v_mfma_f32_16x16x32_bf16 v[160:163], v[208:211], v[104:107], v[160:163]
  ds_read_b64_tr_b16 v[204:205], v225 offset:16392
  v_mfma_f32_16x16x32_bf16 v[168:171], v[208:211], v[108:111], v[168:171]
  ds_read_b64_tr_b16 v[206:207], v225 offset:17416
  v_mfma_f32_16x16x32_bf16 v[164:167], v[212:215], v[104:107], v[164:167]
  ds_read_b64_tr_b16 v[208:209], v226 offset:16384
  v_mfma_f32_16x16x32_bf16 v[172:175], v[212:215], v[108:111], v[172:175]
  ds_read_b64_tr_b16 v[210:211], v226 offset:17408
  v_mfma_f32_16x16x32_bf16 v[176:179], v[216:219], v[104:107], v[176:179]
  ds_read_b64_tr_b16 v[212:213], v226 offset:16392
  v_mfma_f32_16x16x32_bf16 v[184:187], v[216:219], v[108:111], v[184:187]
  ds_read_b64_tr_b16 v[214:215], v226 offset:17416
  v_mfma_f32_16x16x32_bf16 v[180:183], v[220:223], v[104:107], v[180:183]
  ds_read_b64_tr_b16 v[216:217], v227 offset:16384
  v_mfma_f32_16x16x32_bf16 v[188:191], v[220:223], v[108:111], v[188:191]
  ds_read_b64_tr_b16 v[218:219], v227 offset:17408
  ds_read_b64_tr_b16 v[220:221], v227 offset:16392
  ds_read_b64_tr_b16 v[222:223], v227 offset:17416
  s_waitcnt lgkmcnt(0)
  s_barrier
  v_mfma_f32_16x16x32_bf16 v[128:131], v[192:195], v[112:115], v[128:131]
  v_mfma_f32_16x16x32_bf16 v[136:139], v[192:195], v[116:119], v[136:139]
  v_mfma_f32_16x16x32_bf16 v[132:135], v[196:199], v[112:115], v[132:135]
  ds_read_b64_tr_b16 v[192:193], v224 offset:24576
  v_mfma_f32_16x16x32_bf16 v[140:143], v[196:199], v[116:119], v[140:143]
  ds_read_b64_tr_b16 v[194:195], v224 offset:25600
  v_mfma_f32_16x16x32_bf16 v[144:147], v[200:203], v[112:115], v[144:147]
  ds_read_b64_tr_b16 v[196:197], v224 offset:24584
  v_mfma_f32_16x16x32_bf16 v[152:155], v[200:203], v[116:119], v[152:155]
  ds_read_b64_tr_b16 v[198:199], v224 offset:25608
  v_mfma_f32_16x16x32_bf16 v[148:151], v[204:207], v[112:115], v[148:151]
  ds_read_b64_tr_b16 v[200:201], v225 offset:24576
  v_mfma_f32_16x16x32_bf16 v[156:159], v[204:207], v[116:119], v[156:159]
  ds_read_b64_tr_b16 v[202:203], v225 offset:25600
  v_mfma_f32_16x16x32_bf16 v[160:163], v[208:211], v[112:115], v[160:163]
  ds_read_b64_tr_b16 v[204:205], v225 offset:24584
  v_mfma_f32_16x16x32_bf16 v[168:171], v[208:211], v[116:119], v[168:171]
  ds_read_b64_tr_b16 v[206:207], v225 offset:25608
  v_mfma_f32_16x16x32_bf16 v[164:167], v[212:215], v[112:115], v[164:167]
  ds_read_b64_tr_b16 v[208:209], v226 offset:24576
  v_mfma_f32_16x16x32_bf16 v[172:175], v[212:215], v[116:119], v[172:175]
  ds_read_b64_tr_b16 v[210:211], v226 offset:25600
  v_mfma_f32_16x16x32_bf16 v[176:179], v[216:219], v[112:115], v[176:179]
  ds_read_b64_tr_b16 v[212:213], v226 offset:24584
  v_mfma_f32_16x16x32_bf16 v[184:187], v[216:219], v[116:119], v[184:187]
  ds_read_b64_tr_b16 v[214:215], v226 offset:25608
  v_mfma_f32_16x16x32_bf16 v[180:183], v[220:223], v[112:115], v[180:183]
  ds_read_b64_tr_b16 v[216:217], v227 offset:24576
  v_mfma_f32_16x16x32_bf16 v[188:191], v[220:223], v[116:119], v[188:191]
  ds_read_b64_tr_b16 v[218:219], v227 offset:25600
  ds_read_b64_tr_b16 v[220:221], v227 offset:24584
  ds_read_b64_tr_b16 v[222:223], v227 offset:25608
  s_waitcnt lgkmcnt(0)
  s_barrier
  v_mfma_f32_16x16x32_bf16 v[128:131], v[192:195], v[120:123], v[128:131]
  v_mfma_f32_16x16x32_bf16 v[136:139], v[192:195], v[124:127], v[136:139]
  v_mfma_f32_16x16x32_bf16 v[132:135], v[196:199], v[120:123], v[132:135]
  ds_read_b64_tr_b16 v[192:193], v224 offset:0
  v_mfma_f32_16x16x32_bf16 v[140:143], v[196:199], v[124:127], v[140:143]
  ds_read_b64_tr_b16 v[194:195], v224 offset:1024
  v_mfma_f32_16x16x32_bf16 v[144:147], v[200:203], v[120:123], v[144:147]
  ds_read_b64_tr_b16 v[196:197], v224 offset:8
  v_mfma_f32_16x16x32_bf16 v[152:155], v[200:203], v[124:127], v[152:155]
  ds_read_b64_tr_b16 v[198:199], v224 offset:1032
  v_mfma_f32_16x16x32_bf16 v[148:151], v[204:207], v[120:123], v[148:151]
  ds_read_b64_tr_b16 v[200:201], v225 offset:0
  v_mfma_f32_16x16x32_bf16 v[156:159], v[204:207], v[124:127], v[156:159]
  ds_read_b64_tr_b16 v[202:203], v225 offset:1024
  v_mfma_f32_16x16x32_bf16 v[160:163], v[208:211], v[120:123], v[160:163]
  ds_read_b64_tr_b16 v[204:205], v225 offset:8
  v_mfma_f32_16x16x32_bf16 v[168:171], v[208:211], v[124:127], v[168:171]
  ds_read_b64_tr_b16 v[206:207], v225 offset:1032
  v_mfma_f32_16x16x32_bf16 v[164:167], v[212:215], v[120:123], v[164:167]
  ds_read_b64_tr_b16 v[208:209], v226 offset:0
  v_mfma_f32_16x16x32_bf16 v[172:175], v[212:215], v[124:127], v[172:175]
  ds_read_b64_tr_b16 v[210:211], v226 offset:1024
  v_mfma_f32_16x16x32_bf16 v[176:179], v[216:219], v[120:123], v[176:179]
  ds_read_b64_tr_b16 v[212:213], v226 offset:8
  v_mfma_f32_16x16x32_bf16 v[184:187], v[216:219], v[124:127], v[184:187]
  ds_read_b64_tr_b16 v[214:215], v226 offset:1032
  v_mfma_f32_16x16x32_bf16 v[180:183], v[220:223], v[120:123], v[180:183]
  ds_read_b64_tr_b16 v[216:217], v227 offset:0
  v_mfma_f32_16x16x32_bf16 v[188:191], v[220:223], v[124:127], v[188:191]
  ds_read_b64_tr_b16 v[218:219], v227 offset:1024
  ds_read_b64_tr_b16 v[220:221], v227 offset:8
  ds_read_b64_tr_b16 v[222:223], v227 offset:1032
  s_waitcnt lgkmcnt(0)
  s_cmp_lt_u32 s51, 3
  s_cselect_b32 s49, 12, 8
  s_add_u32 s49, s49, s48
  s_lshl_b32 s49, s49, 13
  v_add_u32 v242, s49, v240
  s_nop 3
  v_pk_mul_f32 v[128:129], v[128:129], s[56:57]
  v_pk_mul_f32 v[130:131], v[130:131], s[56:57]
  v_pk_mul_f32 v[132:133], v[132:133], s[56:57]
  v_pk_mul_f32 v[134:135], v[134:135], s[56:57]
  v_cvt_pk_bf16_f32 v128, v128, v129
  v_cvt_pk_bf16_f32 v129, v130, v131
  v_cvt_pk_bf16_f32 v130, v132, v133
  v_cvt_pk_bf16_f32 v131, v134, v135
  ds_write_b128 v242, v[128:131] offset:0
  v_pk_mul_f32 v[136:137], v[136:137], s[56:57]
  v_pk_mul_f32 v[138:139], v[138:139], s[56:57]
  v_pk_mul_f32 v[140:141], v[140:141], s[56:57]
  v_pk_mul_f32 v[142:143], v[142:143], s[56:57]
  v_cvt_pk_bf16_f32 v132, v136, v137
  v_cvt_pk_bf16_f32 v133, v138, v139
  v_cvt_pk_bf16_f32 v134, v140, v141
  v_cvt_pk_bf16_f32 v135, v142, v143
  ds_write_b128 v242, v[132:135] offset:1024
  v_pk_mul_f32 v[144:145], v[144:145], s[56:57]
  v_pk_mul_f32 v[146:147], v[146:147], s[56:57]
  v_pk_mul_f32 v[148:149], v[148:149], s[56:57]
  v_pk_mul_f32 v[150:151], v[150:151], s[56:57]
  v_cvt_pk_bf16_f32 v136, v144, v145
  v_cvt_pk_bf16_f32 v137, v146, v147
  v_cvt_pk_bf16_f32 v138, v148, v149
  v_cvt_pk_bf16_f32 v139, v150, v151
  ds_write_b128 v242, v[136:139] offset:2048
  v_pk_mul_f32 v[152:153], v[152:153], s[56:57]
  v_pk_mul_f32 v[154:155], v[154:155], s[56:57]
  v_pk_mul_f32 v[156:157], v[156:157], s[56:57]
  v_pk_mul_f32 v[158:159], v[158:159], s[56:57]
  v_cvt_pk_bf16_f32 v140, v152, v153
  v_cvt_pk_bf16_f32 v141, v154, v155
  v_cvt_pk_bf16_f32 v142, v156, v157
  v_cvt_pk_bf16_f32 v143, v158, v159
  ds_write_b128 v242, v[140:143] offset:3072
  v_pk_mul_f32 v[160:161], v[160:161], s[56:57]
  v_pk_mul_f32 v[162:163], v[162:163], s[56:57]
  v_pk_mul_f32 v[164:165], v[164:165], s[56:57]
  v_pk_mul_f32 v[166:167], v[166:167], s[56:57]
  v_cvt_pk_bf16_f32 v144, v160, v161
  v_cvt_pk_bf16_f32 v145, v162, v163
  v_cvt_pk_bf16_f32 v146, v164, v165
  v_cvt_pk_bf16_f32 v147, v166, v167
  ds_write_b128 v242, v[144:147] offset:4096
  v_pk_mul_f32 v[168:169], v[168:169], s[56:57]
  v_pk_mul_f32 v[170:171], v[170:171], s[56:57]
  v_pk_mul_f32 v[172:173], v[172:173], s[56:57]
  v_pk_mul_f32 v[174:175], v[174:175], s[56:57]
  v_cvt_pk_bf16_f32 v148, v168, v169
  v_cvt_pk_bf16_f32 v149, v170, v171
  v_cvt_pk_bf16_f32 v150, v172, v173
  v_cvt_pk_bf16_f32 v151, v174, v175
  ds_write_b128 v242, v[148:151] offset:5120
  v_pk_mul_f32 v[176:177], v[176:177], s[56:57]
  v_pk_mul_f32 v[178:179], v[178:179], s[56:57]
  v_pk_mul_f32 v[180:181], v[180:181], s[56:57]
  v_pk_mul_f32 v[182:183], v[182:183], s[56:57]
  v_cvt_pk_bf16_f32 v152, v176, v177
  v_cvt_pk_bf16_f32 v153, v178, v179
  v_cvt_pk_bf16_f32 v154, v180, v181
  v_cvt_pk_bf16_f32 v155, v182, v183
  ds_write_b128 v242, v[152:155] offset:6144
  v_pk_mul_f32 v[184:185], v[184:185], s[56:57]
  v_pk_mul_f32 v[186:187], v[186:187], s[56:57]
  v_pk_mul_f32 v[188:189], v[188:189], s[56:57]
  v_pk_mul_f32 v[190:191], v[190:191], s[56:57]
  v_cvt_pk_bf16_f32 v156, v184, v185
  v_cvt_pk_bf16_f32 v157, v186, v187
  v_cvt_pk_bf16_f32 v158, v188, v189
  v_cvt_pk_bf16_f32 v159, v190, v191
  ds_write_b128 v242, v[156:159] offset:7168
  s_waitcnt lgkmcnt(0)
  s_mov_b32 s51, 1
L_G_unit:
  s_barrier
  v_mfma_f32_16x16x32_bf16 v[128:131], v[192:195], v[0:3], 0
  v_mfma_f32_16x16x32_bf16 v[136:139], v[192:195], v[4:7], 0
  v_mfma_f32_16x16x32_bf16 v[132:135], v[196:199], v[0:3], 0
  ds_read_b64_tr_b16 v[192:193], v224 offset:8192
  v_mfma_f32_16x16x32_bf16 v[140:143], v[196:199], v[4:7], 0
  ds_read_b64_tr_b16 v[194:195], v224 offset:9216
  v_mfma_f32_16x16x32_bf16 v[144:147], v[200:203], v[0:3], 0
  ds_read_b64_tr_b16 v[196:197], v224 offset:8200
  v_mfma_f32_16x16x32_bf16 v[152:155], v[200:203], v[4:7], 0
  ds_read_b64_tr_b16 v[198:199], v224 offset:9224
  v_mfma_f32_16x16x32_bf16 v[148:151], v[204:207], v[0:3], 0
  ds_read_b64_tr_b16 v[200:201], v225 offset:8192
  v_mfma_f32_16x16x32_bf16 v[156:159], v[204:207], v[4:7], 0
  ds_read_b64_tr_b16 v[202:203], v225 offset:9216
  v_mfma_f32_16x16x32_bf16 v[160:163], v[208:211], v[0:3], 0
  ds_read_b64_tr_b16 v[204:205], v225 offset:8200
  v_mfma_f32_16x16x32_bf16 v[168:171], v[208:211], v[4:7], 0
  ds_read_b64_tr_b16 v[206:207], v225 offset:9224
  v_mfma_f32_16x16x32_bf16 v[164:167], v[212:215], v[0:3], 0
  ds_read_b64_tr_b16 v[208:209], v226 offset:8192
  v_mfma_f32_16x16x32_bf16 v[172:175], v[212:215], v[4:7], 0
  ds_read_b64_tr_b16 v[210:211], v226 offset:9216
  v_mfma_f32_16x16x32_bf16 v[176:179], v[216:219], v[0:3], 0
  ds_read_b64_tr_b16 v[212:213], v226 offset:8200
  v_mfma_f32_16x16x32_bf16 v[184:187], v[216:219], v[4:7], 0
  ds_read_b64_tr_b16 v[214:215], v226 offset:9224
  v_mfma_f32_16x16x32_bf16 v[180:183], v[220:223], v[0:3], 0
  ds_read_b64_tr_b16 v[216:217], v227 offset:8192
  v_mfma_f32_16x16x32_bf16 v[188:191], v[220:223], v[4:7], 0
  ds_read_b64_tr_b16 v[218:219], v227 offset:9216
  ds_read_b64_tr_b16 v[220:221], v227 offset:8200
  ds_read_b64_tr_b16 v[222:223], v227 offset:9224
  s_waitcnt lgkmcnt(0)
  s_barrier
  v_mfma_f32_16x16x32_bf16 v[128:131], v[192:195], v[8:11], v[128:131]
  v_mfma_f32_16x16x32_bf16 v[136:139], v[192:195], v[12:15], v[136:139]
  v_mfma_f32_16x16x32_bf16 v[132:135], v[196:199], v[8:11], v[132:135]
  ds_read_b64_tr_b16 v[192:193], v224 offset:16384
  v_mfma_f32_16x16x32_bf16 v[140:143], v[196:199], v[12:15], v[140:143]
  ds_read_b64_tr_b16 v[194:195], v224 offset:17408
  v_mfma_f32_16x16x32_bf16 v[144:147], v[200:203], v[8:11], v[144:147]
  ds_read_b64_tr_b16 v[196:197], v224 offset:16392
  v_mfma_f32_16x16x32_bf16 v[152:155], v[200:203], v[12:15], v[152:155]
  ds_read_b64_tr_b16 v[198:199], v224 offset:17416
  v_mfma_f32_16x16x32_bf16 v[148:151], v[204:207], v[8:11], v[148:151]
  ds_read_b64_tr_b16 v[200:201], v225 offset:16384
  v_mfma_f32_16x16x32_bf16 v[156:159], v[204:207], v[12:15], v[156:159]
  ds_read_b64_tr_b16 v[202:203], v225 offset:17408
  v_mfma_f32_16x16x32_bf16 v[160:163], v[208:211], v[8:11], v[160:163]
  ds_read_b64_tr_b16 v[204:205], v225 offset:16392
  v_mfma_f32_16x16x32_bf16 v[168:171], v[208:211], v[12:15], v[168:171]
  ds_read_b64_tr_b16 v[206:207], v225 offset:17416
  v_mfma_f32_16x16x32_bf16 v[164:167], v[212:215], v[8:11], v[164:167]
  ds_read_b64_tr_b16 v[208:209], v226 offset:16384
  v_mfma_f32_16x16x32_bf16 v[172:175], v[212:215], v[12:15], v[172:175]
  ds_read_b64_tr_b16 v[210:211], v226 offset:17408
  v_mfma_f32_16x16x32_bf16 v[176:179], v[216:219], v[8:11], v[176:179]
  ds_read_b64_tr_b16 v[212:213], v226 offset:16392
  v_mfma_f32_16x16x32_bf16 v[184:187], v[216:219], v[12:15], v[184:187]
  ds_read_b64_tr_b16 v[214:215], v226 offset:17416
  v_mfma_f32_16x16x32_bf16 v[180:183], v[220:223], v[8:11], v[180:183]
  ds_read_b64_tr_b16 v[216:217], v227 offset:16384
  v_mfma_f32_16x16x32_bf16 v[188:191], v[220:223], v[12:15], v[188:191]
  ds_read_b64_tr_b16 v[218:219], v227 offset:17408
  ds_read_b64_tr_b16 v[220:221], v227 offset:16392
  ds_read_b64_tr_b16 v[222:223], v227 offset:17416
  s_waitcnt lgkmcnt(0)
  s_barrier
  v_mfma_f32_16x16x32_bf16 v[128:131], v[192:195], v[16:19], v[128:131]
  v_mfma_f32_16x16x32_bf16 v[136:139], v[192:195], v[20:23], v[136:139]
  v_mfma_f32_16x16x32_bf16 v[132:135], v[196:199], v[16:19], v[132:135]
  ds_read_b64_tr_b16 v[192:193], v224 offset:24576
  v_mfma_f32_16x16x32_bf16 v[140:143], v[196:199], v[20:23], v[140:143]
  ds_read_b64_tr_b16 v[194:195], v224 offset:25600
  v_mfma_f32_16x16x32_bf16 v[144:147], v[200:203], v[16:19], v[144:147]
  ds_read_b64_tr_b16 v[196:197], v224 offset:24584
  v_mfma_f32_16x16x32_bf16 v[152:155], v[200:203], v[20:23], v[152:155]
  ds_read_b64_tr_b16 v[198:199], v224 offset:25608
  v_mfma_f32_16x16x32_bf16 v[148:151], v[204:207], v[16:19], v[148:151]
  ds_read_b64_tr_b16 v[200:201], v225 offset:24576
  v_mfma_f32_16x16x32_bf16 v[156:159], v[204:207], v[20:23], v[156:159]
  ds_read_b64_tr_b16 v[202:203], v225 offset:25600
  v_mfma_f32_16x16x32_bf16 v[160:163], v[208:211], v[16:19], v[160:163]
  ds_read_b64_tr_b16 v[204:205], v225 offset:24584
  v_mfma_f32_16x16x32_bf16 v[168:171], v[208:211], v[20:23], v[168:171]
  ds_read_b64_tr_b16 v[206:207], v225 offset:25608
  v_mfma_f32_16x16x32_bf16 v[164:167], v[212:215], v[16:19], v[164:167]
  ds_read_b64_tr_b16 v[208:209], v226 offset:24576
  v_mfma_f32_16x16x32_bf16 v[172:175], v[212:215], v[20:23], v[172:175]
  ds_read_b64_tr_b16 v[210:211], v226 offset:25600
  v_mfma_f32_16x16x32_bf16 v[176:179], v[216:219], v[16:19], v[176:179]
  ds_read_b64_tr_b16 v[212:213], v226 offset:24584
  v_mfma_f32_16x16x32_bf16 v[184:187], v[216:219], v[20:23], v[184:187]
  ds_read_b64_tr_b16 v[214:215], v226 offset:25608
  v_mfma_f32_16x16x32_bf16 v[180:183], v[220:223], v[16:19], v[180:183]
  ds_read_b64_tr_b16 v[216:217], v227 offset:24576
  v_mfma_f32_16x16x32_bf16 v[188:191], v[220:223], v[20:23], v[188:191]
  ds_read_b64_tr_b16 v[218:219], v227 offset:25600
  ds_read_b64_tr_b16 v[220:221], v227 offset:24584
  ds_read_b64_tr_b16 v[222:223], v227 offset:25608
  s_waitcnt lgkmcnt(0)
  s_barrier
  v_mfma_f32_16x16x32_bf16 v[128:131], v[192:195], v[24:27], v[128:131]
  v_mfma_f32_16x16x32_bf16 v[136:139], v[192:195], v[28:31], v[136:139]
  v_mfma_f32_16x16x32_bf16 v[132:135], v[196:199], v[24:27], v[132:135]
  ds_read_b64_tr_b16 v[192:193], v224 offset:0
  v_mfma_f32_16x16x32_bf16 v[140:143], v[196:199], v[28:31], v[140:143]
  ds_read_b64_tr_b16 v[194:195], v224 offset:1024
  v_mfma_f32_16x16x32_bf16 v[144:147], v[200:203], v[24:27], v[144:147]
  ds_read_b64_tr_b16 v[196:197], v224 offset:8
  v_mfma_f32_16x16x32_bf16 v[152:155], v[200:203], v[28:31], v[152:155]
  ds_read_b64_tr_b16 v[198:199], v224 offset:1032
  v_mfma_f32_16x16x32_bf16 v[148:151], v[204:207], v[24:27], v[148:151]
  ds_read_b64_tr_b16 v[200:201], v225 offset:0
  v_mfma_f32_16x16x32_bf16 v[156:159], v[204:207], v[28:31], v[156:159]
  ds_read_b64_tr_b16 v[202:203], v225 offset:1024
  v_mfma_f32_16x16x32_bf16 v[160:163], v[208:211], v[24:27], v[160:163]
  ds_read_b64_tr_b16 v[204:205], v225 offset:8
  v_mfma_f32_16x16x32_bf16 v[168:171], v[208:211], v[28:31], v[168:171]
  ds_read_b64_tr_b16 v[206:207], v225 offset:1032
  v_mfma_f32_16x16x32_bf16 v[164:167], v[212:215], v[24:27], v[164:167]
  ds_read_b64_tr_b16 v[208:209], v226 offset:0
  v_mfma_f32_16x16x32_bf16 v[172:175], v[212:215], v[28:31], v[172:175]
  ds_read_b64_tr_b16 v[210:211], v226 offset:1024
  v_mfma_f32_16x16x32_bf16 v[176:179], v[216:219], v[24:27], v[176:179]
  ds_read_b64_tr_b16 v[212:213], v226 offset:8
  v_mfma_f32_16x16x32_bf16 v[184:187], v[216:219], v[28:31], v[184:187]
  ds_read_b64_tr_b16 v[214:215], v226 offset:1032
  v_mfma_f32_16x16x32_bf16 v[180:183], v[220:223], v[24:27], v[180:183]
  ds_read_b64_tr_b16 v[216:217], v227 offset:0
  v_mfma_f32_16x16x32_bf16 v[188:191], v[220:223], v[28:31], v[188:191]
  ds_read_b64_tr_b16 v[218:219], v227 offset:1024
  ds_read_b64_tr_b16 v[220:221], v227 offset:8
  ds_read_b64_tr_b16 v[222:223], v227 offset:1032
  s_waitcnt lgkmcnt(0)
  s_barrier
  v_mfma_f32_16x16x32_bf16 v[128:131], v[192:195], v[32:35], v[128:131]
  v_mfma_f32_16x16x32_bf16 v[136:139], v[192:195], v[36:39], v[136:139]
  v_mfma_f32_16x16x32_bf16 v[132:135], v[196:199], v[32:35], v[132:135]
  ds_read_b64_tr_b16 v[192:193], v224 offset:8192
  v_mfma_f32_16x16x32_bf16 v[140:143], v[196:199], v[36:39], v[140:143]
  ds_read_b64_tr_b16 v[194:195], v224 offset:9216
  v_mfma_f32_16x16x32_bf16 v[144:147], v[200:203], v[32:35], v[144:147]
  ds_read_b64_tr_b16 v[196:197], v224 offset:8200
  v_mfma_f32_16x16x32_bf16 v[152:155], v[200:203], v[36:39], v[152:155]
  ds_read_b64_tr_b16 v[198:199], v224 offset:9224
  v_mfma_f32_16x16x32_bf16 v[148:151], v[204:207], v[32:35], v[148:151]
  ds_read_b64_tr_b16 v[200:201], v225 offset:8192
  v_mfma_f32_16x16x32_bf16 v[156:159], v[204:207], v[36:39], v[156:159]
  ds_read_b64_tr_b16 v[202:203], v225 offset:9216
  v_mfma_f32_16x16x32_bf16 v[160:163], v[208:211], v[32:35], v[160:163]
  ds_read_b64_tr_b16 v[204:205], v225 offset:8200
  v_mfma_f32_16x16x32_bf16 v[168:171], v[208:211], v[36:39], v[168:171]
  ds_read_b64_tr_b16 v[206:207], v225 offset:9224
  v_mfma_f32_16x16x32_bf16 v[164:167], v[212:215], v[32:35], v[164:167]
  ds_read_b64_tr_b16 v[208:209], v226 offset:8192
  v_mfma_f32_16x16x32_bf16 v[172:175], v[212:215], v[36:39], v[172:175]
  ds_read_b64_tr_b16 v[210:211], v226 offset:9216
  v_mfma_f32_16x16x32_bf16 v[176:179], v[216:219], v[32:35], v[176:179]
  ds_read_b64_tr_b16 v[212:213], v226 offset:8200
  v_mfma_f32_16x16x32_bf16 v[184:187], v[216:219], v[36:39], v[184:187]
  ds_read_b64_tr_b16 v[214:215], v226 offset:9224
  v_mfma_f32_16x16x32_bf16 v[180:183], v[220:223], v[32:35], v[180:183]
  ds_read_b64_tr_b16 v[216:217], v227 offset:8192
  v_mfma_f32_16x16x32_bf16 v[188:191], v[220:223], v[36:39], v[188:191]
  ds_read_b64_tr_b16 v[218:219], v227 offset:9216
  ds_read_b64_tr_b16 v[220:221], v227 offset:8200
  ds_read_b64_tr_b16 v[222:223], v227 offset:9224
  s_waitcnt lgkmcnt(0)
  s_barrier
  v_mfma_f32_16x16x32_bf16 v[128:131], v[192:195], v[40:43], v[128:131]
  v_mfma_f32_16x16x32_bf16 v[136:139], v[192:195], v[44:47], v[136:139]
  v_mfma_f32_16x16x32_bf16 v[132:135], v[196:199], v[40:43], v[132:135]
  ds_read_b64_tr_b16 v[192:193], v224 offset:16384
  v_mfma_f32_16x16x32_bf16 v[140:143], v[196:199], v[44:47], v[140:143]
  ds_read_b64_tr_b16 v[194:195], v224 offset:17408
  v_mfma_f32_16x16x32_bf16 v[144:147], v[200:203], v[40:43], v[144:147]
  ds_read_b64_tr_b16 v[196:197], v224 offset:16392
  v_mfma_f32_16x16x32_bf16 v[152:155], v[200:203], v[44:47], v[152:155]
  ds_read_b64_tr_b16 v[198:199], v224 offset:17416
  v_mfma_f32_16x16x32_bf16 v[148:151], v[204:207], v[40:43], v[148:151]
  ds_read_b64_tr_b16 v[200:201], v225 offset:16384
  v_mfma_f32_16x16x32_bf16 v[156:159], v[204:207], v[44:47], v[156:159]
  ds_read_b64_tr_b16 v[202:203], v225 offset:17408
  v_mfma_f32_16x16x32_bf16 v[160:163], v[208:211], v[40:43], v[160:163]
  ds_read_b64_tr_b16 v[204:205], v225 offset:16392
  v_mfma_f32_16x16x32_bf16 v[168:171], v[208:211], v[44:47], v[168:171]
  ds_read_b64_tr_b16 v[206:207], v225 offset:17416
  v_mfma_f32_16x16x32_bf16 v[164:167], v[212:215], v[40:43], v[164:167]
  ds_read_b64_tr_b16 v[208:209], v226 offset:16384
  v_mfma_f32_16x16x32_bf16 v[172:175], v[212:215], v[44:47], v[172:175]
  ds_read_b64_tr_b16 v[210:211], v226 offset:17408
  v_mfma_f32_16x16x32_bf16 v[176:179], v[216:219], v[40:43], v[176:179]
  ds_read_b64_tr_b16 v[212:213], v226 offset:16392
  v_mfma_f32_16x16x32_bf16 v[184:187], v[216:219], v[44:47], v[184:187]
  ds_read_b64_tr_b16 v[214:215], v226 offset:17416
  v_mfma_f32_16x16x32_bf16 v[180:183], v[220:223], v[40:43], v[180:183]
  ds_read_b64_tr_b16 v[216:217], v227 offset:16384
  v_mfma_f32_16x16x32_bf16 v[188:191], v[220:223], v[44:47], v[188:191]
  ds_read_b64_tr_b16 v[218:219], v227 offset:17408
  ds_read_b64_tr_b16 v[220:221], v227 offset:16392
  ds_read_b64_tr_b16 v[222:223], v227 offset:17416
  s_waitcnt lgkmcnt(0)
  s_barrier
  v_mfma_f32_16x16x32_bf16 v[128:131], v[192:195], v[48:51], v[128:131]
  v_mfma_f32_16x16x32_bf16 v[136:139], v[192:195], v[52:55], v[136:139]
  v_mfma_f32_16x16x32_bf16 v[132:135], v[196:199], v[48:51], v[132:135]
  ds_read_b64_tr_b16 v[192:193], v224 offset:24576
  v_mfma_f32_16x16x32_bf16 v[140:143], v[196:199], v[52:55], v[140:143]
  ds_read_b64_tr_b16 v[194:195], v224 offset:25600
  v_mfma_f32_16x16x32_bf16 v[144:147], v[200:203], v[48:51], v[144:147]
  ds_read_b64_tr_b16 v[196:197], v224 offset:24584
  v_mfma_f32_16x16x32_bf16 v[152:155], v[200:203], v[52:55], v[152:155]
  ds_read_b64_tr_b16 v[198:199], v224 offset:25608
  v_mfma_f32_16x16x32_bf16 v[148:151], v[204:207], v[48:51], v[148:151]
  ds_read_b64_tr_b16 v[200:201], v225 offset:24576
  v_mfma_f32_16x16x32_bf16 v[156:159], v[204:207], v[52:55], v[156:159]
  ds_read_b64_tr_b16 v[202:203], v225 offset:25600
  v_mfma_f32_16x16x32_bf16 v[160:163], v[208:211], v[48:51], v[160:163]
  ds_read_b64_tr_b16 v[204:205], v225 offset:24584
  v_mfma_f32_16x16x32_bf16 v[168:171], v[208:211], v[52:55], v[168:171]
  ds_read_b64_tr_b16 v[206:207], v225 offset:25608
  v_mfma_f32_16x16x32_bf16 v[164:167], v[212:215], v[48:51], v[164:167]
  ds_read_b64_tr_b16 v[208:209], v226 offset:24576
  v_mfma_f32_16x16x32_bf16 v[172:175], v[212:215], v[52:55], v[172:175]
  ds_read_b64_tr_b16 v[210:211], v226 offset:25600
  v_mfma_f32_16x16x32_bf16 v[176:179], v[216:219], v[48:51], v[176:179]
  ds_read_b64_tr_b16 v[212:213], v226 offset:24584
  v_mfma_f32_16x16x32_bf16 v[184:187], v[216:219], v[52:55], v[184:187]
  ds_read_b64_tr_b16 v[214:215], v226 offset:25608
  v_mfma_f32_16x16x32_bf16 v[180:183], v[220:223], v[48:51], v[180:183]
  ds_read_b64_tr_b16 v[216:217], v227 offset:24576
  v_mfma_f32_16x16x32_bf16 v[188:191], v[220:223], v[52:55], v[188:191]
  ds_read_b64_tr_b16 v[218:219], v227 offset:25600
  ds_read_b64_tr_b16 v[220:221], v227 offset:24584
  ds_read_b64_tr_b16 v[222:223], v227 offset:25608
  s_waitcnt lgkmcnt(0)
  s_barrier
  v_mfma_f32_16x16x32_bf16 v[128:131], v[192:195], v[56:59], v[128:131]
  v_mfma_f32_16x16x32_bf16 v[136:139], v[192:195], v[60:63], v[136:139]
  v_mfma_f32_16x16x32_bf16 v[132:135], v[196:199], v[56:59], v[132:135]
  ds_read_b64_tr_b16 v[192:193], v224 offset:0
  v_mfma_f32_16x16x32_bf16 v[140:143], v[196:199], v[60:63], v[140:143]
  ds_read_b64_tr_b16 v[194:195], v224 offset:1024
  v_mfma_f32_16x16x32_bf16 v[144:147], v[200:203], v[56:59], v[144:147]
  ds_read_b64_tr_b16 v[196:197], v224 offset:8
  v_mfma_f32_16x16x32_bf16 v[152:155], v[200:203], v[60:63], v[152:155]
  ds_read_b64_tr_b16 v[198:199], v224 offset:1032
  v_mfma_f32_16x16x32_bf16 v[148:151], v[204:207], v[56:59], v[148:151]
  ds_read_b64_tr_b16 v[200:201], v225 offset:0
  v_mfma_f32_16x16x32_bf16 v[156:159], v[204:207], v[60:63], v[156:159]
  ds_read_b64_tr_b16 v[202:203], v225 offset:1024
  v_mfma_f32_16x16x32_bf16 v[160:163], v[208:211], v[56:59], v[160:163]
  ds_read_b64_tr_b16 v[204:205], v225 offset:8
  v_mfma_f32_16x16x32_bf16 v[168:171], v[208:211], v[60:63], v[168:171]
  ds_read_b64_tr_b16 v[206:207], v225 offset:1032
  v_mfma_f32_16x16x32_bf16 v[164:167], v[212:215], v[56:59], v[164:167]
  ds_read_b64_tr_b16 v[208:209], v226 offset:0
  v_mfma_f32_16x16x32_bf16 v[172:175], v[212:215], v[60:63], v[172:175]
  ds_read_b64_tr_b16 v[210:211], v226 offset:1024
  v_mfma_f32_16x16x32_bf16 v[176:179], v[216:219], v[56:59], v[176:179]
  ds_read_b64_tr_b16 v[212:213], v226 offset:8
  v_mfma_f32_16x16x32_bf16 v[184:187], v[216:219], v[60:63], v[184:187]
  ds_read_b64_tr_b16 v[214:215], v226 offset:1032
  v_mfma_f32_16x16x32_bf16 v[180:183], v[220:223], v[56:59], v[180:183]
  ds_read_b64_tr_b16 v[216:217], v227 offset:0
  v_mfma_f32_16x16x32_bf16 v[188:191], v[220:223], v[60:63], v[188:191]
  ds_read_b64_tr_b16 v[218:219], v227 offset:1024
  ds_read_b64_tr_b16 v[220:221], v227 offset:8
  ds_read_b64_tr_b16 v[222:223], v227 offset:1032
  s_waitcnt lgkmcnt(0)
  s_barrier
  v_mfma_f32_16x16x32_bf16 v[128:131], v[192:195], v[64:67], v[128:131]
  v_mfma_f32_16x16x32_bf16 v[136:139], v[192:195], v[68:71], v[136:139]
  v_mfma_f32_16x16x32_bf16 v[132:135], v[196:199], v[64:67], v[132:135]
  ds_read_b64_tr_b16 v[192:193], v224 offset:8192
  v_mfma_f32_16x16x32_bf16 v[140:143], v[196:199], v[68:71], v[140:143]
  ds_read_b64_tr_b16 v[194:195], v224 offset:9216
  v_mfma_f32_16x16x32_bf16 v[144:147], v[200:203], v[64:67], v[144:147]
  ds_read_b64_tr_b16 v[196:197], v224 offset:8200
  v_mfma_f32_16x16x32_bf16 v[152:155], v[200:203], v[68:71], v[152:155]
  ds_read_b64_tr_b16 v[198:199], v224 offset:9224
  v_mfma_f32_16x16x32_bf16 v[148:151], v[204:207], v[64:67], v[148:151]
  ds_read_b64_tr_b16 v[200:201], v225 offset:8192
  v_mfma_f32_16x16x32_bf16 v[156:159], v[204:207], v[68:71], v[156:159]
  ds_read_b64_tr_b16 v[202:203], v225 offset:9216
  v_mfma_f32_16x16x32_bf16 v[160:163], v[208:211], v[64:67], v[160:163]
  ds_read_b64_tr_b16 v[204:205], v225 offset:8200
  v_mfma_f32_16x16x32_bf16 v[168:171], v[208:211], v[68:71], v[168:171]
  ds_read_b64_tr_b16 v[206:207], v225 offset:9224
  v_mfma_f32_16x16x32_bf16 v[164:167], v[212:215], v[64:67], v[164:167]
  ds_read_b64_tr_b16 v[208:209], v226 offset:8192
  v_mfma_f32_16x16x32_bf16 v[172:175], v[212:215], v[68:71], v[172:175]
  ds_read_b64_tr_b16 v[210:211], v226 offset:9216
  v_mfma_f32_16x16x32_bf16 v[176:179], v[216:219], v[64:67], v[176:179]
  ds_read_b64_tr_b16 v[212:213], v226 offset:8200
  v_mfma_f32_16x16x32_bf16 v[184:187], v[216:219], v[68:71], v[184:187]
  ds_read_b64_tr_b16 v[214:215], v226 offset:9224
  v_mfma_f32_16x16x32_bf16 v[180:183], v[220:223], v[64:67], v[180:183]
  ds_read_b64_tr_b16 v[216:217], v227 offset:8192
  v_mfma_f32_16x16x32_bf16 v[188:191], v[220:223], v[68:71], v[188:191]
  ds_read_b64_tr_b16 v[218:219], v227 offset:9216
  ds_read_b64_tr_b16 v[220:221], v227 offset:8200
  ds_read_b64_tr_b16 v[222:223], v227 offset:9224
  s_waitcnt lgkmcnt(0)
  s_barrier
  v_mfma_f32_16x16x32_bf16 v[128:131], v[192:195], v[72:75], v[128:131]
  v_mfma_f32_16x16x32_bf16 v[136:139], v[192:195], v[76:79], v[136:139]
  v_mfma_f32_16x16x32_bf16 v[132:135], v[196:199], v[72:75], v[132:135]
  ds_read_b64_tr_b16 v[192:193], v224 offset:16384
  v_mfma_f32_16x16x32_bf16 v[140:143], v[196:199], v[76:79], v[140:143]
  ds_read_b64_tr_b16 v[194:195], v224 offset:17408
  v_mfma_f32_16x16x32_bf16 v[144:147], v[200:203], v[72:75], v[144:147]
  ds_read_b64_tr_b16 v[196:197], v224 offset:16392
  v_mfma_f32_16x16x32_bf16 v[152:155], v[200:203], v[76:79], v[152:155]
  ds_read_b64_tr_b16 v[198:199], v224 offset:17416
  v_mfma_f32_16x16x32_bf16 v[148:151], v[204:207], v[72:75], v[148:151]
  ds_read_b64_tr_b16 v[200:201], v225 offset:16384
  v_mfma_f32_16x16x32_bf16 v[156:159], v[204:207], v[76:79], v[156:159]
  ds_read_b64_tr_b16 v[202:203], v225 offset:17408
  v_mfma_f32_16x16x32_bf16 v[160:163], v[208:211], v[72:75], v[160:163]
  ds_read_b64_tr_b16 v[204:205], v225 offset:16392
  v_mfma_f32_16x16x32_bf16 v[168:171], v[208:211], v[76:79], v[168:171]
  ds_read_b64_tr_b16 v[206:207], v225 offset:17416
  v_mfma_f32_16x16x32_bf16 v[164:167], v[212:215], v[72:75], v[164:167]
  ds_read_b64_tr_b16 v[208:209], v226 offset:16384
  v_mfma_f32_16x16x32_bf16 v[172:175], v[212:215], v[76:79], v[172:175]
  ds_read_b64_tr_b16 v[210:211], v226 offset:17408
  v_mfma_f32_16x16x32_bf16 v[176:179], v[216:219], v[72:75], v[176:179]
  ds_read_b64_tr_b16 v[212:213], v226 offset:16392
  v_mfma_f32_16x16x32_bf16 v[184:187], v[216:219], v[76:79], v[184:187]
  ds_read_b64_tr_b16 v[214:215], v226 offset:17416
  v_mfma_f32_16x16x32_bf16 v[180:183], v[220:223], v[72:75], v[180:183]
  ds_read_b64_tr_b16 v[216:217], v227 offset:16384
  v_mfma_f32_16x16x32_bf16 v[188:191], v[220:223], v[76:79], v[188:191]
  ds_read_b64_tr_b16 v[218:219], v227 offset:17408
  ds_read_b64_tr_b16 v[220:221], v227 offset:16392
  ds_read_b64_tr_b16 v[222:223], v227 offset:17416
  s_waitcnt lgkmcnt(0)
  s_barrier
  v_mfma_f32_16x16x32_bf16 v[128:131], v[192:195], v[80:83], v[128:131]
  v_mfma_f32_16x16x32_bf16 v[136:139], v[192:195], v[84:87], v[136:139]
  v_mfma_f32_16x16x32_bf16 v[132:135], v[196:199], v[80:83], v[132:135]
  ds_read_b64_tr_b16 v[192:193], v224 offset:24576
  v_mfma_f32_16x16x32_bf16 v[140:143], v[196:199], v[84:87], v[140:143]
  ds_read_b64_tr_b16 v[194:195], v224 offset:25600
  v_mfma_f32_16x16x32_bf16 v[144:147], v[200:203], v[80:83], v[144:147]
  ds_read_b64_tr_b16 v[196:197], v224 offset:24584
  v_mfma_f32_16x16x32_bf16 v[152:155], v[200:203], v[84:87], v[152:155]
  ds_read_b64_tr_b16 v[198:199], v224 offset:25608
  v_mfma_f32_16x16x32_bf16 v[148:151], v[204:207], v[80:83], v[148:151]
  ds_read_b64_tr_b16 v[200:201], v225 offset:24576
  v_mfma_f32_16x16x32_bf16 v[156:159], v[204:207], v[84:87], v[156:159]
  ds_read_b64_tr_b16 v[202:203], v225 offset:25600
  v_mfma_f32_16x16x32_bf16 v[160:163], v[208:211], v[80:83], v[160:163]
  ds_read_b64_tr_b16 v[204:205], v225 offset:24584
  v_mfma_f32_16x16x32_bf16 v[168:171], v[208:211], v[84:87], v[168:171]
  ds_read_b64_tr_b16 v[206:207], v225 offset:25608
  v_mfma_f32_16x16x32_bf16 v[164:167], v[212:215], v[80:83], v[164:167]
  ds_read_b64_tr_b16 v[208:209], v226 offset:24576
  v_mfma_f32_16x16x32_bf16 v[172:175], v[212:215], v[84:87], v[172:175]
  ds_read_b64_tr_b16 v[210:211], v226 offset:25600
  v_mfma_f32_16x16x32_bf16 v[176:179], v[216:219], v[80:83], v[176:179]
  ds_read_b64_tr_b16 v[212:213], v226 offset:24584
  v_mfma_f32_16x16x32_bf16 v[184:187], v[216:219], v[84:87], v[184:187]
  ds_read_b64_tr_b16 v[214:215], v226 offset:25608
  v_mfma_f32_16x16x32_bf16 v[180:183], v[220:223], v[80:83], v[180:183]
  ds_read_b64_tr_b16 v[216:217], v227 offset:24576
  v_mfma_f32_16x16x32_bf16 v[188:191], v[220:223], v[84:87], v[188:191]
  ds_read_b64_tr_b16 v[218:219], v227 offset:25600
  ds_read_b64_tr_b16 v[220:221], v227 offset:24584
  ds_read_b64_tr_b16 v[222:223], v227 offset:25608
  s_waitcnt lgkmcnt(0)
  s_barrier
  v_mfma_f32_16x16x32_bf16 v[128:131], v[192:195], v[88:91], v[128:131]
  v_mfma_f32_16x16x32_bf16 v[136:139], v[192:195], v[92:95], v[136:139]
  v_mfma_f32_16x16x32_bf16 v[132:135], v[196:199], v[88:91], v[132:135]
  ds_read_b64_tr_b16 v[192:193], v224 offset:0
  v_mfma_f32_16x16x32_bf16 v[140:143], v[196:199], v[92:95], v[140:143]
  ds_read_b64_tr_b16 v[194:195], v224 offset:1024
  v_mfma_f32_16x16x32_bf16 v[144:147], v[200:203], v[88:91], v[144:147]
  ds_read_b64_tr_b16 v[196:197], v224 offset:8
  v_mfma_f32_16x16x32_bf16 v[152:155], v[200:203], v[92:95], v[152:155]
  ds_read_b64_tr_b16 v[198:199], v224 offset:1032
  v_mfma_f32_16x16x32_bf16 v[148:151], v[204:207], v[88:91], v[148:151]
  ds_read_b64_tr_b16 v[200:201], v225 offset:0
  v_mfma_f32_16x16x32_bf16 v[156:159], v[204:207], v[92:95], v[156:159]
  ds_read_b64_tr_b16 v[202:203], v225 offset:1024
  v_mfma_f32_16x16x32_bf16 v[160:163], v[208:211], v[88:91], v[160:163]
  ds_read_b64_tr_b16 v[204:205], v225 offset:8
  v_mfma_f32_16x16x32_bf16 v[168:171], v[208:211], v[92:95], v[168:171]
  ds_read_b64_tr_b16 v[206:207], v225 offset:1032
  v_mfma_f32_16x16x32_bf16 v[164:167], v[212:215], v[88:91], v[164:167]
  ds_read_b64_tr_b16 v[208:209], v226 offset:0
  v_mfma_f32_16x16x32_bf16 v[172:175], v[212:215], v[92:95], v[172:175]
  ds_read_b64_tr_b16 v[210:211], v226 offset:1024
  v_mfma_f32_16x16x32_bf16 v[176:179], v[216:219], v[88:91], v[176:179]
  ds_read_b64_tr_b16 v[212:213], v226 offset:8
  v_mfma_f32_16x16x32_bf16 v[184:187], v[216:219], v[92:95], v[184:187]
  ds_read_b64_tr_b16 v[214:215], v226 offset:1032
  v_mfma_f32_16x16x32_bf16 v[180:183], v[220:223], v[88:91], v[180:183]
  ds_read_b64_tr_b16 v[216:217], v227 offset:0
  v_mfma_f32_16x16x32_bf16 v[188:191], v[220:223], v[92:95], v[188:191]
  ds_read_b64_tr_b16 v[218:219], v227 offset:1024
  ds_read_b64_tr_b16 v[220:221], v227 offset:8
  ds_read_b64_tr_b16 v[222:223], v227 offset:1032
  s_waitcnt lgkmcnt(0)
  s_barrier
  v_mfma_f32_16x16x32_bf16 v[128:131], v[192:195], v[96:99], v[128:131]
  v_mfma_f32_16x16x32_bf16 v[136:139], v[192:195], v[100:103], v[136:139]
  v_mfma_f32_16x16x32_bf16 v[132:135], v[196:199], v[96:99], v[132:135]
  ds_read_b64_tr_b16 v[192:193], v224 offset:8192
  v_mfma_f32_16x16x32_bf16 v[140:143], v[196:199], v[100:103], v[140:143]
  ds_read_b64_tr_b16 v[194:195], v224 offset:9216
  v_mfma_f32_16x16x32_bf16 v[144:147], v[200:203], v[96:99], v[144:147]
  ds_read_b64_tr_b16 v[196:197], v224 offset:8200
  v_mfma_f32_16x16x32_bf16 v[152:155], v[200:203], v[100:103], v[152:155]
  ds_read_b64_tr_b16 v[198:199], v224 offset:9224
  v_mfma_f32_16x16x32_bf16 v[148:151], v[204:207], v[96:99], v[148:151]
  ds_read_b64_tr_b16 v[200:201], v225 offset:8192
  v_mfma_f32_16x16x32_bf16 v[156:159], v[204:207], v[100:103], v[156:159]
  ds_read_b64_tr_b16 v[202:203], v225 offset:9216
  v_mfma_f32_16x16x32_bf16 v[160:163], v[208:211], v[96:99], v[160:163]
  ds_read_b64_tr_b16 v[204:205], v225 offset:8200
  v_mfma_f32_16x16x32_bf16 v[168:171], v[208:211], v[100:103], v[168:171]
  ds_read_b64_tr_b16 v[206:207], v225 offset:9224
  v_mfma_f32_16x16x32_bf16 v[164:167], v[212:215], v[96:99], v[164:167]
  ds_read_b64_tr_b16 v[208:209], v226 offset:8192
  v_mfma_f32_16x16x32_bf16 v[172:175], v[212:215], v[100:103], v[172:175]
  ds_read_b64_tr_b16 v[210:211], v226 offset:9216
  v_mfma_f32_16x16x32_bf16 v[176:179], v[216:219], v[96:99], v[176:179]
  ds_read_b64_tr_b16 v[212:213], v226 offset:8200
  v_mfma_f32_16x16x32_bf16 v[184:187], v[216:219], v[100:103], v[184:187]
  ds_read_b64_tr_b16 v[214:215], v226 offset:9224
  v_mfma_f32_16x16x32_bf16 v[180:183], v[220:223], v[96:99], v[180:183]
  ds_read_b64_tr_b16 v[216:217], v227 offset:8192
  v_mfma_f32_16x16x32_bf16 v[188:191], v[220:223], v[100:103], v[188:191]
  ds_read_b64_tr_b16 v[218:219], v227 offset:9216
  ds_read_b64_tr_b16 v[220:221], v227 offset:8200
  ds_read_b64_tr_b16 v[222:223], v227 offset:9224
  s_waitcnt lgkmcnt(0)
  s_barrier
  v_mfma_f32_16x16x32_bf16 v[128:131], v[192:195], v[104:107], v[128:131]
  v_mfma_f32_16x16x32_bf16 v[136:139], v[192:195], v[108:111], v[136:139]
  v_mfma_f32_16x16x32_bf16 v[132:135], v[196:199], v[104:107], v[132:135]
  ds_read_b64_tr_b16 v[192:193], v224 offset:16384
  v_mfma_f32_16x16x32_bf16 v[140:143], v[196:199], v[108:111], v[140:143]
  ds_read_b64_tr_b16 v[194:195], v224 offset:17408
  v_mfma_f32_16x16x32_bf16 v[144:147], v[200:203], v[104:107], v[144:147]
  ds_read_b64_tr_b16 v[196:197], v224 offset:16392
  v_mfma_f32_16x16x32_bf16 v[152:155], v[200:203], v[108:111], v[152:155]
  ds_read_b64_tr_b16 v[198:199], v224 offset:17416
  v_mfma_f32_16x16x32_bf16 v[148:151], v[204:207], v[104:107], v[148:151]
  ds_read_b64_tr_b16 v[200:201], v225 offset:16384
  v_mfma_f32_16x16x32_bf16 v[156:159], v[204:207], v[108:111], v[156:159]
  ds_read_b64_tr_b16 v[202:203], v225 offset:17408
  v_mfma_f32_16x16x32_bf16 v[160:163], v[208:211], v[104:107], v[160:163]
  ds_read_b64_tr_b16 v[204:205], v225 offset:16392
  v_mfma_f32_16x16x32_bf16 v[168:171], v[208:211], v[108:111], v[168:171]
  ds_read_b64_tr_b16 v[206:207], v225 offset:17416
  v_mfma_f32_16x16x32_bf16 v[164:167], v[212:215], v[104:107], v[164:167]
  ds_read_b64_tr_b16 v[208:209], v226 offset:16384
  v_mfma_f32_16x16x32_bf16 v[172:175], v[212:215], v[108:111], v[172:175]
  ds_read_b64_tr_b16 v[210:211], v226 offset:17408
  v_mfma_f32_16x16x32_bf16 v[176:179], v[216:219], v[104:107], v[176:179]
  ds_read_b64_tr_b16 v[212:213], v226 offset:16392
  v_mfma_f32_16x16x32_bf16 v[184:187], v[216:219], v[108:111], v[184:187]
  ds_read_b64_tr_b16 v[214:215], v226 offset:17416
  v_mfma_f32_16x16x32_bf16 v[180:183], v[220:223], v[104:107], v[180:183]
  ds_read_b64_tr_b16 v[216:217], v227 offset:16384
  v_mfma_f32_16x16x32_bf16 v[188:191], v[220:223], v[108:111], v[188:191]
  ds_read_b64_tr_b16 v[218:219], v227 offset:17408
  ds_read_b64_tr_b16 v[220:221], v227 offset:16392
  ds_read_b64_tr_b16 v[222:223], v227 offset:17416
  s_waitcnt lgkmcnt(0)
  s_barrier
  v_mfma_f32_16x16x32_bf16 v[128:131], v[192:195], v[112:115], v[128:131]
  v_mfma_f32_16x16x32_bf16 v[136:139], v[192:195], v[116:119], v[136:139]
  v_mfma_f32_16x16x32_bf16 v[132:135], v[196:199], v[112:115], v[132:135]
  ds_read_b64_tr_b16 v[192:193], v224 offset:24576
  v_mfma_f32_16x16x32_bf16 v[140:143], v[196:199], v[116:119], v[140:143]
  ds_read_b64_tr_b16 v[194:195], v224 offset:25600
  v_mfma_f32_16x16x32_bf16 v[144:147], v[200:203], v[112:115], v[144:147]
  ds_read_b64_tr_b16 v[196:197], v224 offset:24584
  v_mfma_f32_16x16x32_bf16 v[152:155], v[200:203], v[116:119], v[152:155]
  ds_read_b64_tr_b16 v[198:199], v224 offset:25608
  v_mfma_f32_16x16x32_bf16 v[148:151], v[204:207], v[112:115], v[148:151]
  ds_read_b64_tr_b16 v[200:201], v225 offset:24576
  v_mfma_f32_16x16x32_bf16 v[156:159], v[204:207], v[116:119], v[156:159]
  ds_read_b64_tr_b16 v[202:203], v225 offset:25600
  v_mfma_f32_16x16x32_bf16 v[160:163], v[208:211], v[112:115], v[160:163]
  ds_read_b64_tr_b16 v[204:205], v225 offset:24584
  v_mfma_f32_16x16x32_bf16 v[168:171], v[208:211], v[116:119], v[168:171]
  ds_read_b64_tr_b16 v[206:207], v225 offset:25608
  v_mfma_f32_16x16x32_bf16 v[164:167], v[212:215], v[112:115], v[164:167]
  ds_read_b64_tr_b16 v[208:209], v226 offset:24576
  v_mfma_f32_16x16x32_bf16 v[172:175], v[212:215], v[116:119], v[172:175]
  ds_read_b64_tr_b16 v[210:211], v226 offset:25600
  v_mfma_f32_16x16x32_bf16 v[176:179], v[216:219], v[112:115], v[176:179]
  ds_read_b64_tr_b16 v[212:213], v226 offset:24584
  v_mfma_f32_16x16x32_bf16 v[184:187], v[216:219], v[116:119], v[184:187]
  ds_read_b64_tr_b16 v[214:215], v226 offset:25608
  v_mfma_f32_16x16x32_bf16 v[180:183], v[220:223], v[112:115], v[180:183]
  ds_read_b64_tr_b16 v[216:217], v227 offset:24576
  v_mfma_f32_16x16x32_bf16 v[188:191], v[220:223], v[116:119], v[188:191]
  ds_read_b64_tr_b16 v[218:219], v227 offset:25600
  ds_read_b64_tr_b16 v[220:221], v227 offset:24584
  ds_read_b64_tr_b16 v[222:223], v227 offset:25608
  s_waitcnt lgkmcnt(0)
  s_barrier
  v_mfma_f32_16x16x32_bf16 v[128:131], v[192:195], v[120:123], v[128:131]
  v_mfma_f32_16x16x32_bf16 v[136:139], v[192:195], v[124:127], v[136:139]
  v_mfma_f32_16x16x32_bf16 v[132:135], v[196:199], v[120:123], v[132:135]
  ds_read_b64_tr_b16 v[192:193], v224 offset:0
  v_mfma_f32_16x16x32_bf16 v[140:143], v[196:199], v[124:127], v[140:143]
  ds_read_b64_tr_b16 v[194:195], v224 offset:1024
  v_mfma_f32_16x16x32_bf16 v[144:147], v[200:203], v[120:123], v[144:147]
  ds_read_b64_tr_b16 v[196:197], v224 offset:8
  v_mfma_f32_16x16x32_bf16 v[152:155], v[200:203], v[124:127], v[152:155]
  ds_read_b64_tr_b16 v[198:199], v224 offset:1032
  v_mfma_f32_16x16x32_bf16 v[148:151], v[204:207], v[120:123], v[148:151]
  ds_read_b64_tr_b16 v[200:201], v225 offset:0
  v_mfma_f32_16x16x32_bf16 v[156:159], v[204:207], v[124:127], v[156:159]
  ds_read_b64_tr_b16 v[202:203], v225 offset:1024
  v_mfma_f32_16x16x32_bf16 v[160:163], v[208:211], v[120:123], v[160:163]
  ds_read_b64_tr_b16 v[204:205], v225 offset:8
  v_mfma_f32_16x16x32_bf16 v[168:171], v[208:211], v[124:127], v[168:171]
  ds_read_b64_tr_b16 v[206:207], v225 offset:1032
  v_mfma_f32_16x16x32_bf16 v[164:167], v[212:215], v[120:123], v[164:167]
  ds_read_b64_tr_b16 v[208:209], v226 offset:0
  v_mfma_f32_16x16x32_bf16 v[172:175], v[212:215], v[124:127], v[172:175]
  ds_read_b64_tr_b16 v[210:211], v226 offset:1024
  v_mfma_f32_16x16x32_bf16 v[176:179], v[216:219], v[120:123], v[176:179]
  ds_read_b64_tr_b16 v[212:213], v226 offset:8
  v_mfma_f32_16x16x32_bf16 v[184:187], v[216:219], v[124:127], v[184:187]
  ds_read_b64_tr_b16 v[214:215], v226 offset:1032
  v_mfma_f32_16x16x32_bf16 v[180:183], v[220:223], v[120:123], v[180:183]
  ds_read_b64_tr_b16 v[216:217], v227 offset:0
  v_mfma_f32_16x16x32_bf16 v[188:191], v[220:223], v[124:127], v[188:191]
  ds_read_b64_tr_b16 v[218:219], v227 offset:1024
  ds_read_b64_tr_b16 v[220:221], v227 offset:8
  ds_read_b64_tr_b16 v[222:223], v227 offset:1032
  s_waitcnt lgkmcnt(0)
  s_cmp_lt_u32 s51, 3
  s_cselect_b32 s49, 12, 8
  s_add_u32 s49, s49, s48
  s_lshl_b32 s49, s49, 13
  v_add_u32 v242, s49, v240
  s_nop 3
  v_pk_mul_f32 v[128:129], v[128:129], s[56:57]
  v_pk_mul_f32 v[130:131], v[130:131], s[56:57]
  v_pk_mul_f32 v[132:133], v[132:133], s[56:57]
  v_pk_mul_f32 v[134:135], v[134:135], s[56:57]
  v_cvt_pk_bf16_f32 v128, v128, v129
  v_cvt_pk_bf16_f32 v129, v130, v131
  v_cvt_pk_bf16_f32 v130, v132, v133
  v_cvt_pk_bf16_f32 v131, v134, v135
  ds_write_b128 v242, v[128:131] offset:0
  v_pk_mul_f32 v[136:137], v[136:137], s[56:57]
  v_pk_mul_f32 v[138:139], v[138:139], s[56:57]
  v_pk_mul_f32 v[140:141], v[140:141], s[56:57]
  v_pk_mul_f32 v[142:143], v[142:143], s[56:57]
  v_cvt_pk_bf16_f32 v132, v136, v137
  v_cvt_pk_bf16_f32 v133, v138, v139
  v_cvt_pk_bf16_f32 v134, v140, v141
  v_cvt_pk_bf16_f32 v135, v142, v143
  ds_write_b128 v242, v[132:135] offset:1024
  v_pk_mul_f32 v[144:145], v[144:145], s[56:57]
  v_pk_mul_f32 v[146:147], v[146:147], s[56:57]
  v_pk_mul_f32 v[148:149], v[148:149], s[56:57]
  v_pk_mul_f32 v[150:151], v[150:151], s[56:57]
  v_cvt_pk_bf16_f32 v136, v144, v145
  v_cvt_pk_bf16_f32 v137, v146, v147
  v_cvt_pk_bf16_f32 v138, v148, v149
  v_cvt_pk_bf16_f32 v139, v150, v151
  ds_write_b128 v242, v[136:139] offset:2048
  v_pk_mul_f32 v[152:153], v[152:153], s[56:57]
  v_pk_mul_f32 v[154:155], v[154:155], s[56:57]
  v_pk_mul_f32 v[156:157], v[156:157], s[56:57]
  v_pk_mul_f32 v[158:159], v[158:159], s[56:57]
  v_cvt_pk_bf16_f32 v140, v152, v153
  v_cvt_pk_bf16_f32 v141, v154, v155
  v_cvt_pk_bf16_f32 v142, v156, v157
  v_cvt_pk_bf16_f32 v143, v158, v159
  ds_write_b128 v242, v[140:143] offset:3072
  v_pk_mul_f32 v[160:161], v[160:161], s[56:57]
  v_pk_mul_f32 v[162:163], v[162:163], s[56:57]
  v_pk_mul_f32 v[164:165], v[164:165], s[56:57]
  v_pk_mul_f32 v[166:167], v[166:167], s[56:57]
  v_cvt_pk_bf16_f32 v144, v160, v161
  v_cvt_pk_bf16_f32 v145, v162, v163
  v_cvt_pk_bf16_f32 v146, v164, v165
  v_cvt_pk_bf16_f32 v147, v166, v167
  ds_write_b128 v242, v[144:147] offset:4096
  v_pk_mul_f32 v[168:169], v[168:169], s[56:57]
  v_pk_mul_f32 v[170:171], v[170:171], s[56:57]
  v_pk_mul_f32 v[172:173], v[172:173], s[56:57]
  v_pk_mul_f32 v[174:175], v[174:175], s[56:57]
  v_cvt_pk_bf16_f32 v148, v168, v169
  v_cvt_pk_bf16_f32 v149, v170, v171
  v_cvt_pk_bf16_f32 v150, v172, v173
  v_cvt_pk_bf16_f32 v151, v174, v175
  ds_write_b128 v242, v[148:151] offset:5120
  v_pk_mul_f32 v[176:177], v[176:177], s[56:57]
  v_pk_mul_f32 v[178:179], v[178:179], s[56:57]
  v_pk_mul_f32 v[180:181], v[180:181], s[56:57]
  v_pk_mul_f32 v[182:183], v[182:183], s[56:57]
  v_cvt_pk_bf16_f32 v152, v176, v177
  v_cvt_pk_bf16_f32 v153, v178, v179
  v_cvt_pk_bf16_f32 v154, v180, v181
  v_cvt_pk_bf16_f32 v155, v182, v183
  ds_write_b128 v242, v[152:155] offset:6144
  v_pk_mul_f32 v[184:185], v[184:185], s[56:57]
  v_pk_mul_f32 v[186:187], v[186:187], s[56:57]
  v_pk_mul_f32 v[188:189], v[188:189], s[56:57]
  v_pk_mul_f32 v[190:191], v[190:191], s[56:57]
  v_cvt_pk_bf16_f32 v156, v184, v185
  v_cvt_pk_bf16_f32 v157, v186, v187
  v_cvt_pk_bf16_f32 v158, v188, v189
  v_cvt_pk_bf16_f32 v159, v190, v191
  ds_write_b128 v242, v[156:159] offset:7168
  s_waitcnt lgkmcnt(0)
  s_add_u32 s51, s51, 1
  s_cmp_lt_u32 s51, 4
  s_cbranch_scc1 L_G_unit
  s_mov_b32 s54, 18
  s_branch L_tail_mm
L_roleA:
  s_mov_b32 s44, s8
  s_and_b32 s45, s9, 0xffff
  s_mov_b32 s46, 0x180000
  s_mov_b32 s47, 0x20000
  v_and_b32 v1, 15, v0
  v_lshrrev_b32 v2, 4, v0
  v_add_u32 v3, 0, v2
  v_xor_b32 v3, v1, v3
  v_lshlrev_b32 v3, 4, v3
  v_lshl_add_u32 v8, v2, 10, v3
  v_add_u32 v3, 4, v2
  v_xor_b32 v3, v1, v3
  v_lshlrev_b32 v3, 4, v3
  v_lshl_add_u32 v9, v2, 10, v3
  v_add_u32 v3, 8, v2
  v_xor_b32 v3, v1, v3
  v_lshlrev_b32 v3, 4, v3
  v_lshl_add_u32 v10, v2, 10, v3
  v_add_u32 v3, 12, v2
  v_xor_b32 v3, v1, v3
  v_lshlrev_b32 v3, 4, v3
  v_lshl_add_u32 v11, v2, 10, v3
  s_mul_i32 s58, s24, 98304
  s_lshl_b32 s50, s20, 15
  s_add_u32 s58, s58, s50
  s_lshr_b32 s59, s27, 2
  s_add_u32 s59, s59, 0
  s_and_b32 s59, s59, 3
  s_lshl_b32 s59, s59, 8
  s_add_u32 s50, s58, s59
  s_lshl_b32 s51, s20, 14
  s_add_u32 s51, s51, 98304
  s_add_u32 m0, s51, 0
  s_nop 0
  buffer_load_dwordx4 v8, s[44:47], s50 offen lds
  s_add_u32 m0, s51, 1024
  s_add_u32 s50, s50, 4096
  buffer_load_dwordx4 v9, s[44:47], s50 offen lds
  s_add_u32 m0, s51, 2048
  s_add_u32 s50, s50, 4096
  buffer_load_dwordx4 v10, s[44:47], s50 offen lds
  s_add_u32 m0, s51, 3072
  s_add_u32 s50, s50, 4096
  buffer_load_dwordx4 v11, s[44:47], s50 offen lds
  s_add_u32 m0, s51, 4096
  s_add_u32 s50, s50, 4096
  buffer_load_dwordx4 v8, s[44:47], s50 offen lds
  s_add_u32 m0, s51, 5120
  s_add_u32 s50, s50, 4096
  buffer_load_dwordx4 v9, s[44:47], s50 offen lds
  s_add_u32 m0, s51, 6144
  s_add_u32 s50, s50, 4096
  buffer_load_dwordx4 v10, s[44:47], s50 offen lds
  s_add_u32 m0, s51, 7168
  s_add_u32 s50, s50, 4096
  buffer_load_dwordx4 v11, s[44:47], s50 offen lds
  s_lshl_b32 s55, s23, 4
  s_add_u32 s55, s55, s24
  s_mov_b32 s54, 0xffff
  s_load_dwordx2 s[56:57], s[0:1], 88
  s_waitcnt lgkmcnt(0)
  s_mov_b32 s40, s56
  s_and_b32 s41, s57, 0xffff
  s_mov_b32 s42, 0x100
  s_mov_b32 s43, 0x20000
  v_lshlrev_b32 v242, 4, v0
  v_mov_b32 v255, v0
  v_lshrrev_b32 v1, 5, v255
  v_bfe_u32 v2, v255, 1, 3
  v_add_u32 v3, 0, v1
  v_xor_b32 v2, v2, v3
  v_lshlrev_b32 v1, 10, v1
  v_bfe_u32 v3, v255, 4, 1
  v_lshl_add_u32 v1, v3, 9, v1
  v_lshrrev_b32 v3, 2, v2
  v_lshl_add_u32 v1, v3, 8, v1
  v_and_b32 v3, 3, v2
  v_lshl_add_u32 v1, v3, 5, v1
  v_and_b32 v3, 1, v255
  v_lshl_add_u32 v248, v3, 4, v1
  v_lshrrev_b32 v1, 5, v255
  v_bfe_u32 v2, v255, 1, 3
  v_add_u32 v3, 2, v1
  v_xor_b32 v2, v2, v3
  v_lshlrev_b32 v1, 10, v1
  v_bfe_u32 v3, v255, 4, 1
  v_lshl_add_u32 v1, v3, 9, v1
  v_lshrrev_b32 v3, 2, v2
  v_lshl_add_u32 v1, v3, 8, v1
  v_and_b32 v3, 3, v2
  v_lshl_add_u32 v1, v3, 5, v1
  v_and_b32 v3, 1, v255
  v_lshl_add_u32 v249, v3, 4, v1
  v_lshrrev_b32 v1, 5, v255
  v_bfe_u32 v2, v255, 1, 3
  v_add_u32 v3, 4, v1
  v_xor_b32 v2, v2, v3
  v_lshlrev_b32 v1, 10, v1
  v_bfe_u32 v3, v255, 4, 1
  v_lshl_add_u32 v1, v3, 9, v1
  v_lshrrev_b32 v3, 2, v2
  v_lshl_add_u32 v1, v3, 8, v1
  v_and_b32 v3, 3, v2
  v_lshl_add_u32 v1, v3, 5, v1
  v_and_b32 v3, 1, v255
  v_lshl_add_u32 v250, v3, 4, v1
  v_lshrrev_b32 v1, 5, v255
  v_bfe_u32 v2, v255, 1, 3
  v_add_u32 v3, 6, v1
  v_xor_b32 v2, v2, v3
  v_lshlrev_b32 v1, 10, v1
  v_bfe_u32 v3, v255, 4, 1
  v_lshl_add_u32 v1, v3, 9, v1
  v_lshrrev_b32 v3, 2, v2
  v_lshl_add_u32 v1, v3, 8, v1
  v_and_b32 v3, 3, v2
  v_lshl_add_u32 v1, v3, 5, v1
  v_and_b32 v3, 1, v255
  v_lshl_add_u32 v251, v3, 4, v1
  s_mov_b32 s32, s16
  s_and_b32 s33, s17, 0xffff
  s_mov_b32 s34, 0x400000
  s_mov_b32 s35, 0x20000
  s_add_u32 s36, s18, 0
  s_addc_u32 s37, s19, 0
  s_and_b32 s37, s37, 0xffff
  s_mov_b32 s38, 0x1800000
  s_mov_b32 s39, 0x20000
  s_add_u32 s64, s18, 27262976
  s_addc_u32 s65, s19, 0
  s_and_b32 s65, s65, 0xffff
  s_mov_b32 s66, 32768
  s_mov_b32 s67, 0x20000
  v_and_b32 v1, 15, v0
  v_lshrrev_b32 v2, 4, v0
  v_xor_b32 v3, v1, v2
  v_lshlrev_b32 v1, 8, v1
  v_xor_b32 v2, 0, v3
  v_lshl_add_u32 v216, v2, 4, v1
  v_xor_b32 v2, 4, v3
  v_lshl_add_u32 v217, v2, 4, v1
  v_xor_b32 v2, 8, v3
  v_lshl_add_u32 v218, v2, 4, v1
  v_xor_b32 v2, 12, v3
  v_lshl_add_u32 v219, v2, 4, v1
  v_and_b32 v1, 15, v0
  v_lshrrev_b32 v2, 4, v0
  v_lshrrev_b32 v3, 2, v1
  v_lshl_add_u32 v4, v2, 2, v3
  v_lshlrev_b32 v5, 8, v4
  v_and_b32 v6, 3, v1
  v_lshl_add_u32 v5, v6, 3, v5
  v_add_u32 v5, 32768, v5
  v_and_b32 v4, 7, v4
  v_xor_b32 v6, 0, v4
  v_lshl_add_u32 v220, v6, 5, v5
  v_xor_b32 v6, 1, v4
  v_lshl_add_u32 v221, v6, 5, v5
  v_xor_b32 v6, 2, v4
  v_lshl_add_u32 v222, v6, 5, v5
  v_xor_b32 v6, 3, v4
  v_lshl_add_u32 v223, v6, 5, v5
  v_xor_b32 v6, 4, v4
  v_lshl_add_u32 v224, v6, 5, v5
  v_xor_b32 v6, 5, v4
  v_lshl_add_u32 v225, v6, 5, v5
  v_xor_b32 v6, 6, v4
  v_lshl_add_u32 v226, v6, 5, v5
  v_xor_b32 v6, 7, v4
  v_lshl_add_u32 v227, v6, 5, v5
  v_mov_b32 v228, 0
  v_mov_b32 v229, 0
  v_mov_b32 v230, 0
  v_mov_b32 v231, 0
  s_waitcnt vmcnt(0)
  s_barrier
  s_lshr_b32 s59, s27, 2
  s_add_u32 s59, s59, 1
  s_and_b32 s59, s59, 3
  s_lshl_b32 s59, s59, 8
  s_add_u32 s50, s58, s59
  s_lshl_b32 s51, s20, 14
  s_add_u32 s51, s51, 106496
  s_add_u32 m0, s51, 0
  s_nop 0
  buffer_load_dwordx4 v8, s[44:47], s50 offen lds
  s_add_u32 m0, s51, 1024
  s_add_u32 s50, s50, 4096
  buffer_load_dwordx4 v9, s[44:47], s50 offen lds
  s_add_u32 m0, s51, 2048
  s_add_u32 s50, s50, 4096
  buffer_load_dwordx4 v10, s[44:47], s50 offen lds
  s_add_u32 m0, s51, 3072
  s_add_u32 s50, s50, 4096
  buffer_load_dwordx4 v11, s[44:47], s50 offen lds
  s_barrier
  s_lshr_b32 s59, s27, 2
  s_add_u32 s59, s59, 1
  s_and_b32 s59, s59, 3
  s_lshl_b32 s59, s59, 8
  s_add_u32 s50, s58, s59
  s_add_u32 s50, s50, 16384
  s_lshl_b32 s51, s20, 14
  s_add_u32 s51, s51, 106496
  s_add_u32 m0, s51, 4096
  s_nop 0
  buffer_load_dwordx4 v8, s[44:47], s50 offen lds
  s_add_u32 m0, s51, 5120
  s_add_u32 s50, s50, 4096
  buffer_load_dwordx4 v9, s[44:47], s50 offen lds
  s_add_u32 m0, s51, 6144
  s_add_u32 s50, s50, 4096
  buffer_load_dwordx4 v10, s[44:47], s50 offen lds
  s_add_u32 m0, s51, 7168
  s_add_u32 s50, s50, 4096
  buffer_load_dwordx4 v11, s[44:47], s50 offen lds
  s_barrier
  s_lshr_b32 s59, s27, 2
  s_add_u32 s59, s59, 2
  s_and_b32 s59, s59, 3
  s_lshl_b32 s59, s59, 8
  s_add_u32 s50, s58, s59
  s_lshl_b32 s51, s20, 14
  s_add_u32 s51, s51, 0
  s_add_u32 m0, s51, 0
  s_nop 0
  buffer_load_dwordx4 v8, s[44:47], s50 offen lds
  s_add_u32 m0, s51, 1024
  s_add_u32 s50, s50, 4096
  buffer_load_dwordx4 v9, s[44:47], s50 offen lds
  s_barrier
  s_lshr_b32 s59, s27, 2
  s_add_u32 s59, s59, 2
  s_and_b32 s59, s59, 3
  s_lshl_b32 s59, s59, 8
  s_add_u32 s50, s58, s59
  s_add_u32 s50, s50, 8192
  s_lshl_b32 s51, s20, 14
  s_add_u32 s51, s51, 0
  s_add_u32 m0, s51, 2048
  s_nop 0
  buffer_load_dwordx4 v10, s[44:47], s50 offen lds
  s_add_u32 m0, s51, 3072
  s_add_u32 s50, s50, 4096
  buffer_load_dwordx4 v11, s[44:47], s50 offen lds
  s_waitcnt vmcnt(4)
  s_barrier
  s_lshr_b32 s59, s27, 2
  s_add_u32 s59, s59, 2
  s_and_b32 s59, s59, 3
  s_lshl_b32 s59, s59, 8
  s_add_u32 s50, s58, s59
  s_add_u32 s50, s50, 16384
  s_lshl_b32 s51, s20, 14
  s_add_u32 s51, s51, 0
  s_add_u32 m0, s51, 4096
  s_nop 0
  buffer_load_dwordx4 v8, s[44:47], s50 offen lds
  s_add_u32 m0, s51, 5120
  s_add_u32 s50, s50, 4096
  buffer_load_dwordx4 v9, s[44:47], s50 offen lds
  s_barrier
  s_lshr_b32 s59, s27, 2
  s_add_u32 s59, s59, 2
  s_and_b32 s59, s59, 3
  s_lshl_b32 s59, s59, 8
  s_add_u32 s50, s58, s59
  s_add_u32 s50, s50, 24576
  s_lshl_b32 s51, s20, 14
  s_add_u32 s51, s51, 0
  s_add_u32 m0, s51, 6144
  s_nop 0
  buffer_load_dwordx4 v10, s[44:47], s50 offen lds
  s_add_u32 m0, s51, 7168
  s_add_u32 s50, s50, 4096
  buffer_load_dwordx4 v11, s[44:47], s50 offen lds
  s_barrier
  s_lshr_b32 s59, s27, 2
  s_add_u32 s59, s59, 3
  s_and_b32 s59, s59, 3
  s_lshl_b32 s59, s59, 8
  s_add_u32 s50, s58, s59
  s_lshl_b32 s51, s20, 14
  s_add_u32 s51, s51, 8192
  s_add_u32 m0, s51, 0
  s_nop 0
  buffer_load_dwordx4 v8, s[44:47], s50 offen lds
  s_add_u32 m0, s51, 1024
  s_add_u32 s50, s50, 4096
  buffer_load_dwordx4 v9, s[44:47], s50 offen lds
  s_barrier
  s_lshr_b32 s59, s27, 2
  s_add_u32 s59, s59, 3
  s_and_b32 s59, s59, 3
  s_lshl_b32 s59, s59, 8
  s_add_u32 s50, s58, s59
  s_add_u32 s50, s50, 8192
  s_lshl_b32 s51, s20, 14
  s_add_u32 s51, s51, 8192
  s_add_u32 m0, s51, 2048
  s_nop 0
  buffer_load_dwordx4 v10, s[44:47], s50 offen lds
  s_add_u32 m0, s51, 3072
  s_add_u32 s50, s50, 4096
  buffer_load_dwordx4 v11, s[44:47], s50 offen lds
  s_waitcnt vmcnt(4)
  s_barrier
  s_lshr_b32 s59, s27, 2
  s_add_u32 s59, s59, 3
  s_and_b32 s59, s59, 3
  s_lshl_b32 s59, s59, 8
  s_add_u32 s50, s58, s59
  s_add_u32 s50, s50, 16384
  s_lshl_b32 s51, s20, 14
  s_add_u32 s51, s51, 8192
  s_add_u32 m0, s51, 4096
  s_nop 0
  buffer_load_dwordx4 v8, s[44:47], s50 offen lds
  s_add_u32 m0, s51, 5120
  s_add_u32 s50, s50, 4096
  buffer_load_dwordx4 v9, s[44:47], s50 offen lds
  s_barrier
  s_lshr_b32 s59, s27, 2
  s_add_u32 s59, s59, 3
  s_and_b32 s59, s59, 3
  s_lshl_b32 s59, s59, 8
  s_add_u32 s50, s58, s59
  s_add_u32 s50, s50, 24576
  s_lshl_b32 s51, s20, 14
  s_add_u32 s51, s51, 8192
  s_add_u32 m0, s51, 6144
  s_nop 0
  buffer_load_dwordx4 v10, s[44:47], s50 offen lds
  s_add_u32 m0, s51, 7168
  s_add_u32 s50, s50, 4096
  buffer_load_dwordx4 v11, s[44:47], s50 offen lds
  s_barrier
  s_barrier
  s_waitcnt vmcnt(0)
  s_barrier
  s_cmp_lg_u32 s20, 0
  s_cbranch_scc1 L_A_noreset0
  s_add_u32 s64, s18, 27262976
  s_addc_u32 s65, s19, 0
  s_and_b32 s65, s65, 0xffff
  s_mov_b32 s66, 32768
  s_mov_b32 s67, 0x20000
  s_lshl_b32 s50, s55, 3
  s_add_u32 s50, s50, s28
  s_lshl_b32 s50, s50, 7
  v_mov_b32 v1, 0
  v_lshlrev_b32 v2, 2, v0
  s_mov_b64 s[60:61], exec
  s_mov_b64 exec, 0xff
  buffer_store_dword v1, v2, s[64:67], s50 offen sc1
  s_mov_b64 exec, s[60:61]
L_A_noreset0:
  s_barrier
  s_barrier
  s_barrier
  s_barrier
  s_cmp_lg_u32 s20, 0
  s_cbranch_scc1 L_A_noreset1
  s_waitcnt vmcnt(0)
  v_mov_b32 v1, 0
  v_mov_b32 v2, 1
  s_lshl_b32 s50, s55, 2
  s_add_u32 s50, s50, 128
  s_mov_b64 s[60:61], exec
  s_mov_b64 exec, 1
  buffer_atomic_add v2, v1, s[40:43], s50 offen
  s_mov_b64 exec, s[60:61]
  s_lshr_b32 s3, s2, 3
  s_mul_i32 s3, s3, 3
  s_lshr_b32 s3, s3, 3
  s_add_u32 s54, s3, 4
L_A_noreset1:
  s_mov_b32 s49, 0
  s_barrier
  s_cmp_lt_u32 s49, 3
  s_cselect_b32 s50, 12, 8
  s_add_u32 s50, s50, s20
  s_lshl_b32 s50, s50, 13
  v_add_u32 v243, s50, v242
  ds_read_b128 v[64:67], v243 offset:0
  ds_read_b128 v[68:71], v243 offset:1024
  ds_read_b128 v[72:75], v243 offset:2048
  ds_read_b128 v[76:79], v243 offset:3072
  ds_read_b128 v[80:83], v243 offset:4096
  ds_read_b128 v[84:87], v243 offset:5120
  ds_read_b128 v[88:91], v243 offset:6144
  ds_read_b128 v[92:95], v243 offset:7168
  ds_read_b128 v[152:155], v216 offset:0
  ds_read_b128 v[156:159], v216 offset:4096
  ds_read_b128 v[160:163], v217 offset:0
  ds_read_b128 v[164:167], v217 offset:4096
  ds_read_b128 v[168:171], v218 offset:0
  ds_read_b128 v[172:175], v218 offset:4096
  ds_read_b128 v[176:179], v219 offset:0
  ds_read_b128 v[180:183], v219 offset:4096
  s_waitcnt lgkmcnt(7)
  v_mfma_f32_16x16x32_bf16 v[96:99], v[152:155], v[64:67], 0
  v_mfma_f32_16x16x32_bf16 v[104:107], v[152:155], v[68:71], 0
  s_waitcnt lgkmcnt(6)
  v_mfma_f32_16x16x32_bf16 v[100:103], v[156:159], v[64:67], 0
  v_mfma_f32_16x16x32_bf16 v[108:111], v[156:159], v[68:71], 0
  s_waitcnt lgkmcnt(5)
  v_mfma_f32_16x16x32_bf16 v[96:99], v[160:163], v[72:75], v[96:99]
  v_mfma_f32_16x16x32_bf16 v[104:107], v[160:163], v[76:79], v[104:107]
  s_waitcnt lgkmcnt(4)
  v_mfma_f32_16x16x32_bf16 v[100:103], v[164:167], v[72:75], v[100:103]
  v_mfma_f32_16x16x32_bf16 v[108:111], v[164:167], v[76:79], v[108:111]
  s_waitcnt lgkmcnt(3)
  v_mfma_f32_16x16x32_bf16 v[96:99], v[168:171], v[80:83], v[96:99]
  v_mfma_f32_16x16x32_bf16 v[104:107], v[168:171], v[84:87], v[104:107]
  s_waitcnt lgkmcnt(2)
  v_mfma_f32_16x16x32_bf16 v[100:103], v[172:175], v[80:83], v[100:103]
  v_mfma_f32_16x16x32_bf16 v[108:111], v[172:175], v[84:87], v[108:111]
  s_waitcnt lgkmcnt(1)
  v_mfma_f32_16x16x32_bf16 v[96:99], v[176:179], v[88:91], v[96:99]
  v_mfma_f32_16x16x32_bf16 v[104:107], v[176:179], v[92:95], v[104:107]
  s_waitcnt lgkmcnt(0)
  v_mfma_f32_16x16x32_bf16 v[100:103], v[180:183], v[88:91], v[100:103]
  v_mfma_f32_16x16x32_bf16 v[108:111], v[180:183], v[92:95], v[108:111]
  s_nop 7
  v_max3_f32 v232, v96, v97, v98
  v_max3_f32 v232, v232, v99, v100
  v_max3_f32 v232, v232, v101, v102
  v_max_f32 v232, v232, v103
  v_mov_b32 v233, v232
  s_nop 1
  v_permlane16_swap_b32 v232, v233
  s_nop 0
  v_max_f32 v232, v232, v233
  v_mov_b32 v233, v232
  s_nop 1
  v_permlane32_swap_b32 v232, v233
  s_nop 0
  v_max_f32 v232, v232, v233
  v_sub_f32 v96, v96, v232
  v_sub_f32 v97, v97, v232
  v_sub_f32 v98, v98, v232
  v_sub_f32 v99, v99, v232
  v_sub_f32 v100, v100, v232
  v_sub_f32 v101, v101, v232
  v_sub_f32 v102, v102, v232
  v_sub_f32 v103, v103, v232
  v_sub_f32 v128, 0, v232
  v_sub_f32 v129, 0, v232
  v_sub_f32 v130, 0, v232
  v_sub_f32 v131, 0, v232
  v_max3_f32 v232, v104, v105, v106
  v_max3_f32 v232, v232, v107, v108
  v_max3_f32 v232, v232, v109, v110
  v_max_f32 v232, v232, v111
  v_mov_b32 v233, v232
  s_nop 1
  v_permlane16_swap_b32 v232, v233
  s_nop 0
  v_max_f32 v232, v232, v233
  v_mov_b32 v233, v232
  s_nop 1
  v_permlane32_swap_b32 v232, v233
  s_nop 0
  v_max_f32 v232, v232, v233
  v_sub_f32 v104, v104, v232
  v_sub_f32 v105, v105, v232
  v_sub_f32 v106, v106, v232
  v_sub_f32 v107, v107, v232
  v_sub_f32 v108, v108, v232
  v_sub_f32 v109, v109, v232
  v_sub_f32 v110, v110, v232
  v_sub_f32 v111, v111, v232
  v_sub_f32 v132, 0, v232
  v_sub_f32 v133, 0, v232
  v_sub_f32 v134, 0, v232
  v_sub_f32 v135, 0, v232
  s_waitcnt lgkmcnt(0)
  s_barrier
  ds_read_b128 v[152:155], v216 offset:8192
  ds_read_b128 v[156:159], v216 offset:12288
  ds_read_b128 v[160:163], v217 offset:8192
  ds_read_b128 v[164:167], v217 offset:12288
  ds_read_b128 v[168:171], v218 offset:8192
  ds_read_b128 v[172:175], v218 offset:12288
  ds_read_b128 v[176:179], v219 offset:8192
  ds_read_b128 v[180:183], v219 offset:12288
  v_exp_f32 v96, v96
  v_exp_f32 v97, v97
  v_add_f32 v228, v228, v96
  v_exp_f32 v98, v98
  v_add_f32 v229, v229, v97
  v_cvt_pk_bf16_f32 v136, v96, v97
  v_exp_f32 v99, v99
  v_add_f32 v228, v228, v98
  v_exp_f32 v100, v100
  v_add_f32 v229, v229, v99
  v_cvt_pk_bf16_f32 v137, v98, v99
  v_exp_f32 v101, v101
  v_add_f32 v228, v228, v100
  v_exp_f32 v102, v102
  v_add_f32 v229, v229, v101
  v_cvt_pk_bf16_f32 v138, v100, v101
  v_exp_f32 v103, v103
  v_add_f32 v228, v228, v102
  s_waitcnt lgkmcnt(7)
  v_mfma_f32_16x16x32_bf16 v[112:115], v[152:155], v[64:67], v[128:131]
  v_exp_f32 v104, v104
  ds_read_b64_tr_b16 v[184:185], v220 offset:0
  v_mfma_f32_16x16x32_bf16 v[120:123], v[152:155], v[68:71], v[132:135]
  v_add_f32 v229, v229, v103
  v_cvt_pk_bf16_f32 v139, v102, v103
  ds_read_b64_tr_b16 v[186:187], v220 offset:4096
  s_waitcnt lgkmcnt(8)
  v_mfma_f32_16x16x32_bf16 v[116:119], v[156:159], v[64:67], v[128:131]
  v_exp_f32 v105, v105
  ds_read_b64_tr_b16 v[188:189], v221 offset:0
  v_mfma_f32_16x16x32_bf16 v[124:127], v[156:159], v[68:71], v[132:135]
  v_add_f32 v230, v230, v104
  ds_read_b64_tr_b16 v[190:191], v221 offset:4096
  s_waitcnt lgkmcnt(9)
  v_mfma_f32_16x16x32_bf16 v[112:115], v[160:163], v[72:75], v[112:115]
  v_exp_f32 v106, v106
  ds_read_b64_tr_b16 v[192:193], v222 offset:0
  v_mfma_f32_16x16x32_bf16 v[120:123], v[160:163], v[76:79], v[120:123]
  v_add_f32 v231, v231, v105
  v_cvt_pk_bf16_f32 v140, v104, v105
  ds_read_b64_tr_b16 v[194:195], v222 offset:4096
  s_waitcnt lgkmcnt(10)
  v_mfma_f32_16x16x32_bf16 v[116:119], v[164:167], v[72:75], v[116:119]
  v_exp_f32 v107, v107
  ds_read_b64_tr_b16 v[196:197], v223 offset:0
  v_mfma_f32_16x16x32_bf16 v[124:127], v[164:167], v[76:79], v[124:127]
  v_add_f32 v230, v230, v106
  ds_read_b64_tr_b16 v[198:199], v223 offset:4096
  s_waitcnt lgkmcnt(11)
  v_mfma_f32_16x16x32_bf16 v[112:115], v[168:171], v[80:83], v[112:115]
  v_exp_f32 v108, v108
  ds_read_b64_tr_b16 v[200:201], v224 offset:0
  v_mfma_f32_16x16x32_bf16 v[120:123], v[168:171], v[84:87], v[120:123]
  v_add_f32 v231, v231, v107
  v_cvt_pk_bf16_f32 v141, v106, v107
  ds_read_b64_tr_b16 v[202:203], v224 offset:4096
  s_waitcnt lgkmcnt(12)
  v_mfma_f32_16x16x32_bf16 v[116:119], v[172:175], v[80:83], v[116:119]
  v_exp_f32 v109, v109
  ds_read_b64_tr_b16 v[204:205], v225 offset:0
  v_mfma_f32_16x16x32_bf16 v[124:127], v[172:175], v[84:87], v[124:127]
  v_add_f32 v230, v230, v108
  ds_read_b64_tr_b16 v[206:207], v225 offset:4096
  s_waitcnt lgkmcnt(13)
  v_mfma_f32_16x16x32_bf16 v[112:115], v[176:179], v[88:91], v[112:115]
  v_exp_f32 v110, v110
  ds_read_b64_tr_b16 v[208:209], v226 offset:0
  v_mfma_f32_16x16x32_bf16 v[120:123], v[176:179], v[92:95], v[120:123]
  v_add_f32 v231, v231, v109
  v_cvt_pk_bf16_f32 v142, v108, v109
  ds_read_b64_tr_b16 v[210:211], v226 offset:4096
  s_waitcnt lgkmcnt(14)
  v_mfma_f32_16x16x32_bf16 v[116:119], v[180:183], v[88:91], v[116:119]
  v_exp_f32 v111, v111
  ds_read_b64_tr_b16 v[212:213], v227 offset:0
  v_mfma_f32_16x16x32_bf16 v[124:127], v[180:183], v[92:95], v[124:127]
  v_add_f32 v230, v230, v110
  ds_read_b64_tr_b16 v[214:215], v227 offset:4096
  s_nop 0
  v_add_f32 v231, v231, v111
  v_cvt_pk_bf16_f32 v143, v110, v111
  s_nop 2
  v_max3_f32 v232, v112, v113, v114
  v_max3_f32 v238, v115, v116, v117
  v_max3_f32 v232, v232, v118, v119
  v_max3_f32 v238, v238, v120, v121
  v_max3_f32 v232, v232, v122, v123
  v_max3_f32 v238, v238, v124, v125
  v_max3_f32 v232, v232, v126, v127
  v_max_f32 v232, v232, v238
  v_cmp_lt_f32 vcc, 0x41000000, v232
  s_cbranch_vccnz L_A_rare_f1
L_A_ret_f1:
  s_waitcnt lgkmcnt(0)
  s_mov_b32 s48, 0
  s_branch L_A_b2
L_A_loop:
  s_lshl_b32 s50, s49, 2
  s_add_u32 s50, s50, s48
  s_cmp_lg_u32 s50, s54
  s_cbranch_scc1 L_A_notrig
  s_lshl_b32 s50, s55, 2
  s_add_u32 s50, s50, 128
  v_mov_b32 v252, 0
  buffer_load_dword v253, v252, s[40:43], s50 offen sc1
L_A_notrig:
  s_cmp_lg_u32 s48, 0
  s_cbranch_scc1 L_A_reg0
  s_cmp_eq_u32 s49, 4
  s_cbranch_scc1 L_A_last
  s_barrier
  s_cmp_lt_u32 s49, 3
  s_cselect_b32 s50, 12, 8
  s_add_u32 s50, s50, s20
  s_lshl_b32 s50, s50, 13
  v_add_u32 v243, s50, v242
  ds_read_b128 v[64:67], v243 offset:0
  ds_read_b128 v[68:71], v243 offset:1024
  ds_read_b128 v[72:75], v243 offset:2048
  ds_read_b128 v[76:79], v243 offset:3072
  ds_read_b128 v[80:83], v243 offset:4096
  ds_read_b128 v[84:87], v243 offset:5120
  ds_read_b128 v[88:91], v243 offset:6144
  ds_read_b128 v[92:95], v243 offset:7168
  v_mfma_f32_16x16x32_bf16 v[0:3], v[184:187], v[136:139], v[0:3]
  v_exp_f32 v112, v112
  v_mfma_f32_16x16x32_bf16 v[8:11], v[184:187], v[140:143], v[8:11]
  ds_read_b128 v[152:155], v216 offset:0
  v_mfma_f32_16x16x32_bf16 v[4:7], v[188:191], v[136:139], v[4:7]
  v_exp_f32 v113, v113
  v_mfma_f32_16x16x32_bf16 v[12:15], v[188:191], v[140:143], v[12:15]
  v_add_f32 v228, v228, v112
  ds_read_b128 v[156:159], v216 offset:4096
  v_mfma_f32_16x16x32_bf16 v[16:19], v[192:195], v[136:139], v[16:19]
  v_exp_f32 v114, v114
  v_mfma_f32_16x16x32_bf16 v[24:27], v[192:195], v[140:143], v[24:27]
  v_add_f32 v229, v229, v113
  v_cvt_pk_bf16_f32 v144, v112, v113
  ds_read_b128 v[160:163], v217 offset:0
  v_mfma_f32_16x16x32_bf16 v[20:23], v[196:199], v[136:139], v[20:23]
  v_exp_f32 v115, v115
  v_mfma_f32_16x16x32_bf16 v[28:31], v[196:199], v[140:143], v[28:31]
  v_add_f32 v228, v228, v114
  ds_read_b128 v[164:167], v217 offset:4096
  v_mfma_f32_16x16x32_bf16 v[32:35], v[200:203], v[136:139], v[32:35]
  v_exp_f32 v116, v116
  v_mfma_f32_16x16x32_bf16 v[40:43], v[200:203], v[140:143], v[40:43]
  v_add_f32 v229, v229, v115
  v_cvt_pk_bf16_f32 v145, v114, v115
  ds_read_b128 v[168:171], v218 offset:0
  v_mfma_f32_16x16x32_bf16 v[36:39], v[204:207], v[136:139], v[36:39]
  v_exp_f32 v117, v117
  v_mfma_f32_16x16x32_bf16 v[44:47], v[204:207], v[140:143], v[44:47]
  v_add_f32 v228, v228, v116
  ds_read_b128 v[172:175], v218 offset:4096
  v_mfma_f32_16x16x32_bf16 v[48:51], v[208:211], v[136:139], v[48:51]
  v_exp_f32 v118, v118
  v_mfma_f32_16x16x32_bf16 v[56:59], v[208:211], v[140:143], v[56:59]
  v_add_f32 v229, v229, v117
  v_cvt_pk_bf16_f32 v146, v116, v117
  ds_read_b128 v[176:179], v219 offset:0
  v_mfma_f32_16x16x32_bf16 v[52:55], v[212:215], v[136:139], v[52:55]
  v_exp_f32 v119, v119
  v_mfma_f32_16x16x32_bf16 v[60:63], v[212:215], v[140:143], v[60:63]
  v_add_f32 v228, v228, v118
  ds_read_b128 v[180:183], v219 offset:4096
  s_waitcnt lgkmcnt(7)
  v_mfma_f32_16x16x32_bf16 v[96:99], v[152:155], v[64:67], 0
  v_exp_f32 v120, v120
  ds_read_b64_tr_b16 v[184:185], v220 offset:24576
  v_mfma_f32_16x16x32_bf16 v[104:107], v[152:155], v[68:71], 0
  v_add_f32 v229, v229, v119
  v_cvt_pk_bf16_f32 v147, v118, v119
  ds_read_b64_tr_b16 v[186:187], v220 offset:28672
  s_waitcnt lgkmcnt(8)
  v_mfma_f32_16x16x32_bf16 v[100:103], v[156:159], v[64:67], 0
  v_exp_f32 v121, v121
  ds_read_b64_tr_b16 v[188:189], v221 offset:24576
  v_mfma_f32_16x16x32_bf16 v[108:111], v[156:159], v[68:71], 0
  v_add_f32 v230, v230, v120
  ds_read_b64_tr_b16 v[190:191], v221 offset:28672
  s_waitcnt lgkmcnt(9)
  v_mfma_f32_16x16x32_bf16 v[96:99], v[160:163], v[72:75], v[96:99]
  v_exp_f32 v122, v122
  ds_read_b64_tr_b16 v[192:193], v222 offset:24576
  v_mfma_f32_16x16x32_bf16 v[104:107], v[160:163], v[76:79], v[104:107]
  v_add_f32 v231, v231, v121
  v_cvt_pk_bf16_f32 v148, v120, v121
  ds_read_b64_tr_b16 v[194:195], v222 offset:28672
  s_waitcnt lgkmcnt(10)
  v_mfma_f32_16x16x32_bf16 v[100:103], v[164:167], v[72:75], v[100:103]
  v_exp_f32 v123, v123
  ds_read_b64_tr_b16 v[196:197], v223 offset:24576
  v_mfma_f32_16x16x32_bf16 v[108:111], v[164:167], v[76:79], v[108:111]
  v_add_f32 v230, v230, v122
  ds_read_b64_tr_b16 v[198:199], v223 offset:28672
  s_waitcnt lgkmcnt(11)
  v_mfma_f32_16x16x32_bf16 v[96:99], v[168:171], v[80:83], v[96:99]
  v_exp_f32 v124, v124
  ds_read_b64_tr_b16 v[200:201], v224 offset:24576
  v_mfma_f32_16x16x32_bf16 v[104:107], v[168:171], v[84:87], v[104:107]
  v_add_f32 v231, v231, v123
  v_cvt_pk_bf16_f32 v149, v122, v123
  ds_read_b64_tr_b16 v[202:203], v224 offset:28672
  s_waitcnt lgkmcnt(12)
  v_mfma_f32_16x16x32_bf16 v[100:103], v[172:175], v[80:83], v[100:103]
  v_exp_f32 v125, v125
  ds_read_b64_tr_b16 v[204:205], v225 offset:24576
  v_mfma_f32_16x16x32_bf16 v[108:111], v[172:175], v[84:87], v[108:111]
  v_add_f32 v230, v230, v124
  ds_read_b64_tr_b16 v[206:207], v225 offset:28672
  s_waitcnt lgkmcnt(13)
  v_mfma_f32_16x16x32_bf16 v[96:99], v[176:179], v[88:91], v[96:99]
  v_exp_f32 v126, v126
  ds_read_b64_tr_b16 v[208:209], v226 offset:24576
  v_mfma_f32_16x16x32_bf16 v[104:107], v[176:179], v[92:95], v[104:107]
  v_add_f32 v231, v231, v125
  v_cvt_pk_bf16_f32 v150, v124, v125
  ds_read_b64_tr_b16 v[210:211], v226 offset:28672
  s_waitcnt lgkmcnt(14)
  v_mfma_f32_16x16x32_bf16 v[100:103], v[180:183], v[88:91], v[100:103]
  v_exp_f32 v127, v127
  ds_read_b64_tr_b16 v[212:213], v227 offset:24576
  v_mfma_f32_16x16x32_bf16 v[108:111], v[180:183], v[92:95], v[108:111]
  v_add_f32 v230, v230, v126
  ds_read_b64_tr_b16 v[214:215], v227 offset:28672
  s_nop 0
  v_add_f32 v231, v231, v127
  v_cvt_pk_bf16_f32 v151, v126, v127
  v_add_f32 v233, v228, v229
  v_mov_b32 v238, v233
  s_nop 1
  v_permlane16_swap_b32 v233, v238
  s_nop 0
  v_add_f32 v233, v233, v238
  v_mov_b32 v238, v233
  s_nop 1
  v_permlane32_swap_b32 v233, v238
  s_nop 0
  v_add_f32 v233, v233, v238
  v_rcp_f32 v234, v233
  v_mov_b32 v228, 0
  v_mov_b32 v235, v234
  v_mov_b32 v229, 0
  v_add_f32 v233, v230, v231
  v_mov_b32 v238, v233
  s_nop 1
  v_permlane16_swap_b32 v233, v238
  s_nop 0
  v_add_f32 v233, v233, v238
  v_mov_b32 v238, v233
  s_nop 1
  v_permlane32_swap_b32 v233, v238
  s_nop 0
  v_add_f32 v233, v233, v238
  v_rcp_f32 v236, v233
  v_mov_b32 v230, 0
  v_mov_b32 v237, v236
  v_mov_b32 v231, 0
  v_max3_f32 v232, v96, v97, v98
  v_max3_f32 v232, v232, v99, v100
  v_max3_f32 v232, v232, v101, v102
  v_max_f32 v232, v232, v103
  v_mov_b32 v233, v232
  s_nop 1
  v_permlane16_swap_b32 v232, v233
  s_nop 0
  v_max_f32 v232, v232, v233
  v_mov_b32 v233, v232
  s_nop 1
  v_permlane32_swap_b32 v232, v233
  s_nop 0
  v_max_f32 v232, v232, v233
  v_sub_f32 v96, v96, v232
  v_sub_f32 v97, v97, v232
  v_sub_f32 v98, v98, v232
  v_sub_f32 v99, v99, v232
  v_sub_f32 v100, v100, v232
  v_sub_f32 v101, v101, v232
  v_sub_f32 v102, v102, v232
  v_sub_f32 v103, v103, v232
  v_sub_f32 v128, 0, v232
  v_sub_f32 v129, 0, v232
  v_sub_f32 v130, 0, v232
  v_sub_f32 v131, 0, v232
  v_max3_f32 v232, v104, v105, v106
  v_max3_f32 v232, v232, v107, v108
  v_max3_f32 v232, v232, v109, v110
  v_max_f32 v232, v232, v111
  v_mov_b32 v233, v232
  s_nop 1
  v_permlane16_swap_b32 v232, v233
  s_nop 0
  v_max_f32 v232, v232, v233
  v_mov_b32 v233, v232
  s_nop 1
  v_permlane32_swap_b32 v232, v233
  s_nop 0
  v_max_f32 v232, v232, v233
  v_sub_f32 v104, v104, v232
  v_sub_f32 v105, v105, v232
  v_sub_f32 v106, v106, v232
  v_sub_f32 v107, v107, v232
  v_sub_f32 v108, v108, v232
  v_sub_f32 v109, v109, v232
  v_sub_f32 v110, v110, v232
  v_sub_f32 v111, v111, v232
  v_sub_f32 v132, 0, v232
  v_sub_f32 v133, 0, v232
  v_sub_f32 v134, 0, v232
  v_sub_f32 v135, 0, v232
  s_waitcnt lgkmcnt(0)
  s_barrier
  s_sub_u32 s50, s49, 1
  s_lshl_b32 s50, s50, 3
  s_lshr_b32 s50, 0x80C11, s50
  s_and_b32 s50, s50, 0xff
  s_add_u32 s50, s50, s20
  s_lshl_b32 s50, s50, 13
  v_add_u32 v243, s50, v242
  v_mfma_f32_16x16x32_bf16 v[0:3], v[184:187], v[144:147], v[0:3]
  v_exp_f32 v96, v96
  v_mfma_f32_16x16x32_bf16 v[8:11], v[184:187], v[148:151], v[8:11]
  ds_read_b128 v[152:155], v216 offset:8192
  v_mfma_f32_16x16x32_bf16 v[4:7], v[188:191], v[144:147], v[4:7]
  v_exp_f32 v97, v97
  v_mfma_f32_16x16x32_bf16 v[12:15], v[188:191], v[148:151], v[12:15]
  v_add_f32 v228, v228, v96
  ds_read_b128 v[156:159], v216 offset:12288
  v_mfma_f32_16x16x32_bf16 v[16:19], v[192:195], v[144:147], v[16:19]
  v_exp_f32 v98, v98
  v_mfma_f32_16x16x32_bf16 v[24:27], v[192:195], v[148:151], v[24:27]
  v_add_f32 v229, v229, v97
  v_cvt_pk_bf16_f32 v136, v96, v97
  ds_read_b128 v[160:163], v217 offset:8192
  v_mfma_f32_16x16x32_bf16 v[20:23], v[196:199], v[144:147], v[20:23]
  v_exp_f32 v99, v99
  v_mfma_f32_16x16x32_bf16 v[28:31], v[196:199], v[148:151], v[28:31]
  v_add_f32 v228, v228, v98
  ds_read_b128 v[164:167], v217 offset:12288
  v_mfma_f32_16x16x32_bf16 v[32:35], v[200:203], v[144:147], v[32:35]
  v_exp_f32 v100, v100
  v_mfma_f32_16x16x32_bf16 v[40:43], v[200:203], v[148:151], v[40:43]
  v_add_f32 v229, v229, v99
  v_cvt_pk_bf16_f32 v137, v98, v99
  ds_read_b128 v[168:171], v218 offset:8192
  v_mfma_f32_16x16x32_bf16 v[36:39], v[204:207], v[144:147], v[36:39]
  v_exp_f32 v101, v101
  v_mfma_f32_16x16x32_bf16 v[44:47], v[204:207], v[148:151], v[44:47]
  v_add_f32 v228, v228, v100
  ds_read_b128 v[172:175], v218 offset:12288
  v_mfma_f32_16x16x32_bf16 v[48:51], v[208:211], v[144:147], v[48:51]
  v_exp_f32 v102, v102
  v_mfma_f32_16x16x32_bf16 v[56:59], v[208:211], v[148:151], v[56:59]
  v_add_f32 v229, v229, v101
  v_cvt_pk_bf16_f32 v138, v100, v101
  ds_read_b128 v[176:179], v219 offset:8192
  v_mfma_f32_16x16x32_bf16 v[52:55], v[212:215], v[144:147], v[52:55]
  v_exp_f32 v103, v103
  v_mfma_f32_16x16x32_bf16 v[60:63], v[212:215], v[148:151], v[60:63]
  v_add_f32 v228, v228, v102
  ds_read_b128 v[180:183], v219 offset:12288
  s_waitcnt lgkmcnt(7)
  v_mfma_f32_16x16x32_bf16 v[112:115], v[152:155], v[64:67], v[128:131]
  v_exp_f32 v104, v104
  ds_read_b64_tr_b16 v[184:185], v220 offset:0
  v_mfma_f32_16x16x32_bf16 v[120:123], v[152:155], v[68:71], v[132:135]
  v_add_f32 v229, v229, v103
  v_cvt_pk_bf16_f32 v139, v102, v103
  ds_read_b64_tr_b16 v[186:187], v220 offset:4096
  v_pk_mul_f32 v[0:1], v[0:1], v[234:235]
  v_pk_mul_f32 v[2:3], v[2:3], v[234:235]
  v_pk_mul_f32 v[4:5], v[4:5], v[234:235]
  v_pk_mul_f32 v[6:7], v[6:7], v[234:235]
  v_cvt_pk_bf16_f32 v0, v0, v1
  v_cvt_pk_bf16_f32 v1, v2, v3
  v_cvt_pk_bf16_f32 v2, v4, v5
  v_cvt_pk_bf16_f32 v3, v6, v7
  ds_write_b128 v243, v[0:3] offset:0
  s_waitcnt lgkmcnt(9)
  v_mfma_f32_16x16x32_bf16 v[116:119], v[156:159], v[64:67], v[128:131]
  v_exp_f32 v105, v105
  ds_read_b64_tr_b16 v[188:189], v221 offset:0
  v_mfma_f32_16x16x32_bf16 v[124:127], v[156:159], v[68:71], v[132:135]
  v_add_f32 v230, v230, v104
  ds_read_b64_tr_b16 v[190:191], v221 offset:4096
  v_pk_mul_f32 v[8:9], v[8:9], v[236:237]
  v_pk_mul_f32 v[10:11], v[10:11], v[236:237]
  v_pk_mul_f32 v[12:13], v[12:13], v[236:237]
  v_pk_mul_f32 v[14:15], v[14:15], v[236:237]
  v_cvt_pk_bf16_f32 v4, v8, v9
  v_cvt_pk_bf16_f32 v5, v10, v11
  v_cvt_pk_bf16_f32 v6, v12, v13
  v_cvt_pk_bf16_f32 v7, v14, v15
  ds_write_b128 v243, v[4:7] offset:1024
  s_waitcnt lgkmcnt(11)
  v_mfma_f32_16x16x32_bf16 v[112:115], v[160:163], v[72:75], v[112:115]
  v_exp_f32 v106, v106
  ds_read_b64_tr_b16 v[192:193], v222 offset:0
  v_mfma_f32_16x16x32_bf16 v[120:123], v[160:163], v[76:79], v[120:123]
  v_add_f32 v231, v231, v105
  v_cvt_pk_bf16_f32 v140, v104, v105
  ds_read_b64_tr_b16 v[194:195], v222 offset:4096
  v_pk_mul_f32 v[16:17], v[16:17], v[234:235]
  v_pk_mul_f32 v[18:19], v[18:19], v[234:235]
  v_pk_mul_f32 v[20:21], v[20:21], v[234:235]
  v_pk_mul_f32 v[22:23], v[22:23], v[234:235]
  v_cvt_pk_bf16_f32 v8, v16, v17
  v_cvt_pk_bf16_f32 v9, v18, v19
  v_cvt_pk_bf16_f32 v10, v20, v21
  v_cvt_pk_bf16_f32 v11, v22, v23
  ds_write_b128 v243, v[8:11] offset:2048
  s_waitcnt lgkmcnt(13)
  v_mfma_f32_16x16x32_bf16 v[116:119], v[164:167], v[72:75], v[116:119]
  v_exp_f32 v107, v107
  ds_read_b64_tr_b16 v[196:197], v223 offset:0
  v_mfma_f32_16x16x32_bf16 v[124:127], v[164:167], v[76:79], v[124:127]
  v_add_f32 v230, v230, v106
  ds_read_b64_tr_b16 v[198:199], v223 offset:4096
  v_pk_mul_f32 v[24:25], v[24:25], v[236:237]
  v_pk_mul_f32 v[26:27], v[26:27], v[236:237]
  v_pk_mul_f32 v[28:29], v[28:29], v[236:237]
  v_pk_mul_f32 v[30:31], v[30:31], v[236:237]
  v_cvt_pk_bf16_f32 v12, v24, v25
  v_cvt_pk_bf16_f32 v13, v26, v27
  v_cvt_pk_bf16_f32 v14, v28, v29
  v_cvt_pk_bf16_f32 v15, v30, v31
  ds_write_b128 v243, v[12:15] offset:3072
  s_waitcnt lgkmcnt(15)
  v_mfma_f32_16x16x32_bf16 v[112:115], v[168:171], v[80:83], v[112:115]
  v_exp_f32 v108, v108
  ds_read_b64_tr_b16 v[200:201], v224 offset:0
  v_mfma_f32_16x16x32_bf16 v[120:123], v[168:171], v[84:87], v[120:123]
  v_add_f32 v231, v231, v107
  v_cvt_pk_bf16_f32 v141, v106, v107
  ds_read_b64_tr_b16 v[202:203], v224 offset:4096
  v_pk_mul_f32 v[32:33], v[32:33], v[234:235]
  v_pk_mul_f32 v[34:35], v[34:35], v[234:235]
  v_pk_mul_f32 v[36:37], v[36:37], v[234:235]
  v_pk_mul_f32 v[38:39], v[38:39], v[234:235]
  v_cvt_pk_bf16_f32 v16, v32, v33
  v_cvt_pk_bf16_f32 v17, v34, v35
  v_cvt_pk_bf16_f32 v18, v36, v37
  v_cvt_pk_bf16_f32 v19, v38, v39
  ds_write_b128 v243, v[16:19] offset:4096
  s_waitcnt lgkmcnt(15)
  v_mfma_f32_16x16x32_bf16 v[116:119], v[172:175], v[80:83], v[116:119]
  v_exp_f32 v109, v109
  ds_read_b64_tr_b16 v[204:205], v225 offset:0
  v_mfma_f32_16x16x32_bf16 v[124:127], v[172:175], v[84:87], v[124:127]
  v_add_f32 v230, v230, v108
  ds_read_b64_tr_b16 v[206:207], v225 offset:4096
  v_pk_mul_f32 v[40:41], v[40:41], v[236:237]
  v_pk_mul_f32 v[42:43], v[42:43], v[236:237]
  v_pk_mul_f32 v[44:45], v[44:45], v[236:237]
  v_pk_mul_f32 v[46:47], v[46:47], v[236:237]
  v_cvt_pk_bf16_f32 v20, v40, v41
  v_cvt_pk_bf16_f32 v21, v42, v43
  v_cvt_pk_bf16_f32 v22, v44, v45
  v_cvt_pk_bf16_f32 v23, v46, v47
  ds_write_b128 v243, v[20:23] offset:5120
  s_waitcnt lgkmcnt(15)
  v_mfma_f32_16x16x32_bf16 v[112:115], v[176:179], v[88:91], v[112:115]
  v_exp_f32 v110, v110
  ds_read_b64_tr_b16 v[208:209], v226 offset:0
  v_mfma_f32_16x16x32_bf16 v[120:123], v[176:179], v[92:95], v[120:123]
  v_add_f32 v231, v231, v109
  v_cvt_pk_bf16_f32 v142, v108, v109
  ds_read_b64_tr_b16 v[210:211], v226 offset:4096
  v_pk_mul_f32 v[48:49], v[48:49], v[234:235]
  v_pk_mul_f32 v[50:51], v[50:51], v[234:235]
  v_pk_mul_f32 v[52:53], v[52:53], v[234:235]
  v_pk_mul_f32 v[54:55], v[54:55], v[234:235]
  v_cvt_pk_bf16_f32 v24, v48, v49
  v_cvt_pk_bf16_f32 v25, v50, v51
  v_cvt_pk_bf16_f32 v26, v52, v53
  v_cvt_pk_bf16_f32 v27, v54, v55
  ds_write_b128 v243, v[24:27] offset:6144
  s_waitcnt lgkmcnt(15)
  v_mfma_f32_16x16x32_bf16 v[116:119], v[180:183], v[88:91], v[116:119]
  v_exp_f32 v111, v111
  ds_read_b64_tr_b16 v[212:213], v227 offset:0
  v_mfma_f32_16x16x32_bf16 v[124:127], v[180:183], v[92:95], v[124:127]
  v_add_f32 v230, v230, v110
  ds_read_b64_tr_b16 v[214:215], v227 offset:4096
  v_pk_mul_f32 v[56:57], v[56:57], v[236:237]
  v_pk_mul_f32 v[58:59], v[58:59], v[236:237]
  v_pk_mul_f32 v[60:61], v[60:61], v[236:237]
  v_pk_mul_f32 v[62:63], v[62:63], v[236:237]
  v_cvt_pk_bf16_f32 v28, v56, v57
  v_cvt_pk_bf16_f32 v29, v58, v59
  v_cvt_pk_bf16_f32 v30, v60, v61
  v_cvt_pk_bf16_f32 v31, v62, v63
  ds_write_b128 v243, v[28:31] offset:7168
  s_nop 0
  v_add_f32 v231, v231, v111
  v_cvt_pk_bf16_f32 v143, v110, v111
  v_max3_f32 v232, v112, v113, v114
  v_max3_f32 v238, v115, v116, v117
  v_max3_f32 v232, v232, v118, v119
  v_max3_f32 v238, v238, v120, v121
  v_max3_f32 v232, v232, v122, v123
  v_max3_f32 v238, v238, v124, v125
  v_max3_f32 v232, v232, v126, v127
  v_max_f32 v232, v232, v238
  v_cmp_lt_f32 vcc, 0x41000000, v232
  s_cbranch_vccnz L_A_rare_b1
L_A_ret_b1:
  s_waitcnt lgkmcnt(0)
L_A_b2:
  s_barrier
  v_mfma_f32_16x16x32_bf16 v[0:3], v[184:187], v[136:139], 0
  v_exp_f32 v112, v112
  v_mfma_f32_16x16x32_bf16 v[8:11], v[184:187], v[140:143], 0
  ds_read_b128 v[152:155], v216 offset:16384
  v_mfma_f32_16x16x32_bf16 v[4:7], v[188:191], v[136:139], 0
  v_exp_f32 v113, v113
  v_mfma_f32_16x16x32_bf16 v[12:15], v[188:191], v[140:143], 0
  v_add_f32 v228, v228, v112
  ds_read_b128 v[156:159], v216 offset:20480
  v_mfma_f32_16x16x32_bf16 v[16:19], v[192:195], v[136:139], 0
  v_exp_f32 v114, v114
  v_mfma_f32_16x16x32_bf16 v[24:27], v[192:195], v[140:143], 0
  v_add_f32 v229, v229, v113
  v_cvt_pk_bf16_f32 v144, v112, v113
  ds_read_b128 v[160:163], v217 offset:16384
  v_mfma_f32_16x16x32_bf16 v[20:23], v[196:199], v[136:139], 0
  v_exp_f32 v115, v115
  v_mfma_f32_16x16x32_bf16 v[28:31], v[196:199], v[140:143], 0
  v_add_f32 v228, v228, v114
  ds_read_b128 v[164:167], v217 offset:20480
  v_mfma_f32_16x16x32_bf16 v[32:35], v[200:203], v[136:139], 0
  v_exp_f32 v116, v116
  v_mfma_f32_16x16x32_bf16 v[40:43], v[200:203], v[140:143], 0
  v_add_f32 v229, v229, v115
  v_cvt_pk_bf16_f32 v145, v114, v115
  ds_read_b128 v[168:171], v218 offset:16384
  v_mfma_f32_16x16x32_bf16 v[36:39], v[204:207], v[136:139], 0
  v_exp_f32 v117, v117
  v_mfma_f32_16x16x32_bf16 v[44:47], v[204:207], v[140:143], 0
  v_add_f32 v228, v228, v116
  ds_read_b128 v[172:175], v218 offset:20480
  v_mfma_f32_16x16x32_bf16 v[48:51], v[208:211], v[136:139], 0
  v_exp_f32 v118, v118
  v_mfma_f32_16x16x32_bf16 v[56:59], v[208:211], v[140:143], 0
  v_add_f32 v229, v229, v117
  v_cvt_pk_bf16_f32 v146, v116, v117
  ds_read_b128 v[176:179], v219 offset:16384
  v_mfma_f32_16x16x32_bf16 v[52:55], v[212:215], v[136:139], 0
  v_exp_f32 v119, v119
  v_mfma_f32_16x16x32_bf16 v[60:63], v[212:215], v[140:143], 0
  v_add_f32 v228, v228, v118
  ds_read_b128 v[180:183], v219 offset:20480
  s_waitcnt lgkmcnt(7)
  v_mfma_f32_16x16x32_bf16 v[96:99], v[152:155], v[64:67], v[128:131]
  v_exp_f32 v120, v120
  ds_read_b64_tr_b16 v[184:185], v220 offset:8192
  v_mfma_f32_16x16x32_bf16 v[104:107], v[152:155], v[68:71], v[132:135]
  v_add_f32 v229, v229, v119
  v_cvt_pk_bf16_f32 v147, v118, v119
  ds_read_b64_tr_b16 v[186:187], v220 offset:12288
  s_waitcnt lgkmcnt(8)
  v_mfma_f32_16x16x32_bf16 v[100:103], v[156:159], v[64:67], v[128:131]
  v_exp_f32 v121, v121
  ds_read_b64_tr_b16 v[188:189], v221 offset:8192
  v_mfma_f32_16x16x32_bf16 v[108:111], v[156:159], v[68:71], v[132:135]
  v_add_f32 v230, v230, v120
  ds_read_b64_tr_b16 v[190:191], v221 offset:12288
  s_waitcnt lgkmcnt(9)
  v_mfma_f32_16x16x32_bf16 v[96:99], v[160:163], v[72:75], v[96:99]
  v_exp_f32 v122, v122
  ds_read_b64_tr_b16 v[192:193], v222 offset:8192
  v_mfma_f32_16x16x32_bf16 v[104:107], v[160:163], v[76:79], v[104:107]
  v_add_f32 v231, v231, v121
  v_cvt_pk_bf16_f32 v148, v120, v121
  ds_read_b64_tr_b16 v[194:195], v222 offset:12288
  s_waitcnt lgkmcnt(10)
  v_mfma_f32_16x16x32_bf16 v[100:103], v[164:167], v[72:75], v[100:103]
  v_exp_f32 v123, v123
  ds_read_b64_tr_b16 v[196:197], v223 offset:8192
  v_mfma_f32_16x16x32_bf16 v[108:111], v[164:167], v[76:79], v[108:111]
  v_add_f32 v230, v230, v122
  ds_read_b64_tr_b16 v[198:199], v223 offset:12288
  s_waitcnt lgkmcnt(11)
  v_mfma_f32_16x16x32_bf16 v[96:99], v[168:171], v[80:83], v[96:99]
  v_exp_f32 v124, v124
  ds_read_b64_tr_b16 v[200:201], v224 offset:8192
  v_mfma_f32_16x16x32_bf16 v[104:107], v[168:171], v[84:87], v[104:107]
  v_add_f32 v231, v231, v123
  v_cvt_pk_bf16_f32 v149, v122, v123
  ds_read_b64_tr_b16 v[202:203], v224 offset:12288
  s_waitcnt lgkmcnt(12)
  v_mfma_f32_16x16x32_bf16 v[100:103], v[172:175], v[80:83], v[100:103]
  v_exp_f32 v125, v125
  ds_read_b64_tr_b16 v[204:205], v225 offset:8192
  v_mfma_f32_16x16x32_bf16 v[108:111], v[172:175], v[84:87], v[108:111]
  v_add_f32 v230, v230, v124
  ds_read_b64_tr_b16 v[206:207], v225 offset:12288
  s_waitcnt lgkmcnt(13)
  v_mfma_f32_16x16x32_bf16 v[96:99], v[176:179], v[88:91], v[96:99]
  v_exp_f32 v126, v126
  ds_read_b64_tr_b16 v[208:209], v226 offset:8192
  v_mfma_f32_16x16x32_bf16 v[104:107], v[176:179], v[92:95], v[104:107]
  v_add_f32 v231, v231, v125
  v_cvt_pk_bf16_f32 v150, v124, v125
  ds_read_b64_tr_b16 v[210:211], v226 offset:12288
  s_waitcnt lgkmcnt(14)
  v_mfma_f32_16x16x32_bf16 v[100:103], v[180:183], v[88:91], v[100:103]
  v_exp_f32 v127, v127
  ds_read_b64_tr_b16 v[212:213], v227 offset:8192
  v_mfma_f32_16x16x32_bf16 v[108:111], v[180:183], v[92:95], v[108:111]
  v_add_f32 v230, v230, v126
  ds_read_b64_tr_b16 v[214:215], v227 offset:12288
  s_nop 0
  v_add_f32 v231, v231, v127
  v_cvt_pk_bf16_f32 v151, v126, v127
  s_nop 2
  v_max3_f32 v232, v96, v97, v98
  v_max3_f32 v238, v99, v100, v101
  v_max3_f32 v232, v232, v102, v103
  v_max3_f32 v238, v238, v104, v105
  v_max3_f32 v232, v232, v106, v107
  v_max3_f32 v238, v238, v108, v109
  v_max3_f32 v232, v232, v110, v111
  v_max_f32 v232, v232, v238
  v_cmp_lt_f32 vcc, 0x41000000, v232
  s_cbranch_vccnz L_A_rare_b2
L_A_ret_b2:
  s_waitcnt lgkmcnt(0)
  s_branch L_A_reg3
L_A_reg0:
  s_barrier
  v_mfma_f32_16x16x32_bf16 v[0:3], v[184:187], v[136:139], v[0:3]
  v_exp_f32 v112, v112
  v_mfma_f32_16x16x32_bf16 v[8:11], v[184:187], v[140:143], v[8:11]
  ds_read_b128 v[152:155], v216 offset:0
  v_mfma_f32_16x16x32_bf16 v[4:7], v[188:191], v[136:139], v[4:7]
  v_exp_f32 v113, v113
  v_mfma_f32_16x16x32_bf16 v[12:15], v[188:191], v[140:143], v[12:15]
  v_add_f32 v228, v228, v112
  ds_read_b128 v[156:159], v216 offset:4096
  v_mfma_f32_16x16x32_bf16 v[16:19], v[192:195], v[136:139], v[16:19]
  v_exp_f32 v114, v114
  v_mfma_f32_16x16x32_bf16 v[24:27], v[192:195], v[140:143], v[24:27]
  v_add_f32 v229, v229, v113
  v_cvt_pk_bf16_f32 v144, v112, v113
  ds_read_b128 v[160:163], v217 offset:0
  v_mfma_f32_16x16x32_bf16 v[20:23], v[196:199], v[136:139], v[20:23]
  v_exp_f32 v115, v115
  v_mfma_f32_16x16x32_bf16 v[28:31], v[196:199], v[140:143], v[28:31]
  v_add_f32 v228, v228, v114
  ds_read_b128 v[164:167], v217 offset:4096
  v_mfma_f32_16x16x32_bf16 v[32:35], v[200:203], v[136:139], v[32:35]
  v_exp_f32 v116, v116
  v_mfma_f32_16x16x32_bf16 v[40:43], v[200:203], v[140:143], v[40:43]
  v_add_f32 v229, v229, v115
  v_cvt_pk_bf16_f32 v145, v114, v115
  ds_read_b128 v[168:171], v218 offset:0
  v_mfma_f32_16x16x32_bf16 v[36:39], v[204:207], v[136:139], v[36:39]
  v_exp_f32 v117, v117
  v_mfma_f32_16x16x32_bf16 v[44:47], v[204:207], v[140:143], v[44:47]
  v_add_f32 v228, v228, v116
  ds_read_b128 v[172:175], v218 offset:4096
  v_mfma_f32_16x16x32_bf16 v[48:51], v[208:211], v[136:139], v[48:51]
  v_exp_f32 v118, v118
  v_mfma_f32_16x16x32_bf16 v[56:59], v[208:211], v[140:143], v[56:59]
  v_add_f32 v229, v229, v117
  v_cvt_pk_bf16_f32 v146, v116, v117
  ds_read_b128 v[176:179], v219 offset:0
  v_mfma_f32_16x16x32_bf16 v[52:55], v[212:215], v[136:139], v[52:55]
  v_exp_f32 v119, v119
  v_mfma_f32_16x16x32_bf16 v[60:63], v[212:215], v[140:143], v[60:63]
  v_add_f32 v228, v228, v118
  ds_read_b128 v[180:183], v219 offset:4096
  s_waitcnt lgkmcnt(7)
  v_mfma_f32_16x16x32_bf16 v[96:99], v[152:155], v[64:67], v[128:131]
  v_exp_f32 v120, v120
  ds_read_b64_tr_b16 v[184:185], v220 offset:24576
  v_mfma_f32_16x16x32_bf16 v[104:107], v[152:155], v[68:71], v[132:135]
  v_add_f32 v229, v229, v119
  v_cvt_pk_bf16_f32 v147, v118, v119
  ds_read_b64_tr_b16 v[186:187], v220 offset:28672
  s_waitcnt lgkmcnt(8)
  v_mfma_f32_16x16x32_bf16 v[100:103], v[156:159], v[64:67], v[128:131]
  v_exp_f32 v121, v121
  ds_read_b64_tr_b16 v[188:189], v221 offset:24576
  v_mfma_f32_16x16x32_bf16 v[108:111], v[156:159], v[68:71], v[132:135]
  v_add_f32 v230, v230, v120
  ds_read_b64_tr_b16 v[190:191], v221 offset:28672
  s_waitcnt lgkmcnt(9)
  v_mfma_f32_16x16x32_bf16 v[96:99], v[160:163], v[72:75], v[96:99]
  v_exp_f32 v122, v122
  ds_read_b64_tr_b16 v[192:193], v222 offset:24576
  v_mfma_f32_16x16x32_bf16 v[104:107], v[160:163], v[76:79], v[104:107]
  v_add_f32 v231, v231, v121
  v_cvt_pk_bf16_f32 v148, v120, v121
  ds_read_b64_tr_b16 v[194:195], v222 offset:28672
  s_waitcnt lgkmcnt(10)
  v_mfma_f32_16x16x32_bf16 v[100:103], v[164:167], v[72:75], v[100:103]
  v_exp_f32 v123, v123
  ds_read_b64_tr_b16 v[196:197], v223 offset:24576
  v_mfma_f32_16x16x32_bf16 v[108:111], v[164:167], v[76:79], v[108:111]
  v_add_f32 v230, v230, v122
  ds_read_b64_tr_b16 v[198:199], v223 offset:28672
  s_waitcnt lgkmcnt(11)
  v_mfma_f32_16x16x32_bf16 v[96:99], v[168:171], v[80:83], v[96:99]
  v_exp_f32 v124, v124
  ds_read_b64_tr_b16 v[200:201], v224 offset:24576
  v_mfma_f32_16x16x32_bf16 v[104:107], v[168:171], v[84:87], v[104:107]
  v_add_f32 v231, v231, v123
  v_cvt_pk_bf16_f32 v149, v122, v123
  ds_read_b64_tr_b16 v[202:203], v224 offset:28672
  s_waitcnt lgkmcnt(12)
  v_mfma_f32_16x16x32_bf16 v[100:103], v[172:175], v[80:83], v[100:103]
  v_exp_f32 v125, v125
  ds_read_b64_tr_b16 v[204:205], v225 offset:24576
  v_mfma_f32_16x16x32_bf16 v[108:111], v[172:175], v[84:87], v[108:111]
  v_add_f32 v230, v230, v124
  ds_read_b64_tr_b16 v[206:207], v225 offset:28672
  s_waitcnt lgkmcnt(13)
  v_mfma_f32_16x16x32_bf16 v[96:99], v[176:179], v[88:91], v[96:99]
  v_exp_f32 v126, v126
  ds_read_b64_tr_b16 v[208:209], v226 offset:24576
  v_mfma_f32_16x16x32_bf16 v[104:107], v[176:179], v[92:95], v[104:107]
  v_add_f32 v231, v231, v125
  v_cvt_pk_bf16_f32 v150, v124, v125
  ds_read_b64_tr_b16 v[210:211], v226 offset:28672
  s_waitcnt lgkmcnt(14)
  v_mfma_f32_16x16x32_bf16 v[100:103], v[180:183], v[88:91], v[100:103]
  v_exp_f32 v127, v127
  ds_read_b64_tr_b16 v[212:213], v227 offset:24576
  v_mfma_f32_16x16x32_bf16 v[108:111], v[180:183], v[92:95], v[108:111]
  v_add_f32 v230, v230, v126
  ds_read_b64_tr_b16 v[214:215], v227 offset:28672
  s_nop 0
  v_add_f32 v231, v231, v127
  v_cvt_pk_bf16_f32 v151, v126, v127
  s_nop 2
  v_max3_f32 v232, v96, v97, v98
  v_max3_f32 v238, v99, v100, v101
  v_max3_f32 v232, v232, v102, v103
  v_max3_f32 v238, v238, v104, v105
  v_max3_f32 v232, v232, v106, v107
  v_max3_f32 v238, v238, v108, v109
  v_max3_f32 v232, v232, v110, v111
  v_max_f32 v232, v232, v238
  v_cmp_lt_f32 vcc, 0x41000000, v232
  s_cbranch_vccnz L_A_rare_0
L_A_ret_0:
  s_waitcnt lgkmcnt(0)
  s_barrier
  v_mfma_f32_16x16x32_bf16 v[0:3], v[184:187], v[144:147], v[0:3]
  v_exp_f32 v96, v96
  v_mfma_f32_16x16x32_bf16 v[8:11], v[184:187], v[148:151], v[8:11]
  ds_read_b128 v[152:155], v216 offset:8192
  v_mfma_f32_16x16x32_bf16 v[4:7], v[188:191], v[144:147], v[4:7]
  v_exp_f32 v97, v97
  v_mfma_f32_16x16x32_bf16 v[12:15], v[188:191], v[148:151], v[12:15]
  v_add_f32 v228, v228, v96
  ds_read_b128 v[156:159], v216 offset:12288
  v_mfma_f32_16x16x32_bf16 v[16:19], v[192:195], v[144:147], v[16:19]
  v_exp_f32 v98, v98
  v_mfma_f32_16x16x32_bf16 v[24:27], v[192:195], v[148:151], v[24:27]
  v_add_f32 v229, v229, v97
  v_cvt_pk_bf16_f32 v136, v96, v97
  ds_read_b128 v[160:163], v217 offset:8192
  v_mfma_f32_16x16x32_bf16 v[20:23], v[196:199], v[144:147], v[20:23]
  v_exp_f32 v99, v99
  v_mfma_f32_16x16x32_bf16 v[28:31], v[196:199], v[148:151], v[28:31]
  v_add_f32 v228, v228, v98
  ds_read_b128 v[164:167], v217 offset:12288
  v_mfma_f32_16x16x32_bf16 v[32:35], v[200:203], v[144:147], v[32:35]
  v_exp_f32 v100, v100
  v_mfma_f32_16x16x32_bf16 v[40:43], v[200:203], v[148:151], v[40:43]
  v_add_f32 v229, v229, v99
  v_cvt_pk_bf16_f32 v137, v98, v99
  ds_read_b128 v[168:171], v218 offset:8192
  v_mfma_f32_16x16x32_bf16 v[36:39], v[204:207], v[144:147], v[36:39]
  v_exp_f32 v101, v101
  v_mfma_f32_16x16x32_bf16 v[44:47], v[204:207], v[148:151], v[44:47]
  v_add_f32 v228, v228, v100
  ds_read_b128 v[172:175], v218 offset:12288
  v_mfma_f32_16x16x32_bf16 v[48:51], v[208:211], v[144:147], v[48:51]
  v_exp_f32 v102, v102
  v_mfma_f32_16x16x32_bf16 v[56:59], v[208:211], v[148:151], v[56:59]
  v_add_f32 v229, v229, v101
  v_cvt_pk_bf16_f32 v138, v100, v101
  ds_read_b128 v[176:179], v219 offset:8192
  v_mfma_f32_16x16x32_bf16 v[52:55], v[212:215], v[144:147], v[52:55]
  v_exp_f32 v103, v103
  v_mfma_f32_16x16x32_bf16 v[60:63], v[212:215], v[148:151], v[60:63]
  v_add_f32 v228, v228, v102
  ds_read_b128 v[180:183], v219 offset:12288
  s_waitcnt lgkmcnt(7)
  v_mfma_f32_16x16x32_bf16 v[112:115], v[152:155], v[64:67], v[128:131]
  v_exp_f32 v104, v104
  ds_read_b64_tr_b16 v[184:185], v220 offset:0
  v_mfma_f32_16x16x32_bf16 v[120:123], v[152:155], v[68:71], v[132:135]
  v_add_f32 v229, v229, v103
  v_cvt_pk_bf16_f32 v139, v102, v103
  ds_read_b64_tr_b16 v[186:187], v220 offset:4096
  s_waitcnt lgkmcnt(8)
  v_mfma_f32_16x16x32_bf16 v[116:119], v[156:159], v[64:67], v[128:131]
  v_exp_f32 v105, v105
  ds_read_b64_tr_b16 v[188:189], v221 offset:0
  v_mfma_f32_16x16x32_bf16 v[124:127], v[156:159], v[68:71], v[132:135]
  v_add_f32 v230, v230, v104
  ds_read_b64_tr_b16 v[190:191], v221 offset:4096
  s_waitcnt lgkmcnt(9)
  v_mfma_f32_16x16x32_bf16 v[112:115], v[160:163], v[72:75], v[112:115]
  v_exp_f32 v106, v106
  ds_read_b64_tr_b16 v[192:193], v222 offset:0
  v_mfma_f32_16x16x32_bf16 v[120:123], v[160:163], v[76:79], v[120:123]
  v_add_f32 v231, v231, v105
  v_cvt_pk_bf16_f32 v140, v104, v105
  ds_read_b64_tr_b16 v[194:195], v222 offset:4096
  s_waitcnt lgkmcnt(10)
  v_mfma_f32_16x16x32_bf16 v[116:119], v[164:167], v[72:75], v[116:119]
  v_exp_f32 v107, v107
  ds_read_b64_tr_b16 v[196:197], v223 offset:0
  v_mfma_f32_16x16x32_bf16 v[124:127], v[164:167], v[76:79], v[124:127]
  v_add_f32 v230, v230, v106
  ds_read_b64_tr_b16 v[198:199], v223 offset:4096
  s_waitcnt lgkmcnt(11)
  v_mfma_f32_16x16x32_bf16 v[112:115], v[168:171], v[80:83], v[112:115]
  v_exp_f32 v108, v108
  ds_read_b64_tr_b16 v[200:201], v224 offset:0
  v_mfma_f32_16x16x32_bf16 v[120:123], v[168:171], v[84:87], v[120:123]
  v_add_f32 v231, v231, v107
  v_cvt_pk_bf16_f32 v141, v106, v107
  ds_read_b64_tr_b16 v[202:203], v224 offset:4096
  s_waitcnt lgkmcnt(12)
  v_mfma_f32_16x16x32_bf16 v[116:119], v[172:175], v[80:83], v[116:119]
  v_exp_f32 v109, v109
  ds_read_b64_tr_b16 v[204:205], v225 offset:0
  v_mfma_f32_16x16x32_bf16 v[124:127], v[172:175], v[84:87], v[124:127]
  v_add_f32 v230, v230, v108
  ds_read_b64_tr_b16 v[206:207], v225 offset:4096
  s_waitcnt lgkmcnt(13)
  v_mfma_f32_16x16x32_bf16 v[112:115], v[176:179], v[88:91], v[112:115]
  v_exp_f32 v110, v110
  ds_read_b64_tr_b16 v[208:209], v226 offset:0
  v_mfma_f32_16x16x32_bf16 v[120:123], v[176:179], v[92:95], v[120:123]
  v_add_f32 v231, v231, v109
  v_cvt_pk_bf16_f32 v142, v108, v109
  ds_read_b64_tr_b16 v[210:211], v226 offset:4096
  s_waitcnt lgkmcnt(14)
  v_mfma_f32_16x16x32_bf16 v[116:119], v[180:183], v[88:91], v[116:119]
  v_exp_f32 v111, v111
  ds_read_b64_tr_b16 v[212:213], v227 offset:0
  v_mfma_f32_16x16x32_bf16 v[124:127], v[180:183], v[92:95], v[124:127]
  v_add_f32 v230, v230, v110
  ds_read_b64_tr_b16 v[214:215], v227 offset:4096
  s_nop 0
  v_add_f32 v231, v231, v111
  v_cvt_pk_bf16_f32 v143, v110, v111
  s_nop 2
  v_max3_f32 v232, v112, v113, v114
  v_max3_f32 v238, v115, v116, v117
  v_max3_f32 v232, v232, v118, v119
  v_max3_f32 v238, v238, v120, v121
  v_max3_f32 v232, v232, v122, v123
  v_max3_f32 v238, v238, v124, v125
  v_max3_f32 v232, v232, v126, v127
  v_max_f32 v232, v232, v238
  v_cmp_lt_f32 vcc, 0x41000000, v232
  s_cbranch_vccnz L_A_rare_1
L_A_ret_1:
  s_waitcnt lgkmcnt(0)
  s_barrier
  v_mfma_f32_16x16x32_bf16 v[0:3], v[184:187], v[136:139], v[0:3]
  v_exp_f32 v112, v112
  v_mfma_f32_16x16x32_bf16 v[8:11], v[184:187], v[140:143], v[8:11]
  ds_read_b128 v[152:155], v216 offset:16384
  v_mfma_f32_16x16x32_bf16 v[4:7], v[188:191], v[136:139], v[4:7]
  v_exp_f32 v113, v113
  v_mfma_f32_16x16x32_bf16 v[12:15], v[188:191], v[140:143], v[12:15]
  v_add_f32 v228, v228, v112
  ds_read_b128 v[156:159], v216 offset:20480
  v_mfma_f32_16x16x32_bf16 v[16:19], v[192:195], v[136:139], v[16:19]
  v_exp_f32 v114, v114
  v_mfma_f32_16x16x32_bf16 v[24:27], v[192:195], v[140:143], v[24:27]
  v_add_f32 v229, v229, v113
  v_cvt_pk_bf16_f32 v144, v112, v113
  ds_read_b128 v[160:163], v217 offset:16384
  v_mfma_f32_16x16x32_bf16 v[20:23], v[196:199], v[136:139], v[20:23]
  v_exp_f32 v115, v115
  v_mfma_f32_16x16x32_bf16 v[28:31], v[196:199], v[140:143], v[28:31]
  v_add_f32 v228, v228, v114
  ds_read_b128 v[164:167], v217 offset:20480
  v_mfma_f32_16x16x32_bf16 v[32:35], v[200:203], v[136:139], v[32:35]
  v_exp_f32 v116, v116
  v_mfma_f32_16x16x32_bf16 v[40:43], v[200:203], v[140:143], v[40:43]
  v_add_f32 v229, v229, v115
  v_cvt_pk_bf16_f32 v145, v114, v115
  ds_read_b128 v[168:171], v218 offset:16384
  v_mfma_f32_16x16x32_bf16 v[36:39], v[204:207], v[136:139], v[36:39]
  v_exp_f32 v117, v117
  v_mfma_f32_16x16x32_bf16 v[44:47], v[204:207], v[140:143], v[44:47]
  v_add_f32 v228, v228, v116
  ds_read_b128 v[172:175], v218 offset:20480
  v_mfma_f32_16x16x32_bf16 v[48:51], v[208:211], v[136:139], v[48:51]
  v_exp_f32 v118, v118
  v_mfma_f32_16x16x32_bf16 v[56:59], v[208:211], v[140:143], v[56:59]
  v_add_f32 v229, v229, v117
  v_cvt_pk_bf16_f32 v146, v116, v117
  ds_read_b128 v[176:179], v219 offset:16384
  v_mfma_f32_16x16x32_bf16 v[52:55], v[212:215], v[136:139], v[52:55]
  v_exp_f32 v119, v119
  v_mfma_f32_16x16x32_bf16 v[60:63], v[212:215], v[140:143], v[60:63]
  v_add_f32 v228, v228, v118
  ds_read_b128 v[180:183], v219 offset:20480
  s_waitcnt lgkmcnt(7)
  v_mfma_f32_16x16x32_bf16 v[96:99], v[152:155], v[64:67], v[128:131]
  v_exp_f32 v120, v120
  ds_read_b64_tr_b16 v[184:185], v220 offset:8192
  v_mfma_f32_16x16x32_bf16 v[104:107], v[152:155], v[68:71], v[132:135]
  v_add_f32 v229, v229, v119
  v_cvt_pk_bf16_f32 v147, v118, v119
  ds_read_b64_tr_b16 v[186:187], v220 offset:12288
  s_waitcnt lgkmcnt(8)
  v_mfma_f32_16x16x32_bf16 v[100:103], v[156:159], v[64:67], v[128:131]
  v_exp_f32 v121, v121
  ds_read_b64_tr_b16 v[188:189], v221 offset:8192
  v_mfma_f32_16x16x32_bf16 v[108:111], v[156:159], v[68:71], v[132:135]
  v_add_f32 v230, v230, v120
  ds_read_b64_tr_b16 v[190:191], v221 offset:12288
  s_waitcnt lgkmcnt(9)
  v_mfma_f32_16x16x32_bf16 v[96:99], v[160:163], v[72:75], v[96:99]
  v_exp_f32 v122, v122
  ds_read_b64_tr_b16 v[192:193], v222 offset:8192
  v_mfma_f32_16x16x32_bf16 v[104:107], v[160:163], v[76:79], v[104:107]
  v_add_f32 v231, v231, v121
  v_cvt_pk_bf16_f32 v148, v120, v121
  ds_read_b64_tr_b16 v[194:195], v222 offset:12288
  s_waitcnt lgkmcnt(10)
  v_mfma_f32_16x16x32_bf16 v[100:103], v[164:167], v[72:75], v[100:103]
  v_exp_f32 v123, v123
  ds_read_b64_tr_b16 v[196:197], v223 offset:8192
  v_mfma_f32_16x16x32_bf16 v[108:111], v[164:167], v[76:79], v[108:111]
  v_add_f32 v230, v230, v122
  ds_read_b64_tr_b16 v[198:199], v223 offset:12288
  s_waitcnt lgkmcnt(11)
  v_mfma_f32_16x16x32_bf16 v[96:99], v[168:171], v[80:83], v[96:99]
  v_exp_f32 v124, v124
  ds_read_b64_tr_b16 v[200:201], v224 offset:8192
  v_mfma_f32_16x16x32_bf16 v[104:107], v[168:171], v[84:87], v[104:107]
  v_add_f32 v231, v231, v123
  v_cvt_pk_bf16_f32 v149, v122, v123
  ds_read_b64_tr_b16 v[202:203], v224 offset:12288
  s_waitcnt lgkmcnt(12)
  v_mfma_f32_16x16x32_bf16 v[100:103], v[172:175], v[80:83], v[100:103]
  v_exp_f32 v125, v125
  ds_read_b64_tr_b16 v[204:205], v225 offset:8192
  v_mfma_f32_16x16x32_bf16 v[108:111], v[172:175], v[84:87], v[108:111]
  v_add_f32 v230, v230, v124
  ds_read_b64_tr_b16 v[206:207], v225 offset:12288
  s_waitcnt lgkmcnt(13)
  v_mfma_f32_16x16x32_bf16 v[96:99], v[176:179], v[88:91], v[96:99]
  v_exp_f32 v126, v126
  ds_read_b64_tr_b16 v[208:209], v226 offset:8192
  v_mfma_f32_16x16x32_bf16 v[104:107], v[176:179], v[92:95], v[104:107]
  v_add_f32 v231, v231, v125
  v_cvt_pk_bf16_f32 v150, v124, v125
  ds_read_b64_tr_b16 v[210:211], v226 offset:12288
  s_waitcnt lgkmcnt(14)
  v_mfma_f32_16x16x32_bf16 v[100:103], v[180:183], v[88:91], v[100:103]
  v_exp_f32 v127, v127
  ds_read_b64_tr_b16 v[212:213], v227 offset:8192
  v_mfma_f32_16x16x32_bf16 v[108:111], v[180:183], v[92:95], v[108:111]
  v_add_f32 v230, v230, v126
  ds_read_b64_tr_b16 v[214:215], v227 offset:12288
  s_nop 0
  v_add_f32 v231, v231, v127
  v_cvt_pk_bf16_f32 v151, v126, v127
  s_nop 2
  v_max3_f32 v232, v96, v97, v98
  v_max3_f32 v238, v99, v100, v101
  v_max3_f32 v232, v232, v102, v103
  v_max3_f32 v238, v238, v104, v105
  v_max3_f32 v232, v232, v106, v107
  v_max3_f32 v238, v238, v108, v109
  v_max3_f32 v232, v232, v110, v111
  v_max_f32 v232, v232, v238
  v_cmp_lt_f32 vcc, 0x41000000, v232
  s_cbranch_vccnz L_A_rare_2
L_A_ret_2:
  s_waitcnt lgkmcnt(0)
L_A_reg3:
  s_barrier
  v_mfma_f32_16x16x32_bf16 v[0:3], v[184:187], v[144:147], v[0:3]
  v_exp_f32 v96, v96
  v_mfma_f32_16x16x32_bf16 v[8:11], v[184:187], v[148:151], v[8:11]
  ds_read_b128 v[152:155], v216 offset:24576
  v_mfma_f32_16x16x32_bf16 v[4:7], v[188:191], v[144:147], v[4:7]
  v_exp_f32 v97, v97
  v_mfma_f32_16x16x32_bf16 v[12:15], v[188:191], v[148:151], v[12:15]
  v_add_f32 v228, v228, v96
  ds_read_b128 v[156:159], v216 offset:28672
  v_mfma_f32_16x16x32_bf16 v[16:19], v[192:195], v[144:147], v[16:19]
  v_exp_f32 v98, v98
  v_mfma_f32_16x16x32_bf16 v[24:27], v[192:195], v[148:151], v[24:27]
  v_add_f32 v229, v229, v97
  v_cvt_pk_bf16_f32 v136, v96, v97
  ds_read_b128 v[160:163], v217 offset:24576
  v_mfma_f32_16x16x32_bf16 v[20:23], v[196:199], v[144:147], v[20:23]
  v_exp_f32 v99, v99
  v_mfma_f32_16x16x32_bf16 v[28:31], v[196:199], v[148:151], v[28:31]
  v_add_f32 v228, v228, v98
  ds_read_b128 v[164:167], v217 offset:28672
  v_mfma_f32_16x16x32_bf16 v[32:35], v[200:203], v[144:147], v[32:35]
  v_exp_f32 v100, v100
  v_mfma_f32_16x16x32_bf16 v[40:43], v[200:203], v[148:151], v[40:43]
  v_add_f32 v229, v229, v99
  v_cvt_pk_bf16_f32 v137, v98, v99
  ds_read_b128 v[168:171], v218 offset:24576
  v_mfma_f32_16x16x32_bf16 v[36:39], v[204:207], v[144:147], v[36:39]
  v_exp_f32 v101, v101
  v_mfma_f32_16x16x32_bf16 v[44:47], v[204:207], v[148:151], v[44:47]
  v_add_f32 v228, v228, v100
  ds_read_b128 v[172:175], v218 offset:28672
  v_mfma_f32_16x16x32_bf16 v[48:51], v[208:211], v[144:147], v[48:51]
  v_exp_f32 v102, v102
  v_mfma_f32_16x16x32_bf16 v[56:59], v[208:211], v[148:151], v[56:59]
  v_add_f32 v229, v229, v101
  v_cvt_pk_bf16_f32 v138, v100, v101
  ds_read_b128 v[176:179], v219 offset:24576
  v_mfma_f32_16x16x32_bf16 v[52:55], v[212:215], v[144:147], v[52:55]
  v_exp_f32 v103, v103
  v_mfma_f32_16x16x32_bf16 v[60:63], v[212:215], v[148:151], v[60:63]
  v_add_f32 v228, v228, v102
  ds_read_b128 v[180:183], v219 offset:28672
  s_waitcnt lgkmcnt(7)
  v_mfma_f32_16x16x32_bf16 v[112:115], v[152:155], v[64:67], v[128:131]
  v_exp_f32 v104, v104
  ds_read_b64_tr_b16 v[184:185], v220 offset:16384
  v_mfma_f32_16x16x32_bf16 v[120:123], v[152:155], v[68:71], v[132:135]
  v_add_f32 v229, v229, v103
  v_cvt_pk_bf16_f32 v139, v102, v103
  ds_read_b64_tr_b16 v[186:187], v220 offset:20480
  s_waitcnt lgkmcnt(8)
  v_mfma_f32_16x16x32_bf16 v[116:119], v[156:159], v[64:67], v[128:131]
  v_exp_f32 v105, v105
  ds_read_b64_tr_b16 v[188:189], v221 offset:16384
  v_mfma_f32_16x16x32_bf16 v[124:127], v[156:159], v[68:71], v[132:135]
  v_add_f32 v230, v230, v104
  ds_read_b64_tr_b16 v[190:191], v221 offset:20480
  s_waitcnt lgkmcnt(9)
  v_mfma_f32_16x16x32_bf16 v[112:115], v[160:163], v[72:75], v[112:115]
  v_exp_f32 v106, v106
  ds_read_b64_tr_b16 v[192:193], v222 offset:16384
  v_mfma_f32_16x16x32_bf16 v[120:123], v[160:163], v[76:79], v[120:123]
  v_add_f32 v231, v231, v105
  v_cvt_pk_bf16_f32 v140, v104, v105
  ds_read_b64_tr_b16 v[194:195], v222 offset:20480
  s_waitcnt lgkmcnt(10)
  v_mfma_f32_16x16x32_bf16 v[116:119], v[164:167], v[72:75], v[116:119]
  v_exp_f32 v107, v107
  ds_read_b64_tr_b16 v[196:197], v223 offset:16384
  v_mfma_f32_16x16x32_bf16 v[124:127], v[164:167], v[76:79], v[124:127]
  v_add_f32 v230, v230, v106
  ds_read_b64_tr_b16 v[198:199], v223 offset:20480
  s_waitcnt lgkmcnt(11)
  v_mfma_f32_16x16x32_bf16 v[112:115], v[168:171], v[80:83], v[112:115]
  v_exp_f32 v108, v108
  ds_read_b64_tr_b16 v[200:201], v224 offset:16384
  v_mfma_f32_16x16x32_bf16 v[120:123], v[168:171], v[84:87], v[120:123]
  v_add_f32 v231, v231, v107
  v_cvt_pk_bf16_f32 v141, v106, v107
  ds_read_b64_tr_b16 v[202:203], v224 offset:20480
  s_waitcnt lgkmcnt(12)
  v_mfma_f32_16x16x32_bf16 v[116:119], v[172:175], v[80:83], v[116:119]
  v_exp_f32 v109, v109
  ds_read_b64_tr_b16 v[204:205], v225 offset:16384
  v_mfma_f32_16x16x32_bf16 v[124:127], v[172:175], v[84:87], v[124:127]
  v_add_f32 v230, v230, v108
  ds_read_b64_tr_b16 v[206:207], v225 offset:20480
  s_waitcnt lgkmcnt(13)
  v_mfma_f32_16x16x32_bf16 v[112:115], v[176:179], v[88:91], v[112:115]
  v_exp_f32 v110, v110
  ds_read_b64_tr_b16 v[208:209], v226 offset:16384
  v_mfma_f32_16x16x32_bf16 v[120:123], v[176:179], v[92:95], v[120:123]
  v_add_f32 v231, v231, v109
  v_cvt_pk_bf16_f32 v142, v108, v109
  ds_read_b64_tr_b16 v[210:211], v226 offset:20480
  s_waitcnt lgkmcnt(14)
  v_mfma_f32_16x16x32_bf16 v[116:119], v[180:183], v[88:91], v[116:119]
  v_exp_f32 v111, v111
  ds_read_b64_tr_b16 v[212:213], v227 offset:16384
  v_mfma_f32_16x16x32_bf16 v[124:127], v[180:183], v[92:95], v[124:127]
  v_add_f32 v230, v230, v110
  ds_read_b64_tr_b16 v[214:215], v227 offset:20480
  s_nop 0
  v_add_f32 v231, v231, v111
  v_cvt_pk_bf16_f32 v143, v110, v111
  s_nop 2
  v_max3_f32 v232, v112, v113, v114
  v_max3_f32 v238, v115, v116, v117
  v_max3_f32 v232, v232, v118, v119
  v_max3_f32 v238, v238, v120, v121
  v_max3_f32 v232, v232, v122, v123
  v_max3_f32 v238, v238, v124, v125
  v_max3_f32 v232, v232, v126, v127
  v_max_f32 v232, v232, v238
  v_cmp_lt_f32 vcc, 0x41000000, v232
  s_cbranch_vccnz L_A_rare_3
L_A_ret_3:
  s_waitcnt lgkmcnt(0)
  s_add_u32 s48, s48, 1
  s_cmp_eq_u32 s48, 4
  s_cbranch_scc0 L_A_loop
  s_mov_b32 s48, 0
  s_add_u32 s49, s49, 1
  s_branch L_A_loop
L_A_last:
  s_barrier
  v_mfma_f32_16x16x32_bf16 v[0:3], v[184:187], v[136:139], v[0:3]
  v_exp_f32 v112, v112
  v_mfma_f32_16x16x32_bf16 v[8:11], v[184:187], v[140:143], v[8:11]
  v_mfma_f32_16x16x32_bf16 v[4:7], v[188:191], v[136:139], v[4:7]
  v_exp_f32 v113, v113
  v_mfma_f32_16x16x32_bf16 v[12:15], v[188:191], v[140:143], v[12:15]
  v_add_f32 v228, v228, v112
  v_mfma_f32_16x16x32_bf16 v[16:19], v[192:195], v[136:139], v[16:19]
  v_exp_f32 v114, v114
  v_mfma_f32_16x16x32_bf16 v[24:27], v[192:195], v[140:143], v[24:27]
  v_add_f32 v229, v229, v113
  v_cvt_pk_bf16_f32 v144, v112, v113
  v_mfma_f32_16x16x32_bf16 v[20:23], v[196:199], v[136:139], v[20:23]
  v_exp_f32 v115, v115
  v_mfma_f32_16x16x32_bf16 v[28:31], v[196:199], v[140:143], v[28:31]
  v_add_f32 v228, v228, v114
  v_mfma_f32_16x16x32_bf16 v[32:35], v[200:203], v[136:139], v[32:35]
  v_exp_f32 v116, v116
  v_mfma_f32_16x16x32_bf16 v[40:43], v[200:203], v[140:143], v[40:43]
  v_add_f32 v229, v229, v115
  v_cvt_pk_bf16_f32 v145, v114, v115
  v_mfma_f32_16x16x32_bf16 v[36:39], v[204:207], v[136:139], v[36:39]
  v_exp_f32 v117, v117
  v_mfma_f32_16x16x32_bf16 v[44:47], v[204:207], v[140:143], v[44:47]
  v_add_f32 v228, v228, v116
  v_mfma_f32_16x16x32_bf16 v[48:51], v[208:211], v[136:139], v[48:51]
  v_exp_f32 v118, v118
  v_mfma_f32_16x16x32_bf16 v[56:59], v[208:211], v[140:143], v[56:59]
  v_add_f32 v229, v229, v117
  v_cvt_pk_bf16_f32 v146, v116, v117
  v_mfma_f32_16x16x32_bf16 v[52:55], v[212:215], v[136:139], v[52:55]
  v_exp_f32 v119, v119
  v_mfma_f32_16x16x32_bf16 v[60:63], v[212:215], v[140:143], v[60:63]
  v_add_f32 v228, v228, v118
  v_exp_f32 v120, v120
  ds_read_b64_tr_b16 v[184:185], v220 offset:24576
  v_add_f32 v229, v229, v119
  v_cvt_pk_bf16_f32 v147, v118, v119
  ds_read_b64_tr_b16 v[186:187], v220 offset:28672
  v_exp_f32 v121, v121
  ds_read_b64_tr_b16 v[188:189], v221 offset:24576
  v_add_f32 v230, v230, v120
  ds_read_b64_tr_b16 v[190:191], v221 offset:28672
  v_exp_f32 v122, v122
  ds_read_b64_tr_b16 v[192:193], v222 offset:24576
  v_add_f32 v231, v231, v121
  v_cvt_pk_bf16_f32 v148, v120, v121
  ds_read_b64_tr_b16 v[194:195], v222 offset:28672
  v_exp_f32 v123, v123
  ds_read_b64_tr_b16 v[196:197], v223 offset:24576
  v_add_f32 v230, v230, v122
  ds_read_b64_tr_b16 v[198:199], v223 offset:28672
  v_exp_f32 v124, v124
  ds_read_b64_tr_b16 v[200:201], v224 offset:24576
  v_add_f32 v231, v231, v123
  v_cvt_pk_bf16_f32 v149, v122, v123
  ds_read_b64_tr_b16 v[202:203], v224 offset:28672
  v_exp_f32 v125, v125
  ds_read_b64_tr_b16 v[204:205], v225 offset:24576
  v_add_f32 v230, v230, v124
  ds_read_b64_tr_b16 v[206:207], v225 offset:28672
  v_exp_f32 v126, v126
  ds_read_b64_tr_b16 v[208:209], v226 offset:24576
  v_add_f32 v231, v231, v125
  v_cvt_pk_bf16_f32 v150, v124, v125
  ds_read_b64_tr_b16 v[210:211], v226 offset:28672
  v_exp_f32 v127, v127
  ds_read_b64_tr_b16 v[212:213], v227 offset:24576
  v_add_f32 v230, v230, v126
  ds_read_b64_tr_b16 v[214:215], v227 offset:28672
  s_nop 0
  v_add_f32 v231, v231, v127
  v_cvt_pk_bf16_f32 v151, v126, v127
  v_add_f32 v233, v228, v229
  v_mov_b32 v238, v233
  s_nop 1
  v_permlane16_swap_b32 v233, v238
  s_nop 0
  v_add_f32 v233, v233, v238
  v_mov_b32 v238, v233
  s_nop 1
  v_permlane32_swap_b32 v233, v238
  s_nop 0
  v_add_f32 v233, v233, v238
  v_rcp_f32 v234, v233
  v_mov_b32 v228, 0
  v_mov_b32 v235, v234
  v_mov_b32 v229, 0
  v_add_f32 v233, v230, v231
  v_mov_b32 v238, v233
  s_nop 1
  v_permlane16_swap_b32 v233, v238
  s_nop 0
  v_add_f32 v233, v233, v238
  v_mov_b32 v238, v233
  s_nop 1
  v_permlane32_swap_b32 v233, v238
  s_nop 0
  v_add_f32 v233, v233, v238
  v_rcp_f32 v236, v233
  v_mov_b32 v230, 0
  v_mov_b32 v237, v236
  v_mov_b32 v231, 0
  s_waitcnt lgkmcnt(0)
  s_barrier
  s_sub_u32 s50, s49, 1
  s_lshl_b32 s50, s50, 3
  s_lshr_b32 s50, 0x80C11, s50
  s_and_b32 s50, s50, 0xff
  s_add_u32 s50, s50, s20
  s_lshl_b32 s50, s50, 13
  v_add_u32 v243, s50, v242
  v_mfma_f32_16x16x32_bf16 v[0:3], v[184:187], v[144:147], v[0:3]
  v_mfma_f32_16x16x32_bf16 v[8:11], v[184:187], v[148:151], v[8:11]
  v_mfma_f32_16x16x32_bf16 v[4:7], v[188:191], v[144:147], v[4:7]
  v_mfma_f32_16x16x32_bf16 v[12:15], v[188:191], v[148:151], v[12:15]
  v_mfma_f32_16x16x32_bf16 v[16:19], v[192:195], v[144:147], v[16:19]
  v_mfma_f32_16x16x32_bf16 v[24:27], v[192:195], v[148:151], v[24:27]
  v_mfma_f32_16x16x32_bf16 v[20:23], v[196:199], v[144:147], v[20:23]
  v_mfma_f32_16x16x32_bf16 v[28:31], v[196:199], v[148:151], v[28:31]
  v_mfma_f32_16x16x32_bf16 v[32:35], v[200:203], v[144:147], v[32:35]
  v_mfma_f32_16x16x32_bf16 v[40:43], v[200:203], v[148:151], v[40:43]
  v_mfma_f32_16x16x32_bf16 v[36:39], v[204:207], v[144:147], v[36:39]
  v_mfma_f32_16x16x32_bf16 v[44:47], v[204:207], v[148:151], v[44:47]
  v_mfma_f32_16x16x32_bf16 v[48:51], v[208:211], v[144:147], v[48:51]
  v_mfma_f32_16x16x32_bf16 v[56:59], v[208:211], v[148:151], v[56:59]
  v_mfma_f32_16x16x32_bf16 v[52:55], v[212:215], v[144:147], v[52:55]
  v_mfma_f32_16x16x32_bf16 v[60:63], v[212:215], v[148:151], v[60:63]
  s_nop 7
  v_pk_mul_f32 v[0:1], v[0:1], v[234:235]
  v_pk_mul_f32 v[2:3], v[2:3], v[234:235]
  v_pk_mul_f32 v[4:5], v[4:5], v[234:235]
  v_pk_mul_f32 v[6:7], v[6:7], v[234:235]
  v_cvt_pk_bf16_f32 v0, v0, v1
  v_cvt_pk_bf16_f32 v1, v2, v3
  v_cvt_pk_bf16_f32 v2, v4, v5
  v_cvt_pk_bf16_f32 v3, v6, v7
  ds_write_b128 v243, v[0:3] offset:0
  v_pk_mul_f32 v[8:9], v[8:9], v[236:237]
  v_pk_mul_f32 v[10:11], v[10:11], v[236:237]
  v_pk_mul_f32 v[12:13], v[12:13], v[236:237]
  v_pk_mul_f32 v[14:15], v[14:15], v[236:237]
  v_cvt_pk_bf16_f32 v4, v8, v9
  v_cvt_pk_bf16_f32 v5, v10, v11
  v_cvt_pk_bf16_f32 v6, v12, v13
  v_cvt_pk_bf16_f32 v7, v14, v15
  ds_write_b128 v243, v[4:7] offset:1024
  v_pk_mul_f32 v[16:17], v[16:17], v[234:235]
  v_pk_mul_f32 v[18:19], v[18:19], v[234:235]
  v_pk_mul_f32 v[20:21], v[20:21], v[234:235]
  v_pk_mul_f32 v[22:23], v[22:23], v[234:235]
  v_cvt_pk_bf16_f32 v8, v16, v17
  v_cvt_pk_bf16_f32 v9, v18, v19
  v_cvt_pk_bf16_f32 v10, v20, v21
  v_cvt_pk_bf16_f32 v11, v22, v23
  ds_write_b128 v243, v[8:11] offset:2048
  v_pk_mul_f32 v[24:25], v[24:25], v[236:237]
  v_pk_mul_f32 v[26:27], v[26:27], v[236:237]
  v_pk_mul_f32 v[28:29], v[28:29], v[236:237]
  v_pk_mul_f32 v[30:31], v[30:31], v[236:237]
  v_cvt_pk_bf16_f32 v12, v24, v25
  v_cvt_pk_bf16_f32 v13, v26, v27
  v_cvt_pk_bf16_f32 v14, v28, v29
  v_cvt_pk_bf16_f32 v15, v30, v31
  ds_write_b128 v243, v[12:15] offset:3072
  v_pk_mul_f32 v[32:33], v[32:33], v[234:235]
  v_pk_mul_f32 v[34:35], v[34:35], v[234:235]
  v_pk_mul_f32 v[36:37], v[36:37], v[234:235]
  v_pk_mul_f32 v[38:39], v[38:39], v[234:235]
  v_cvt_pk_bf16_f32 v16, v32, v33
  v_cvt_pk_bf16_f32 v17, v34, v35
  v_cvt_pk_bf16_f32 v18, v36, v37
  v_cvt_pk_bf16_f32 v19, v38, v39
  ds_write_b128 v243, v[16:19] offset:4096
  v_pk_mul_f32 v[40:41], v[40:41], v[236:237]
  v_pk_mul_f32 v[42:43], v[42:43], v[236:237]
  v_pk_mul_f32 v[44:45], v[44:45], v[236:237]
  v_pk_mul_f32 v[46:47], v[46:47], v[236:237]
  v_cvt_pk_bf16_f32 v20, v40, v41
  v_cvt_pk_bf16_f32 v21, v42, v43
  v_cvt_pk_bf16_f32 v22, v44, v45
  v_cvt_pk_bf16_f32 v23, v46, v47
  ds_write_b128 v243, v[20:23] offset:5120
  v_pk_mul_f32 v[48:49], v[48:49], v[234:235]
  v_pk_mul_f32 v[50:51], v[50:51], v[234:235]
  v_pk_mul_f32 v[52:53], v[52:53], v[234:235]
  v_pk_mul_f32 v[54:55], v[54:55], v[234:235]
  v_cvt_pk_bf16_f32 v24, v48, v49
  v_cvt_pk_bf16_f32 v25, v50, v51
  v_cvt_pk_bf16_f32 v26, v52, v53
  v_cvt_pk_bf16_f32 v27, v54, v55
  ds_write_b128 v243, v[24:27] offset:6144
  v_pk_mul_f32 v[56:57], v[56:57], v[236:237]
  v_pk_mul_f32 v[58:59], v[58:59], v[236:237]
  v_pk_mul_f32 v[60:61], v[60:61], v[236:237]
  v_pk_mul_f32 v[62:63], v[62:63], v[236:237]
  v_cvt_pk_bf16_f32 v28, v56, v57
  v_cvt_pk_bf16_f32 v29, v58, v59
  v_cvt_pk_bf16_f32 v30, v60, v61
  v_cvt_pk_bf16_f32 v31, v62, v63
  ds_write_b128 v243, v[28:31] offset:7168
  s_waitcnt lgkmcnt(0)
  s_branch L_tail_ld
L_A_rare_f1:
  s_nop 15
  v_max3_f32 v232, v112, v113, v114
  v_max3_f32 v232, v232, v115, v116
  v_max3_f32 v232, v232, v117, v118
  v_max_f32 v232, v232, v119
  v_mov_b32 v233, v232
  s_nop 1
  v_permlane16_swap_b32 v232, v233
  s_nop 0
  v_max_f32 v232, v232, v233
  v_mov_b32 v233, v232
  s_nop 1
  v_permlane32_swap_b32 v232, v233
  s_nop 0
  v_max_f32 v232, v232, v233
  v_max_f32 v232, 0, v232
  v_ceil_f32 v232, v232
  v_min_f32 v233, 0x43480000, v232
  v_cvt_i32_f32 v233, v233
  v_sub_u32 v233, 0, v233
  v_ldexp_f32 v238, 1.0, v233
  v_mov_b32 v239, v238
  v_sub_f32 v112, v112, v232
  v_sub_f32 v113, v113, v232
  v_sub_f32 v114, v114, v232
  v_sub_f32 v115, v115, v232
  v_sub_f32 v116, v116, v232
  v_sub_f32 v117, v117, v232
  v_sub_f32 v118, v118, v232
  v_sub_f32 v119, v119, v232
  v_sub_f32 v128, v128, v232
  v_sub_f32 v129, v129, v232
  v_sub_f32 v130, v130, v232
  v_sub_f32 v131, v131, v232
  v_pk_mul_f32 v[0:1], v[0:1], v[238:239]
  v_pk_mul_f32 v[2:3], v[2:3], v[238:239]
  v_pk_mul_f32 v[4:5], v[4:5], v[238:239]
  v_pk_mul_f32 v[6:7], v[6:7], v[238:239]
  v_pk_mul_f32 v[16:17], v[16:17], v[238:239]
  v_pk_mul_f32 v[18:19], v[18:19], v[238:239]
  v_pk_mul_f32 v[20:21], v[20:21], v[238:239]
  v_pk_mul_f32 v[22:23], v[22:23], v[238:239]
  v_pk_mul_f32 v[32:33], v[32:33], v[238:239]
  v_pk_mul_f32 v[34:35], v[34:35], v[238:239]
  v_pk_mul_f32 v[36:37], v[36:37], v[238:239]
  v_pk_mul_f32 v[38:39], v[38:39], v[238:239]
  v_pk_mul_f32 v[48:49], v[48:49], v[238:239]
  v_pk_mul_f32 v[50:51], v[50:51], v[238:239]
  v_pk_mul_f32 v[52:53], v[52:53], v[238:239]
  v_pk_mul_f32 v[54:55], v[54:55], v[238:239]
  v_mul_f32 v228, v228, v238
  v_mul_f32 v229, v229, v238
  v_lshlrev_b32 v232, 16, v136
  v_and_b32 v233, 0xffff0000, v136
  v_mul_f32 v232, v232, v238
  v_mul_f32 v233, v233, v238
  v_cvt_pk_bf16_f32 v136, v232, v233
  v_lshlrev_b32 v232, 16, v137
  v_and_b32 v233, 0xffff0000, v137
  v_mul_f32 v232, v232, v238
  v_mul_f32 v233, v233, v238
  v_cvt_pk_bf16_f32 v137, v232, v233
  v_lshlrev_b32 v232, 16, v138
  v_and_b32 v233, 0xffff0000, v138
  v_mul_f32 v232, v232, v238
  v_mul_f32 v233, v233, v238
  v_cvt_pk_bf16_f32 v138, v232, v233
  v_lshlrev_b32 v232, 16, v139
  v_and_b32 v233, 0xffff0000, v139
  v_mul_f32 v232, v232, v238
  v_mul_f32 v233, v233, v238
  v_cvt_pk_bf16_f32 v139, v232, v233
  v_max3_f32 v232, v120, v121, v122
  v_max3_f32 v232, v232, v123, v124
  v_max3_f32 v232, v232, v125, v126
  v_max_f32 v232, v232, v127
  v_mov_b32 v233, v232
  s_nop 1
  v_permlane16_swap_b32 v232, v233
  s_nop 0
  v_max_f32 v232, v232, v233
  v_mov_b32 v233, v232
  s_nop 1
  v_permlane32_swap_b32 v232, v233
  s_nop 0
  v_max_f32 v232, v232, v233
  v_max_f32 v232, 0, v232
  v_ceil_f32 v232, v232
  v_min_f32 v233, 0x43480000, v232
  v_cvt_i32_f32 v233, v233
  v_sub_u32 v233, 0, v233
  v_ldexp_f32 v238, 1.0, v233
  v_mov_b32 v239, v238
  v_sub_f32 v120, v120, v232
  v_sub_f32 v121, v121, v232
  v_sub_f32 v122, v122, v232
  v_sub_f32 v123, v123, v232
  v_sub_f32 v124, v124, v232
  v_sub_f32 v125, v125, v232
  v_sub_f32 v126, v126, v232
  v_sub_f32 v127, v127, v232
  v_sub_f32 v132, v132, v232
  v_sub_f32 v133, v133, v232
  v_sub_f32 v134, v134, v232
  v_sub_f32 v135, v135, v232
  v_pk_mul_f32 v[8:9], v[8:9], v[238:239]
  v_pk_mul_f32 v[10:11], v[10:11], v[238:239]
  v_pk_mul_f32 v[12:13], v[12:13], v[238:239]
  v_pk_mul_f32 v[14:15], v[14:15], v[238:239]
  v_pk_mul_f32 v[24:25], v[24:25], v[238:239]
  v_pk_mul_f32 v[26:27], v[26:27], v[238:239]
  v_pk_mul_f32 v[28:29], v[28:29], v[238:239]
  v_pk_mul_f32 v[30:31], v[30:31], v[238:239]
  v_pk_mul_f32 v[40:41], v[40:41], v[238:239]
  v_pk_mul_f32 v[42:43], v[42:43], v[238:239]
  v_pk_mul_f32 v[44:45], v[44:45], v[238:239]
  v_pk_mul_f32 v[46:47], v[46:47], v[238:239]
  v_pk_mul_f32 v[56:57], v[56:57], v[238:239]
  v_pk_mul_f32 v[58:59], v[58:59], v[238:239]
  v_pk_mul_f32 v[60:61], v[60:61], v[238:239]
  v_pk_mul_f32 v[62:63], v[62:63], v[238:239]
  v_mul_f32 v230, v230, v238
  v_mul_f32 v231, v231, v238
  v_lshlrev_b32 v232, 16, v140
  v_and_b32 v233, 0xffff0000, v140
  v_mul_f32 v232, v232, v238
  v_mul_f32 v233, v233, v238
  v_cvt_pk_bf16_f32 v140, v232, v233
  v_lshlrev_b32 v232, 16, v141
  v_and_b32 v233, 0xffff0000, v141
  v_mul_f32 v232, v232, v238
  v_mul_f32 v233, v233, v238
  v_cvt_pk_bf16_f32 v141, v232, v233
  v_lshlrev_b32 v232, 16, v142
  v_and_b32 v233, 0xffff0000, v142
  v_mul_f32 v232, v232, v238
  v_mul_f32 v233, v233, v238
  v_cvt_pk_bf16_f32 v142, v232, v233
  v_lshlrev_b32 v232, 16, v143
  v_and_b32 v233, 0xffff0000, v143
  v_mul_f32 v232, v232, v238
  v_mul_f32 v233, v233, v238
  v_cvt_pk_bf16_f32 v143, v232, v233
  s_nop 1
  s_branch L_A_ret_f1
L_A_rare_b1:
  s_nop 15
  v_max3_f32 v232, v112, v113, v114
  v_max3_f32 v232, v232, v115, v116
  v_max3_f32 v232, v232, v117, v118
  v_max_f32 v232, v232, v119
  v_mov_b32 v233, v232
  s_nop 1
  v_permlane16_swap_b32 v232, v233
  s_nop 0
  v_max_f32 v232, v232, v233
  v_mov_b32 v233, v232
  s_nop 1
  v_permlane32_swap_b32 v232, v233
  s_nop 0
  v_max_f32 v232, v232, v233
  v_max_f32 v232, 0, v232
  v_ceil_f32 v232, v232
  v_min_f32 v233, 0x43480000, v232
  v_cvt_i32_f32 v233, v233
  v_sub_u32 v233, 0, v233
  v_ldexp_f32 v238, 1.0, v233
  v_mov_b32 v239, v238
  v_sub_f32 v112, v112, v232
  v_sub_f32 v113, v113, v232
  v_sub_f32 v114, v114, v232
  v_sub_f32 v115, v115, v232
  v_sub_f32 v116, v116, v232
  v_sub_f32 v117, v117, v232
  v_sub_f32 v118, v118, v232
  v_sub_f32 v119, v119, v232
  v_sub_f32 v128, v128, v232
  v_sub_f32 v129, v129, v232
  v_sub_f32 v130, v130, v232
  v_sub_f32 v131, v131, v232
  v_pk_mul_f32 v[0:1], v[0:1], v[238:239]
  v_pk_mul_f32 v[2:3], v[2:3], v[238:239]
  v_pk_mul_f32 v[4:5], v[4:5], v[238:239]
  v_pk_mul_f32 v[6:7], v[6:7], v[238:239]
  v_pk_mul_f32 v[16:17], v[16:17], v[238:239]
  v_pk_mul_f32 v[18:19], v[18:19], v[238:239]
  v_pk_mul_f32 v[20:21], v[20:21], v[238:239]
  v_pk_mul_f32 v[22:23], v[22:23], v[238:239]
  v_pk_mul_f32 v[32:33], v[32:33], v[238:239]
  v_pk_mul_f32 v[34:35], v[34:35], v[238:239]
  v_pk_mul_f32 v[36:37], v[36:37], v[238:239]
  v_pk_mul_f32 v[38:39], v[38:39], v[238:239]
  v_pk_mul_f32 v[48:49], v[48:49], v[238:239]
  v_pk_mul_f32 v[50:51], v[50:51], v[238:239]
  v_pk_mul_f32 v[52:53], v[52:53], v[238:239]
  v_pk_mul_f32 v[54:55], v[54:55], v[238:239]
  v_mul_f32 v228, v228, v238
  v_mul_f32 v229, v229, v238
  v_lshlrev_b32 v232, 16, v136
  v_and_b32 v233, 0xffff0000, v136
  v_mul_f32 v232, v232, v238
  v_mul_f32 v233, v233, v238
  v_cvt_pk_bf16_f32 v136, v232, v233
  v_lshlrev_b32 v232, 16, v137
  v_and_b32 v233, 0xffff0000, v137
  v_mul_f32 v232, v232, v238
  v_mul_f32 v233, v233, v238
  v_cvt_pk_bf16_f32 v137, v232, v233
  v_lshlrev_b32 v232, 16, v138
  v_and_b32 v233, 0xffff0000, v138
  v_mul_f32 v232, v232, v238
  v_mul_f32 v233, v233, v238
  v_cvt_pk_bf16_f32 v138, v232, v233
  v_lshlrev_b32 v232, 16, v139
  v_and_b32 v233, 0xffff0000, v139
  v_mul_f32 v232, v232, v238
  v_mul_f32 v233, v233, v238
  v_cvt_pk_bf16_f32 v139, v232, v233
  v_max3_f32 v232, v120, v121, v122
  v_max3_f32 v232, v232, v123, v124
  v_max3_f32 v232, v232, v125, v126
  v_max_f32 v232, v232, v127
  v_mov_b32 v233, v232
  s_nop 1
  v_permlane16_swap_b32 v232, v233
  s_nop 0
  v_max_f32 v232, v232, v233
  v_mov_b32 v233, v232
  s_nop 1
  v_permlane32_swap_b32 v232, v233
  s_nop 0
  v_max_f32 v232, v232, v233
  v_max_f32 v232, 0, v232
  v_ceil_f32 v232, v232
  v_min_f32 v233, 0x43480000, v232
  v_cvt_i32_f32 v233, v233
  v_sub_u32 v233, 0, v233
  v_ldexp_f32 v238, 1.0, v233
  v_mov_b32 v239, v238
  v_sub_f32 v120, v120, v232
  v_sub_f32 v121, v121, v232
  v_sub_f32 v122, v122, v232
  v_sub_f32 v123, v123, v232
  v_sub_f32 v124, v124, v232
  v_sub_f32 v125, v125, v232
  v_sub_f32 v126, v126, v232
  v_sub_f32 v127, v127, v232
  v_sub_f32 v132, v132, v232
  v_sub_f32 v133, v133, v232
  v_sub_f32 v134, v134, v232
  v_sub_f32 v135, v135, v232
  v_pk_mul_f32 v[8:9], v[8:9], v[238:239]
  v_pk_mul_f32 v[10:11], v[10:11], v[238:239]
  v_pk_mul_f32 v[12:13], v[12:13], v[238:239]
  v_pk_mul_f32 v[14:15], v[14:15], v[238:239]
  v_pk_mul_f32 v[24:25], v[24:25], v[238:239]
  v_pk_mul_f32 v[26:27], v[26:27], v[238:239]
  v_pk_mul_f32 v[28:29], v[28:29], v[238:239]
  v_pk_mul_f32 v[30:31], v[30:31], v[238:239]
  v_pk_mul_f32 v[40:41], v[40:41], v[238:239]
  v_pk_mul_f32 v[42:43], v[42:43], v[238:239]
  v_pk_mul_f32 v[44:45], v[44:45], v[238:239]
  v_pk_mul_f32 v[46:47], v[46:47], v[238:239]
  v_pk_mul_f32 v[56:57], v[56:57], v[238:239]
  v_pk_mul_f32 v[58:59], v[58:59], v[238:239]
  v_pk_mul_f32 v[60:61], v[60:61], v[238:239]
  v_pk_mul_f32 v[62:63], v[62:63], v[238:239]
  v_mul_f32 v230, v230, v238
  v_mul_f32 v231, v231, v238
  v_lshlrev_b32 v232, 16, v140
  v_and_b32 v233, 0xffff0000, v140
  v_mul_f32 v232, v232, v238
  v_mul_f32 v233, v233, v238
  v_cvt_pk_bf16_f32 v140, v232, v233
  v_lshlrev_b32 v232, 16, v141
  v_and_b32 v233, 0xffff0000, v141
  v_mul_f32 v232, v232, v238
  v_mul_f32 v233, v233, v238
  v_cvt_pk_bf16_f32 v141, v232, v233
  v_lshlrev_b32 v232, 16, v142
  v_and_b32 v233, 0xffff0000, v142
  v_mul_f32 v232, v232, v238
  v_mul_f32 v233, v233, v238
  v_cvt_pk_bf16_f32 v142, v232, v233
  v_lshlrev_b32 v232, 16, v143
  v_and_b32 v233, 0xffff0000, v143
  v_mul_f32 v232, v232, v238
  v_mul_f32 v233, v233, v238
  v_cvt_pk_bf16_f32 v143, v232, v233
  s_nop 1
  s_branch L_A_ret_b1
L_A_rare_b2:
  s_nop 15
  v_max3_f32 v232, v96, v97, v98
  v_max3_f32 v232, v232, v99, v100
  v_max3_f32 v232, v232, v101, v102
  v_max_f32 v232, v232, v103
  v_mov_b32 v233, v232
  s_nop 1
  v_permlane16_swap_b32 v232, v233
  s_nop 0
  v_max_f32 v232, v232, v233
  v_mov_b32 v233, v232
  s_nop 1
  v_permlane32_swap_b32 v232, v233
  s_nop 0
  v_max_f32 v232, v232, v233
  v_max_f32 v232, 0, v232
  v_ceil_f32 v232, v232
  v_min_f32 v233, 0x43480000, v232
  v_cvt_i32_f32 v233, v233
  v_sub_u32 v233, 0, v233
  v_ldexp_f32 v238, 1.0, v233
  v_mov_b32 v239, v238
  v_sub_f32 v96, v96, v232
  v_sub_f32 v97, v97, v232
  v_sub_f32 v98, v98, v232
  v_sub_f32 v99, v99, v232
  v_sub_f32 v100, v100, v232
  v_sub_f32 v101, v101, v232
  v_sub_f32 v102, v102, v232
  v_sub_f32 v103, v103, v232
  v_sub_f32 v128, v128, v232
  v_sub_f32 v129, v129, v232
  v_sub_f32 v130, v130, v232
  v_sub_f32 v131, v131, v232
  v_pk_mul_f32 v[0:1], v[0:1], v[238:239]
  v_pk_mul_f32 v[2:3], v[2:3], v[238:239]
  v_pk_mul_f32 v[4:5], v[4:5], v[238:239]
  v_pk_mul_f32 v[6:7], v[6:7], v[238:239]
  v_pk_mul_f32 v[16:17], v[16:17], v[238:239]
  v_pk_mul_f32 v[18:19], v[18:19], v[238:239]
  v_pk_mul_f32 v[20:21], v[20:21], v[238:239]
  v_pk_mul_f32 v[22:23], v[22:23], v[238:239]
  v_pk_mul_f32 v[32:33], v[32:33], v[238:239]
  v_pk_mul_f32 v[34:35], v[34:35], v[238:239]
  v_pk_mul_f32 v[36:37], v[36:37], v[238:239]
  v_pk_mul_f32 v[38:39], v[38:39], v[238:239]
  v_pk_mul_f32 v[48:49], v[48:49], v[238:239]
  v_pk_mul_f32 v[50:51], v[50:51], v[238:239]
  v_pk_mul_f32 v[52:53], v[52:53], v[238:239]
  v_pk_mul_f32 v[54:55], v[54:55], v[238:239]
  v_mul_f32 v228, v228, v238
  v_mul_f32 v229, v229, v238
  v_lshlrev_b32 v232, 16, v144
  v_and_b32 v233, 0xffff0000, v144
  v_mul_f32 v232, v232, v238
  v_mul_f32 v233, v233, v238
  v_cvt_pk_bf16_f32 v144, v232, v233
  v_lshlrev_b32 v232, 16, v145
  v_and_b32 v233, 0xffff0000, v145
  v_mul_f32 v232, v232, v238
  v_mul_f32 v233, v233, v238
  v_cvt_pk_bf16_f32 v145, v232, v233
  v_lshlrev_b32 v232, 16, v146
  v_and_b32 v233, 0xffff0000, v146
  v_mul_f32 v232, v232, v238
  v_mul_f32 v233, v233, v238
  v_cvt_pk_bf16_f32 v146, v232, v233
  v_lshlrev_b32 v232, 16, v147
  v_and_b32 v233, 0xffff0000, v147
  v_mul_f32 v232, v232, v238
  v_mul_f32 v233, v233, v238
  v_cvt_pk_bf16_f32 v147, v232, v233
  v_max3_f32 v232, v104, v105, v106
  v_max3_f32 v232, v232, v107, v108
  v_max3_f32 v232, v232, v109, v110
  v_max_f32 v232, v232, v111
  v_mov_b32 v233, v232
  s_nop 1
  v_permlane16_swap_b32 v232, v233
  s_nop 0
  v_max_f32 v232, v232, v233
  v_mov_b32 v233, v232
  s_nop 1
  v_permlane32_swap_b32 v232, v233
  s_nop 0
  v_max_f32 v232, v232, v233
  v_max_f32 v232, 0, v232
  v_ceil_f32 v232, v232
  v_min_f32 v233, 0x43480000, v232
  v_cvt_i32_f32 v233, v233
  v_sub_u32 v233, 0, v233
  v_ldexp_f32 v238, 1.0, v233
  v_mov_b32 v239, v238
  v_sub_f32 v104, v104, v232
  v_sub_f32 v105, v105, v232
  v_sub_f32 v106, v106, v232
  v_sub_f32 v107, v107, v232
  v_sub_f32 v108, v108, v232
  v_sub_f32 v109, v109, v232
  v_sub_f32 v110, v110, v232
  v_sub_f32 v111, v111, v232
  v_sub_f32 v132, v132, v232
  v_sub_f32 v133, v133, v232
  v_sub_f32 v134, v134, v232
  v_sub_f32 v135, v135, v232
  v_pk_mul_f32 v[8:9], v[8:9], v[238:239]
  v_pk_mul_f32 v[10:11], v[10:11], v[238:239]
  v_pk_mul_f32 v[12:13], v[12:13], v[238:239]
  v_pk_mul_f32 v[14:15], v[14:15], v[238:239]
  v_pk_mul_f32 v[24:25], v[24:25], v[238:239]
  v_pk_mul_f32 v[26:27], v[26:27], v[238:239]
  v_pk_mul_f32 v[28:29], v[28:29], v[238:239]
  v_pk_mul_f32 v[30:31], v[30:31], v[238:239]
  v_pk_mul_f32 v[40:41], v[40:41], v[238:239]
  v_pk_mul_f32 v[42:43], v[42:43], v[238:239]
  v_pk_mul_f32 v[44:45], v[44:45], v[238:239]
  v_pk_mul_f32 v[46:47], v[46:47], v[238:239]
  v_pk_mul_f32 v[56:57], v[56:57], v[238:239]
  v_pk_mul_f32 v[58:59], v[58:59], v[238:239]
  v_pk_mul_f32 v[60:61], v[60:61], v[238:239]
  v_pk_mul_f32 v[62:63], v[62:63], v[238:239]
  v_mul_f32 v230, v230, v238
  v_mul_f32 v231, v231, v238
  v_lshlrev_b32 v232, 16, v148
  v_and_b32 v233, 0xffff0000, v148
  v_mul_f32 v232, v232, v238
  v_mul_f32 v233, v233, v238
  v_cvt_pk_bf16_f32 v148, v232, v233
  v_lshlrev_b32 v232, 16, v149
  v_and_b32 v233, 0xffff0000, v149
  v_mul_f32 v232, v232, v238
  v_mul_f32 v233, v233, v238
  v_cvt_pk_bf16_f32 v149, v232, v233
  v_lshlrev_b32 v232, 16, v150
  v_and_b32 v233, 0xffff0000, v150
  v_mul_f32 v232, v232, v238
  v_mul_f32 v233, v233, v238
  v_cvt_pk_bf16_f32 v150, v232, v233
  v_lshlrev_b32 v232, 16, v151
  v_and_b32 v233, 0xffff0000, v151
  v_mul_f32 v232, v232, v238
  v_mul_f32 v233, v233, v238
  v_cvt_pk_bf16_f32 v151, v232, v233
  s_nop 1
  s_branch L_A_ret_b2
L_A_rare_0:
  s_nop 15
  v_max3_f32 v232, v96, v97, v98
  v_max3_f32 v232, v232, v99, v100
  v_max3_f32 v232, v232, v101, v102
  v_max_f32 v232, v232, v103
  v_mov_b32 v233, v232
  s_nop 1
  v_permlane16_swap_b32 v232, v233
  s_nop 0
  v_max_f32 v232, v232, v233
  v_mov_b32 v233, v232
  s_nop 1
  v_permlane32_swap_b32 v232, v233
  s_nop 0
  v_max_f32 v232, v232, v233
  v_max_f32 v232, 0, v232
  v_ceil_f32 v232, v232
  v_min_f32 v233, 0x43480000, v232
  v_cvt_i32_f32 v233, v233
  v_sub_u32 v233, 0, v233
  v_ldexp_f32 v238, 1.0, v233
  v_mov_b32 v239, v238
  v_sub_f32 v96, v96, v232
  v_sub_f32 v97, v97, v232
  v_sub_f32 v98, v98, v232
  v_sub_f32 v99, v99, v232
  v_sub_f32 v100, v100, v232
  v_sub_f32 v101, v101, v232
  v_sub_f32 v102, v102, v232
  v_sub_f32 v103, v103, v232
  v_sub_f32 v128, v128, v232
  v_sub_f32 v129, v129, v232
  v_sub_f32 v130, v130, v232
  v_sub_f32 v131, v131, v232
  v_pk_mul_f32 v[0:1], v[0:1], v[238:239]
  v_pk_mul_f32 v[2:3], v[2:3], v[238:239]
  v_pk_mul_f32 v[4:5], v[4:5], v[238:239]
  v_pk_mul_f32 v[6:7], v[6:7], v[238:239]
  v_pk_mul_f32 v[16:17], v[16:17], v[238:239]
  v_pk_mul_f32 v[18:19], v[18:19], v[238:239]
  v_pk_mul_f32 v[20:21], v[20:21], v[238:239]
  v_pk_mul_f32 v[22:23], v[22:23], v[238:239]
  v_pk_mul_f32 v[32:33], v[32:33], v[238:239]
  v_pk_mul_f32 v[34:35], v[34:35], v[238:239]
  v_pk_mul_f32 v[36:37], v[36:37], v[238:239]
  v_pk_mul_f32 v[38:39], v[38:39], v[238:239]
  v_pk_mul_f32 v[48:49], v[48:49], v[238:239]
  v_pk_mul_f32 v[50:51], v[50:51], v[238:239]
  v_pk_mul_f32 v[52:53], v[52:53], v[238:239]
  v_pk_mul_f32 v[54:55], v[54:55], v[238:239]
  v_mul_f32 v228, v228, v238
  v_mul_f32 v229, v229, v238
  v_lshlrev_b32 v232, 16, v144
  v_and_b32 v233, 0xffff0000, v144
  v_mul_f32 v232, v232, v238
  v_mul_f32 v233, v233, v238
  v_cvt_pk_bf16_f32 v144, v232, v233
  v_lshlrev_b32 v232, 16, v145
  v_and_b32 v233, 0xffff0000, v145
  v_mul_f32 v232, v232, v238
  v_mul_f32 v233, v233, v238
  v_cvt_pk_bf16_f32 v145, v232, v233
  v_lshlrev_b32 v232, 16, v146
  v_and_b32 v233, 0xffff0000, v146
  v_mul_f32 v232, v232, v238
  v_mul_f32 v233, v233, v238
  v_cvt_pk_bf16_f32 v146, v232, v233
  v_lshlrev_b32 v232, 16, v147
  v_and_b32 v233, 0xffff0000, v147
  v_mul_f32 v232, v232, v238
  v_mul_f32 v233, v233, v238
  v_cvt_pk_bf16_f32 v147, v232, v233
  v_max3_f32 v232, v104, v105, v106
  v_max3_f32 v232, v232, v107, v108
  v_max3_f32 v232, v232, v109, v110
  v_max_f32 v232, v232, v111
  v_mov_b32 v233, v232
  s_nop 1
  v_permlane16_swap_b32 v232, v233
  s_nop 0
  v_max_f32 v232, v232, v233
  v_mov_b32 v233, v232
  s_nop 1
  v_permlane32_swap_b32 v232, v233
  s_nop 0
  v_max_f32 v232, v232, v233
  v_max_f32 v232, 0, v232
  v_ceil_f32 v232, v232
  v_min_f32 v233, 0x43480000, v232
  v_cvt_i32_f32 v233, v233
  v_sub_u32 v233, 0, v233
  v_ldexp_f32 v238, 1.0, v233
  v_mov_b32 v239, v238
  v_sub_f32 v104, v104, v232
  v_sub_f32 v105, v105, v232
  v_sub_f32 v106, v106, v232
  v_sub_f32 v107, v107, v232
  v_sub_f32 v108, v108, v232
  v_sub_f32 v109, v109, v232
  v_sub_f32 v110, v110, v232
  v_sub_f32 v111, v111, v232
  v_sub_f32 v132, v132, v232
  v_sub_f32 v133, v133, v232
  v_sub_f32 v134, v134, v232
  v_sub_f32 v135, v135, v232
  v_pk_mul_f32 v[8:9], v[8:9], v[238:239]
  v_pk_mul_f32 v[10:11], v[10:11], v[238:239]
  v_pk_mul_f32 v[12:13], v[12:13], v[238:239]
  v_pk_mul_f32 v[14:15], v[14:15], v[238:239]
  v_pk_mul_f32 v[24:25], v[24:25], v[238:239]
  v_pk_mul_f32 v[26:27], v[26:27], v[238:239]
  v_pk_mul_f32 v[28:29], v[28:29], v[238:239]
  v_pk_mul_f32 v[30:31], v[30:31], v[238:239]
  v_pk_mul_f32 v[40:41], v[40:41], v[238:239]
  v_pk_mul_f32 v[42:43], v[42:43], v[238:239]
  v_pk_mul_f32 v[44:45], v[44:45], v[238:239]
  v_pk_mul_f32 v[46:47], v[46:47], v[238:239]
  v_pk_mul_f32 v[56:57], v[56:57], v[238:239]
  v_pk_mul_f32 v[58:59], v[58:59], v[238:239]
  v_pk_mul_f32 v[60:61], v[60:61], v[238:239]
  v_pk_mul_f32 v[62:63], v[62:63], v[238:239]
  v_mul_f32 v230, v230, v238
  v_mul_f32 v231, v231, v238
  v_lshlrev_b32 v232, 16, v148
  v_and_b32 v233, 0xffff0000, v148
  v_mul_f32 v232, v232, v238
  v_mul_f32 v233, v233, v238
  v_cvt_pk_bf16_f32 v148, v232, v233
  v_lshlrev_b32 v232, 16, v149
  v_and_b32 v233, 0xffff0000, v149
  v_mul_f32 v232, v232, v238
  v_mul_f32 v233, v233, v238
  v_cvt_pk_bf16_f32 v149, v232, v233
  v_lshlrev_b32 v232, 16, v150
  v_and_b32 v233, 0xffff0000, v150
  v_mul_f32 v232, v232, v238
  v_mul_f32 v233, v233, v238
  v_cvt_pk_bf16_f32 v150, v232, v233
  v_lshlrev_b32 v232, 16, v151
  v_and_b32 v233, 0xffff0000, v151
  v_mul_f32 v232, v232, v238
  v_mul_f32 v233, v233, v238
  v_cvt_pk_bf16_f32 v151, v232, v233
  s_nop 1
  s_branch L_A_ret_0
L_A_rare_1:
  s_nop 15
  v_max3_f32 v232, v112, v113, v114
  v_max3_f32 v232, v232, v115, v116
  v_max3_f32 v232, v232, v117, v118
  v_max_f32 v232, v232, v119
  v_mov_b32 v233, v232
  s_nop 1
  v_permlane16_swap_b32 v232, v233
  s_nop 0
  v_max_f32 v232, v232, v233
  v_mov_b32 v233, v232
  s_nop 1
  v_permlane32_swap_b32 v232, v233
  s_nop 0
  v_max_f32 v232, v232, v233
  v_max_f32 v232, 0, v232
  v_ceil_f32 v232, v232
  v_min_f32 v233, 0x43480000, v232
  v_cvt_i32_f32 v233, v233
  v_sub_u32 v233, 0, v233
  v_ldexp_f32 v238, 1.0, v233
  v_mov_b32 v239, v238
  v_sub_f32 v112, v112, v232
  v_sub_f32 v113, v113, v232
  v_sub_f32 v114, v114, v232
  v_sub_f32 v115, v115, v232
  v_sub_f32 v116, v116, v232
  v_sub_f32 v117, v117, v232
  v_sub_f32 v118, v118, v232
  v_sub_f32 v119, v119, v232
  v_sub_f32 v128, v128, v232
  v_sub_f32 v129, v129, v232
  v_sub_f32 v130, v130, v232
  v_sub_f32 v131, v131, v232
  v_pk_mul_f32 v[0:1], v[0:1], v[238:239]
  v_pk_mul_f32 v[2:3], v[2:3], v[238:239]
  v_pk_mul_f32 v[4:5], v[4:5], v[238:239]
  v_pk_mul_f32 v[6:7], v[6:7], v[238:239]
  v_pk_mul_f32 v[16:17], v[16:17], v[238:239]
  v_pk_mul_f32 v[18:19], v[18:19], v[238:239]
  v_pk_mul_f32 v[20:21], v[20:21], v[238:239]
  v_pk_mul_f32 v[22:23], v[22:23], v[238:239]
  v_pk_mul_f32 v[32:33], v[32:33], v[238:239]
  v_pk_mul_f32 v[34:35], v[34:35], v[238:239]
  v_pk_mul_f32 v[36:37], v[36:37], v[238:239]
  v_pk_mul_f32 v[38:39], v[38:39], v[238:239]
  v_pk_mul_f32 v[48:49], v[48:49], v[238:239]
  v_pk_mul_f32 v[50:51], v[50:51], v[238:239]
  v_pk_mul_f32 v[52:53], v[52:53], v[238:239]
  v_pk_mul_f32 v[54:55], v[54:55], v[238:239]
  v_mul_f32 v228, v228, v238
  v_mul_f32 v229, v229, v238
  v_lshlrev_b32 v232, 16, v136
  v_and_b32 v233, 0xffff0000, v136
  v_mul_f32 v232, v232, v238
  v_mul_f32 v233, v233, v238
  v_cvt_pk_bf16_f32 v136, v232, v233
  v_lshlrev_b32 v232, 16, v137
  v_and_b32 v233, 0xffff0000, v137
  v_mul_f32 v232, v232, v238
  v_mul_f32 v233, v233, v238
  v_cvt_pk_bf16_f32 v137, v232, v233
  v_lshlrev_b32 v232, 16, v138
  v_and_b32 v233, 0xffff0000, v138
  v_mul_f32 v232, v232, v238
  v_mul_f32 v233, v233, v238
  v_cvt_pk_bf16_f32 v138, v232, v233
  v_lshlrev_b32 v232, 16, v139
  v_and_b32 v233, 0xffff0000, v139
  v_mul_f32 v232, v232, v238
  v_mul_f32 v233, v233, v238
  v_cvt_pk_bf16_f32 v139, v232, v233
  v_max3_f32 v232, v120, v121, v122
  v_max3_f32 v232, v232, v123, v124
  v_max3_f32 v232, v232, v125, v126
  v_max_f32 v232, v232, v127
  v_mov_b32 v233, v232
  s_nop 1
  v_permlane16_swap_b32 v232, v233
  s_nop 0
  v_max_f32 v232, v232, v233
  v_mov_b32 v233, v232
  s_nop 1
  v_permlane32_swap_b32 v232, v233
  s_nop 0
  v_max_f32 v232, v232, v233
  v_max_f32 v232, 0, v232
  v_ceil_f32 v232, v232
  v_min_f32 v233, 0x43480000, v232
  v_cvt_i32_f32 v233, v233
  v_sub_u32 v233, 0, v233
  v_ldexp_f32 v238, 1.0, v233
  v_mov_b32 v239, v238
  v_sub_f32 v120, v120, v232
  v_sub_f32 v121, v121, v232
  v_sub_f32 v122, v122, v232
  v_sub_f32 v123, v123, v232
  v_sub_f32 v124, v124, v232
  v_sub_f32 v125, v125, v232
  v_sub_f32 v126, v126, v232
  v_sub_f32 v127, v127, v232
  v_sub_f32 v132, v132, v232
  v_sub_f32 v133, v133, v232
  v_sub_f32 v134, v134, v232
  v_sub_f32 v135, v135, v232
  v_pk_mul_f32 v[8:9], v[8:9], v[238:239]
  v_pk_mul_f32 v[10:11], v[10:11], v[238:239]
  v_pk_mul_f32 v[12:13], v[12:13], v[238:239]
  v_pk_mul_f32 v[14:15], v[14:15], v[238:239]
  v_pk_mul_f32 v[24:25], v[24:25], v[238:239]
  v_pk_mul_f32 v[26:27], v[26:27], v[238:239]
  v_pk_mul_f32 v[28:29], v[28:29], v[238:239]
  v_pk_mul_f32 v[30:31], v[30:31], v[238:239]
  v_pk_mul_f32 v[40:41], v[40:41], v[238:239]
  v_pk_mul_f32 v[42:43], v[42:43], v[238:239]
  v_pk_mul_f32 v[44:45], v[44:45], v[238:239]
  v_pk_mul_f32 v[46:47], v[46:47], v[238:239]
  v_pk_mul_f32 v[56:57], v[56:57], v[238:239]
  v_pk_mul_f32 v[58:59], v[58:59], v[238:239]
  v_pk_mul_f32 v[60:61], v[60:61], v[238:239]
  v_pk_mul_f32 v[62:63], v[62:63], v[238:239]
  v_mul_f32 v230, v230, v238
  v_mul_f32 v231, v231, v238
  v_lshlrev_b32 v232, 16, v140
  v_and_b32 v233, 0xffff0000, v140
  v_mul_f32 v232, v232, v238
  v_mul_f32 v233, v233, v238
  v_cvt_pk_bf16_f32 v140, v232, v233
  v_lshlrev_b32 v232, 16, v141
  v_and_b32 v233, 0xffff0000, v141
  v_mul_f32 v232, v232, v238
  v_mul_f32 v233, v233, v238
  v_cvt_pk_bf16_f32 v141, v232, v233
  v_lshlrev_b32 v232, 16, v142
  v_and_b32 v233, 0xffff0000, v142
  v_mul_f32 v232, v232, v238
  v_mul_f32 v233, v233, v238
  v_cvt_pk_bf16_f32 v142, v232, v233
  v_lshlrev_b32 v232, 16, v143
  v_and_b32 v233, 0xffff0000, v143
  v_mul_f32 v232, v232, v238
  v_mul_f32 v233, v233, v238
  v_cvt_pk_bf16_f32 v143, v232, v233
  s_nop 1
  s_branch L_A_ret_1
L_A_rare_2:
  s_nop 15
  v_max3_f32 v232, v96, v97, v98
  v_max3_f32 v232, v232, v99, v100
  v_max3_f32 v232, v232, v101, v102
  v_max_f32 v232, v232, v103
  v_mov_b32 v233, v232
  s_nop 1
  v_permlane16_swap_b32 v232, v233
  s_nop 0
  v_max_f32 v232, v232, v233
  v_mov_b32 v233, v232
  s_nop 1
  v_permlane32_swap_b32 v232, v233
  s_nop 0
  v_max_f32 v232, v232, v233
  v_max_f32 v232, 0, v232
  v_ceil_f32 v232, v232
  v_min_f32 v233, 0x43480000, v232
  v_cvt_i32_f32 v233, v233
  v_sub_u32 v233, 0, v233
  v_ldexp_f32 v238, 1.0, v233
  v_mov_b32 v239, v238
  v_sub_f32 v96, v96, v232
  v_sub_f32 v97, v97, v232
  v_sub_f32 v98, v98, v232
  v_sub_f32 v99, v99, v232
  v_sub_f32 v100, v100, v232
  v_sub_f32 v101, v101, v232
  v_sub_f32 v102, v102, v232
  v_sub_f32 v103, v103, v232
  v_sub_f32 v128, v128, v232
  v_sub_f32 v129, v129, v232
  v_sub_f32 v130, v130, v232
  v_sub_f32 v131, v131, v232
  v_pk_mul_f32 v[0:1], v[0:1], v[238:239]
  v_pk_mul_f32 v[2:3], v[2:3], v[238:239]
  v_pk_mul_f32 v[4:5], v[4:5], v[238:239]
  v_pk_mul_f32 v[6:7], v[6:7], v[238:239]
  v_pk_mul_f32 v[16:17], v[16:17], v[238:239]
  v_pk_mul_f32 v[18:19], v[18:19], v[238:239]
  v_pk_mul_f32 v[20:21], v[20:21], v[238:239]
  v_pk_mul_f32 v[22:23], v[22:23], v[238:239]
  v_pk_mul_f32 v[32:33], v[32:33], v[238:239]
  v_pk_mul_f32 v[34:35], v[34:35], v[238:239]
  v_pk_mul_f32 v[36:37], v[36:37], v[238:239]
  v_pk_mul_f32 v[38:39], v[38:39], v[238:239]
  v_pk_mul_f32 v[48:49], v[48:49], v[238:239]
  v_pk_mul_f32 v[50:51], v[50:51], v[238:239]
  v_pk_mul_f32 v[52:53], v[52:53], v[238:239]
  v_pk_mul_f32 v[54:55], v[54:55], v[238:239]
  v_mul_f32 v228, v228, v238
  v_mul_f32 v229, v229, v238
  v_lshlrev_b32 v232, 16, v144
  v_and_b32 v233, 0xffff0000, v144
  v_mul_f32 v232, v232, v238
  v_mul_f32 v233, v233, v238
  v_cvt_pk_bf16_f32 v144, v232, v233
  v_lshlrev_b32 v232, 16, v145
  v_and_b32 v233, 0xffff0000, v145
  v_mul_f32 v232, v232, v238
  v_mul_f32 v233, v233, v238
  v_cvt_pk_bf16_f32 v145, v232, v233
  v_lshlrev_b32 v232, 16, v146
  v_and_b32 v233, 0xffff0000, v146
  v_mul_f32 v232, v232, v238
  v_mul_f32 v233, v233, v238
  v_cvt_pk_bf16_f32 v146, v232, v233
  v_lshlrev_b32 v232, 16, v147
  v_and_b32 v233, 0xffff0000, v147
  v_mul_f32 v232, v232, v238
  v_mul_f32 v233, v233, v238
  v_cvt_pk_bf16_f32 v147, v232, v233
  v_max3_f32 v232, v104, v105, v106
  v_max3_f32 v232, v232, v107, v108
  v_max3_f32 v232, v232, v109, v110
  v_max_f32 v232, v232, v111
  v_mov_b32 v233, v232
  s_nop 1
  v_permlane16_swap_b32 v232, v233
  s_nop 0
  v_max_f32 v232, v232, v233
  v_mov_b32 v233, v232
  s_nop 1
  v_permlane32_swap_b32 v232, v233
  s_nop 0
  v_max_f32 v232, v232, v233
  v_max_f32 v232, 0, v232
  v_ceil_f32 v232, v232
  v_min_f32 v233, 0x43480000, v232
  v_cvt_i32_f32 v233, v233
  v_sub_u32 v233, 0, v233
  v_ldexp_f32 v238, 1.0, v233
  v_mov_b32 v239, v238
  v_sub_f32 v104, v104, v232
  v_sub_f32 v105, v105, v232
  v_sub_f32 v106, v106, v232
  v_sub_f32 v107, v107, v232
  v_sub_f32 v108, v108, v232
  v_sub_f32 v109, v109, v232
  v_sub_f32 v110, v110, v232
  v_sub_f32 v111, v111, v232
  v_sub_f32 v132, v132, v232
  v_sub_f32 v133, v133, v232
  v_sub_f32 v134, v134, v232
  v_sub_f32 v135, v135, v232
  v_pk_mul_f32 v[8:9], v[8:9], v[238:239]
  v_pk_mul_f32 v[10:11], v[10:11], v[238:239]
  v_pk_mul_f32 v[12:13], v[12:13], v[238:239]
  v_pk_mul_f32 v[14:15], v[14:15], v[238:239]
  v_pk_mul_f32 v[24:25], v[24:25], v[238:239]
  v_pk_mul_f32 v[26:27], v[26:27], v[238:239]
  v_pk_mul_f32 v[28:29], v[28:29], v[238:239]
  v_pk_mul_f32 v[30:31], v[30:31], v[238:239]
  v_pk_mul_f32 v[40:41], v[40:41], v[238:239]
  v_pk_mul_f32 v[42:43], v[42:43], v[238:239]
  v_pk_mul_f32 v[44:45], v[44:45], v[238:239]
  v_pk_mul_f32 v[46:47], v[46:47], v[238:239]
  v_pk_mul_f32 v[56:57], v[56:57], v[238:239]
  v_pk_mul_f32 v[58:59], v[58:59], v[238:239]
  v_pk_mul_f32 v[60:61], v[60:61], v[238:239]
  v_pk_mul_f32 v[62:63], v[62:63], v[238:239]
  v_mul_f32 v230, v230, v238
  v_mul_f32 v231, v231, v238
  v_lshlrev_b32 v232, 16, v148
  v_and_b32 v233, 0xffff0000, v148
  v_mul_f32 v232, v232, v238
  v_mul_f32 v233, v233, v238
  v_cvt_pk_bf16_f32 v148, v232, v233
  v_lshlrev_b32 v232, 16, v149
  v_and_b32 v233, 0xffff0000, v149
  v_mul_f32 v232, v232, v238
  v_mul_f32 v233, v233, v238
  v_cvt_pk_bf16_f32 v149, v232, v233
  v_lshlrev_b32 v232, 16, v150
  v_and_b32 v233, 0xffff0000, v150
  v_mul_f32 v232, v232, v238
  v_mul_f32 v233, v233, v238
  v_cvt_pk_bf16_f32 v150, v232, v233
  v_lshlrev_b32 v232, 16, v151
  v_and_b32 v233, 0xffff0000, v151
  v_mul_f32 v232, v232, v238
  v_mul_f32 v233, v233, v238
  v_cvt_pk_bf16_f32 v151, v232, v233
  s_nop 1
  s_branch L_A_ret_2
L_A_rare_3:
  s_nop 15
  v_max3_f32 v232, v112, v113, v114
  v_max3_f32 v232, v232, v115, v116
  v_max3_f32 v232, v232, v117, v118
  v_max_f32 v232, v232, v119
  v_mov_b32 v233, v232
  s_nop 1
  v_permlane16_swap_b32 v232, v233
  s_nop 0
  v_max_f32 v232, v232, v233
  v_mov_b32 v233, v232
  s_nop 1
  v_permlane32_swap_b32 v232, v233
  s_nop 0
  v_max_f32 v232, v232, v233
  v_max_f32 v232, 0, v232
  v_ceil_f32 v232, v232
  v_min_f32 v233, 0x43480000, v232
  v_cvt_i32_f32 v233, v233
  v_sub_u32 v233, 0, v233
  v_ldexp_f32 v238, 1.0, v233
  v_mov_b32 v239, v238
  v_sub_f32 v112, v112, v232
  v_sub_f32 v113, v113, v232
  v_sub_f32 v114, v114, v232
  v_sub_f32 v115, v115, v232
  v_sub_f32 v116, v116, v232
  v_sub_f32 v117, v117, v232
  v_sub_f32 v118, v118, v232
  v_sub_f32 v119, v119, v232
  v_sub_f32 v128, v128, v232
  v_sub_f32 v129, v129, v232
  v_sub_f32 v130, v130, v232
  v_sub_f32 v131, v131, v232
  v_pk_mul_f32 v[0:1], v[0:1], v[238:239]
  v_pk_mul_f32 v[2:3], v[2:3], v[238:239]
  v_pk_mul_f32 v[4:5], v[4:5], v[238:239]
  v_pk_mul_f32 v[6:7], v[6:7], v[238:239]
  v_pk_mul_f32 v[16:17], v[16:17], v[238:239]
  v_pk_mul_f32 v[18:19], v[18:19], v[238:239]
  v_pk_mul_f32 v[20:21], v[20:21], v[238:239]
  v_pk_mul_f32 v[22:23], v[22:23], v[238:239]
  v_pk_mul_f32 v[32:33], v[32:33], v[238:239]
  v_pk_mul_f32 v[34:35], v[34:35], v[238:239]
  v_pk_mul_f32 v[36:37], v[36:37], v[238:239]
  v_pk_mul_f32 v[38:39], v[38:39], v[238:239]
  v_pk_mul_f32 v[48:49], v[48:49], v[238:239]
  v_pk_mul_f32 v[50:51], v[50:51], v[238:239]
  v_pk_mul_f32 v[52:53], v[52:53], v[238:239]
  v_pk_mul_f32 v[54:55], v[54:55], v[238:239]
  v_mul_f32 v228, v228, v238
  v_mul_f32 v229, v229, v238
  v_lshlrev_b32 v232, 16, v136
  v_and_b32 v233, 0xffff0000, v136
  v_mul_f32 v232, v232, v238
  v_mul_f32 v233, v233, v238
  v_cvt_pk_bf16_f32 v136, v232, v233
  v_lshlrev_b32 v232, 16, v137
  v_and_b32 v233, 0xffff0000, v137
  v_mul_f32 v232, v232, v238
  v_mul_f32 v233, v233, v238
  v_cvt_pk_bf16_f32 v137, v232, v233
  v_lshlrev_b32 v232, 16, v138
  v_and_b32 v233, 0xffff0000, v138
  v_mul_f32 v232, v232, v238
  v_mul_f32 v233, v233, v238
  v_cvt_pk_bf16_f32 v138, v232, v233
  v_lshlrev_b32 v232, 16, v139
  v_and_b32 v233, 0xffff0000, v139
  v_mul_f32 v232, v232, v238
  v_mul_f32 v233, v233, v238
  v_cvt_pk_bf16_f32 v139, v232, v233
  v_max3_f32 v232, v120, v121, v122
  v_max3_f32 v232, v232, v123, v124
  v_max3_f32 v232, v232, v125, v126
  v_max_f32 v232, v232, v127
  v_mov_b32 v233, v232
  s_nop 1
  v_permlane16_swap_b32 v232, v233
  s_nop 0
  v_max_f32 v232, v232, v233
  v_mov_b32 v233, v232
  s_nop 1
  v_permlane32_swap_b32 v232, v233
  s_nop 0
  v_max_f32 v232, v232, v233
  v_max_f32 v232, 0, v232
  v_ceil_f32 v232, v232
  v_min_f32 v233, 0x43480000, v232
  v_cvt_i32_f32 v233, v233
  v_sub_u32 v233, 0, v233
  v_ldexp_f32 v238, 1.0, v233
  v_mov_b32 v239, v238
  v_sub_f32 v120, v120, v232
  v_sub_f32 v121, v121, v232
  v_sub_f32 v122, v122, v232
  v_sub_f32 v123, v123, v232
  v_sub_f32 v124, v124, v232
  v_sub_f32 v125, v125, v232
  v_sub_f32 v126, v126, v232
  v_sub_f32 v127, v127, v232
  v_sub_f32 v132, v132, v232
  v_sub_f32 v133, v133, v232
  v_sub_f32 v134, v134, v232
  v_sub_f32 v135, v135, v232
  v_pk_mul_f32 v[8:9], v[8:9], v[238:239]
  v_pk_mul_f32 v[10:11], v[10:11], v[238:239]
  v_pk_mul_f32 v[12:13], v[12:13], v[238:239]
  v_pk_mul_f32 v[14:15], v[14:15], v[238:239]
  v_pk_mul_f32 v[24:25], v[24:25], v[238:239]
  v_pk_mul_f32 v[26:27], v[26:27], v[238:239]
  v_pk_mul_f32 v[28:29], v[28:29], v[238:239]
  v_pk_mul_f32 v[30:31], v[30:31], v[238:239]
  v_pk_mul_f32 v[40:41], v[40:41], v[238:239]
  v_pk_mul_f32 v[42:43], v[42:43], v[238:239]
  v_pk_mul_f32 v[44:45], v[44:45], v[238:239]
  v_pk_mul_f32 v[46:47], v[46:47], v[238:239]
  v_pk_mul_f32 v[56:57], v[56:57], v[238:239]
  v_pk_mul_f32 v[58:59], v[58:59], v[238:239]
  v_pk_mul_f32 v[60:61], v[60:61], v[238:239]
  v_pk_mul_f32 v[62:63], v[62:63], v[238:239]
  v_mul_f32 v230, v230, v238
  v_mul_f32 v231, v231, v238
  v_lshlrev_b32 v232, 16, v140
  v_and_b32 v233, 0xffff0000, v140
  v_mul_f32 v232, v232, v238
  v_mul_f32 v233, v233, v238
  v_cvt_pk_bf16_f32 v140, v232, v233
  v_lshlrev_b32 v232, 16, v141
  v_and_b32 v233, 0xffff0000, v141
  v_mul_f32 v232, v232, v238
  v_mul_f32 v233, v233, v238
  v_cvt_pk_bf16_f32 v141, v232, v233
  v_lshlrev_b32 v232, 16, v142
  v_and_b32 v233, 0xffff0000, v142
  v_mul_f32 v232, v232, v238
  v_mul_f32 v233, v233, v238
  v_cvt_pk_bf16_f32 v142, v232, v233
  v_lshlrev_b32 v232, 16, v143
  v_and_b32 v233, 0xffff0000, v143
  v_mul_f32 v232, v232, v238
  v_mul_f32 v233, v233, v238
  v_cvt_pk_bf16_f32 v143, v232, v233
  s_nop 1
  s_branch L_A_ret_3
L_tail_pre:
  s_load_dwordx2 s[60:61], s[0:1], 88
  s_waitcnt lgkmcnt(0)
  s_mov_b32 s40, s60
  s_and_b32 s41, s61, 0xffff
  s_mov_b32 s42, 0x100
  s_mov_b32 s43, 0x20000
  v_mbcnt_lo_u32_b32 v255, -1, 0
  v_mbcnt_hi_u32_b32 v255, -1, v255
  v_lshrrev_b32 v10, 5, v255
  v_bfe_u32 v11, v255, 1, 3
  v_add_u32 v12, 0, v10
  v_xor_b32 v11, v11, v12
  v_lshlrev_b32 v10, 10, v10
  v_bfe_u32 v12, v255, 4, 1
  v_lshl_add_u32 v10, v12, 9, v10
  v_lshrrev_b32 v12, 2, v11
  v_lshl_add_u32 v10, v12, 8, v10
  v_and_b32 v12, 3, v11
  v_lshl_add_u32 v10, v12, 5, v10
  v_and_b32 v12, 1, v255
  v_lshl_add_u32 v248, v12, 4, v10
  v_lshrrev_b32 v10, 5, v255
  v_bfe_u32 v11, v255, 1, 3
  v_add_u32 v12, 2, v10
  v_xor_b32 v11, v11, v12
  v_lshlrev_b32 v10, 10, v10
  v_bfe_u32 v12, v255, 4, 1
  v_lshl_add_u32 v10, v12, 9, v10
  v_lshrrev_b32 v12, 2, v11
  v_lshl_add_u32 v10, v12, 8, v10
  v_and_b32 v12, 3, v11
  v_lshl_add_u32 v10, v12, 5, v10
  v_and_b32 v12, 1, v255
  v_lshl_add_u32 v249, v12, 4, v10
  v_lshrrev_b32 v10, 5, v255
  v_bfe_u32 v11, v255, 1, 3
  v_add_u32 v12, 4, v10
  v_xor_b32 v11, v11, v12
  v_lshlrev_b32 v10, 10, v10
  v_bfe_u32 v12, v255, 4, 1
  v_lshl_add_u32 v10, v12, 9, v10
  v_lshrrev_b32 v12, 2, v11
  v_lshl_add_u32 v10, v12, 8, v10
  v_and_b32 v12, 3, v11
  v_lshl_add_u32 v10, v12, 5, v10
  v_and_b32 v12, 1, v255
  v_lshl_add_u32 v250, v12, 4, v10
  v_lshrrev_b32 v10, 5, v255
  v_bfe_u32 v11, v255, 1, 3
  v_add_u32 v12, 6, v10
  v_xor_b32 v11, v11, v12
  v_lshlrev_b32 v10, 10, v10
  v_bfe_u32 v12, v255, 4, 1
  v_lshl_add_u32 v10, v12, 9, v10
  v_lshrrev_b32 v12, 2, v11
  v_lshl_add_u32 v10, v12, 8, v10
  v_and_b32 v12, 3, v11
  v_lshl_add_u32 v10, v12, 5, v10
  v_and_b32 v12, 1, v255
  v_lshl_add_u32 v251, v12, 4, v10
  s_mov_b32 s32, s16
  s_and_b32 s33, s17, 0xffff
  s_mov_b32 s34, 0x400000
  s_mov_b32 s35, 0x20000
  s_add_u32 s36, s18, 0
  s_addc_u32 s37, s19, 0
  s_and_b32 s37, s37, 0xffff
  s_mov_b32 s38, 0x1800000
  s_mov_b32 s39, 0x20000
  s_add_u32 s64, s18, 27262976
  s_addc_u32 s65, s19, 0
  s_and_b32 s65, s65, 0xffff
  s_mov_b32 s66, 32768
  s_mov_b32 s67, 0x20000
  s_lshl_b32 s53, s26, 17
  s_mov_b32 s63, 0
  s_barrier
  s_and_b32 s49, s63, 15
  s_add_u32 s49, s49, s24
  s_and_b32 s49, s49, 15
  s_lshl_b32 s49, s49, 15
  s_lshr_b32 s50, s63, 4
  s_xor_b32 s50, s50, s24
  s_and_b32 s50, s50, 1
  s_lshl_b32 s50, s50, 7
  s_add_u32 s49, s49, s50
  s_add_u32 s49, s49, s53
  s_and_b32 s50, s63, 3
  s_lshl_b32 s50, s50, 3
  s_lshr_b32 s52, 0x703050f, s50
  s_and_b32 s52, s52, 0xff
  s_lshl_b32 s52, s52, 13
  s_add_u32 m0, s52, 0
  s_nop 0
  buffer_load_dwordx4 v248, s[32:35], s49 offen lds
  s_add_u32 m0, s52, 1024
  s_add_u32 s49, s49, 2048
  buffer_load_dwordx4 v249, s[32:35], s49 offen lds
  s_add_u32 m0, s52, 2048
  s_add_u32 s49, s49, 2048
  buffer_load_dwordx4 v250, s[32:35], s49 offen lds
  s_add_u32 m0, s52, 3072
  s_add_u32 s49, s49, 2048
  buffer_load_dwordx4 v251, s[32:35], s49 offen lds
  s_add_u32 m0, s52, 4096
  s_add_u32 s49, s49, 2048
  buffer_load_dwordx4 v248, s[32:35], s49 offen lds
  s_add_u32 m0, s52, 5120
  s_add_u32 s49, s49, 2048
  buffer_load_dwordx4 v249, s[32:35], s49 offen lds
  s_add_u32 m0, s52, 6144
  s_add_u32 s49, s49, 2048
  buffer_load_dwordx4 v250, s[32:35], s49 offen lds
  s_add_u32 m0, s52, 7168
  s_add_u32 s49, s49, 2048
  buffer_load_dwordx4 v251, s[32:35], s49 offen lds
  s_lshr_b32 s52, 0xb040610, s50
  s_and_b32 s52, s52, 0xff
  s_lshl_b32 s52, s52, 13
  s_add_u32 m0, s52, 0
  s_add_u32 s49, s49, 2048
  buffer_load_dwordx4 v248, s[32:35], s49 offen lds
  s_add_u32 m0, s52, 1024
  s_add_u32 s49, s49, 2048
  buffer_load_dwordx4 v249, s[32:35], s49 offen lds
  s_add_u32 m0, s52, 2048
  s_add_u32 s49, s49, 2048
  buffer_load_dwordx4 v250, s[32:35], s49 offen lds
  s_add_u32 m0, s52, 3072
  s_add_u32 s49, s49, 2048
  buffer_load_dwordx4 v251, s[32:35], s49 offen lds
  s_add_u32 m0, s52, 4096
  s_add_u32 s49, s49, 2048
  buffer_load_dwordx4 v248, s[32:35], s49 offen lds
  s_add_u32 m0, s52, 5120
  s_add_u32 s49, s49, 2048
  buffer_load_dwordx4 v249, s[32:35], s49 offen lds
  s_add_u32 m0, s52, 6144
  s_add_u32 s49, s49, 2048
  buffer_load_dwordx4 v250, s[32:35], s49 offen lds
  s_add_u32 m0, s52, 7168
  s_add_u32 s49, s49, 2048
  buffer_load_dwordx4 v251, s[32:35], s49 offen lds
  s_add_u32 s63, s63, 1
  s_barrier
  s_and_b32 s49, s63, 15
  s_add_u32 s49, s49, s24
  s_and_b32 s49, s49, 15
  s_lshl_b32 s49, s49, 15
  s_lshr_b32 s50, s63, 4
  s_xor_b32 s50, s50, s24
  s_and_b32 s50, s50, 1
  s_lshl_b32 s50, s50, 7
  s_add_u32 s49, s49, s50
  s_add_u32 s49, s49, s53
  s_and_b32 s50, s63, 3
  s_lshl_b32 s50, s50, 3
  s_lshr_b32 s52, 0x703050f, s50
  s_and_b32 s52, s52, 0xff
  s_lshl_b32 s52, s52, 13
  s_add_u32 m0, s52, 0
  s_nop 0
  buffer_load_dwordx4 v248, s[32:35], s49 offen lds
  s_add_u32 m0, s52, 1024
  s_add_u32 s49, s49, 2048
  buffer_load_dwordx4 v249, s[32:35], s49 offen lds
  s_add_u32 m0, s52, 2048
  s_add_u32 s49, s49, 2048
  buffer_load_dwordx4 v250, s[32:35], s49 offen lds
  s_add_u32 m0, s52, 3072
  s_add_u32 s49, s49, 2048
  buffer_load_dwordx4 v251, s[32:35], s49 offen lds
  s_add_u32 m0, s52, 4096
  s_add_u32 s49, s49, 2048
  buffer_load_dwordx4 v248, s[32:35], s49 offen lds
  s_add_u32 m0, s52, 5120
  s_add_u32 s49, s49, 2048
  buffer_load_dwordx4 v249, s[32:35], s49 offen lds
  s_add_u32 m0, s52, 6144
  s_add_u32 s49, s49, 2048
  buffer_load_dwordx4 v250, s[32:35], s49 offen lds
  s_add_u32 m0, s52, 7168
  s_add_u32 s49, s49, 2048
  buffer_load_dwordx4 v251, s[32:35], s49 offen lds
  s_lshr_b32 s52, 0xb040610, s50
  s_and_b32 s52, s52, 0xff
  s_lshl_b32 s52, s52, 13
  s_add_u32 m0, s52, 0
  s_add_u32 s49, s49, 2048
  buffer_load_dwordx4 v248, s[32:35], s49 offen lds
  s_add_u32 m0, s52, 1024
  s_add_u32 s49, s49, 2048
  buffer_load_dwordx4 v249, s[32:35], s49 offen lds
  s_add_u32 m0, s52, 2048
  s_add_u32 s49, s49, 2048
  buffer_load_dwordx4 v250, s[32:35], s49 offen lds
  s_add_u32 m0, s52, 3072
  s_add_u32 s49, s49, 2048
  buffer_load_dwordx4 v251, s[32:35], s49 offen lds
  s_add_u32 m0, s52, 4096
  s_add_u32 s49, s49, 2048
  buffer_load_dwordx4 v248, s[32:35], s49 offen lds
  s_add_u32 m0, s52, 5120
  s_add_u32 s49, s49, 2048
  buffer_load_dwordx4 v249, s[32:35], s49 offen lds
  s_add_u32 m0, s52, 6144
  s_add_u32 s49, s49, 2048
  buffer_load_dwordx4 v250, s[32:35], s49 offen lds
  s_add_u32 m0, s52, 7168
  s_add_u32 s49, s49, 2048
  buffer_load_dwordx4 v251, s[32:35], s49 offen lds
  s_add_u32 s63, s63, 1
  s_barrier
  s_and_b32 s49, s63, 15
  s_add_u32 s49, s49, s24
  s_and_b32 s49, s49, 15
  s_lshl_b32 s49, s49, 15
  s_lshr_b32 s50, s63, 4
  s_xor_b32 s50, s50, s24
  s_and_b32 s50, s50, 1
  s_lshl_b32 s50, s50, 7
  s_add_u32 s49, s49, s50
  s_add_u32 s49, s49, s53
  s_and_b32 s50, s63, 3
  s_lshl_b32 s50, s50, 3
  s_lshr_b32 s52, 0x703050f, s50
  s_and_b32 s52, s52, 0xff
  s_lshl_b32 s52, s52, 13
  s_add_u32 m0, s52, 0
  s_nop 0
  buffer_load_dwordx4 v248, s[32:35], s49 offen lds
  s_add_u32 m0, s52, 1024
  s_add_u32 s49, s49, 2048
  buffer_load_dwordx4 v249, s[32:35], s49 offen lds
  s_add_u32 m0, s52, 2048
  s_add_u32 s49, s49, 2048
  buffer_load_dwordx4 v250, s[32:35], s49 offen lds
  s_add_u32 m0, s52, 3072
  s_add_u32 s49, s49, 2048
  buffer_load_dwordx4 v251, s[32:35], s49 offen lds
  s_add_u32 m0, s52, 4096
  s_add_u32 s49, s49, 2048
  buffer_load_dwordx4 v248, s[32:35], s49 offen lds
  s_add_u32 m0, s52, 5120
  s_add_u32 s49, s49, 2048
  buffer_load_dwordx4 v249, s[32:35], s49 offen lds
  s_add_u32 m0, s52, 6144
  s_add_u32 s49, s49, 2048
  buffer_load_dwordx4 v250, s[32:35], s49 offen lds
  s_add_u32 m0, s52, 7168
  s_add_u32 s49, s49, 2048
  buffer_load_dwordx4 v251, s[32:35], s49 offen lds
  s_lshr_b32 s52, 0xb040610, s50
  s_and_b32 s52, s52, 0xff
  s_lshl_b32 s52, s52, 13
  s_add_u32 m0, s52, 0
  s_add_u32 s49, s49, 2048
  buffer_load_dwordx4 v248, s[32:35], s49 offen lds
  s_add_u32 m0, s52, 1024
  s_add_u32 s49, s49, 2048
  buffer_load_dwordx4 v249, s[32:35], s49 offen lds
  s_add_u32 m0, s52, 2048
  s_add_u32 s49, s49, 2048
  buffer_load_dwordx4 v250, s[32:35], s49 offen lds
  s_add_u32 m0, s52, 3072
  s_add_u32 s49, s49, 2048
  buffer_load_dwordx4 v251, s[32:35], s49 offen lds
  s_add_u32 m0, s52, 4096
  s_add_u32 s49, s49, 2048
  buffer_load_dwordx4 v248, s[32:35], s49 offen lds
  s_add_u32 m0, s52, 5120
  s_add_u32 s49, s49, 2048
  buffer_load_dwordx4 v249, s[32:35], s49 offen lds
  s_add_u32 m0, s52, 6144
  s_add_u32 s49, s49, 2048
  buffer_load_dwordx4 v250, s[32:35], s49 offen lds
  s_add_u32 m0, s52, 7168
  s_add_u32 s49, s49, 2048
  buffer_load_dwordx4 v251, s[32:35], s49 offen lds
  s_add_u32 s63, s63, 1
  s_waitcnt vmcnt(16)
  s_branch L_tail_ld2
L_tail_ld:
  s_setprio 0
  s_lshl_b32 s53, s26, 17
  s_mov_b32 s63, 3
L_tail_ld2:
  s_lshl_b32 s55, s23, 4
  s_add_u32 s55, s55, s24
  s_cmp_lg_u32 s20, 0
  s_cbranch_scc1 L_T_rdy
  s_waitcnt vmcnt(0)
  v_readfirstlane_b32 s62, v253
  s_cmp_ge_u32 s62, 8
  s_cbranch_scc1 L_T_rdy
  s_lshl_b32 s49, s55, 2
  s_add_u32 s49, s49, 128
  s_mov_b32 s52, 0
  v_mov_b32 v252, 0
L_T_rdypoll:
  buffer_load_dword v253, v252, s[40:43], s49 offen sc1
  s_waitcnt vmcnt(0)
  v_readfirstlane_b32 s62, v253
  s_add_u32 s52, s52, 1
  s_cmp_ge_u32 s62, 8
  s_cbranch_scc1 L_T_rdy
  s_cmp_lt_u32 s52, 0x4000
  s_cbranch_scc0 L_T_rdy
  s_sleep 8
  s_branch L_T_rdypoll
L_T_rdy:
  s_mov_b32 s56, 0x703050f
  s_cmp_ge_u32 s20, 2
  s_cselect_b32 s56, 0xb040610, s56
  s_and_b32 s51, s20, 1
  s_lshl_b32 s51, s51, 12
  s_lshl_b32 s57, s20, 13
  s_barrier
  s_mov_b32 s48, 29
L_TL_loop:
  s_and_b32 s49, s63, 15
  s_add_u32 s49, s49, s24
  s_and_b32 s49, s49, 15
  s_lshl_b32 s49, s49, 15
  s_lshr_b32 s50, s63, 4
  s_xor_b32 s50, s50, s24
  s_and_b32 s50, s50, 1
  s_lshl_b32 s50, s50, 7
  s_add_u32 s49, s49, s50
  s_add_u32 s49, s49, s53
  s_and_b32 s50, s63, 3
  s_lshl_b32 s50, s50, 3
  s_lshr_b32 s52, s56, s50
  s_and_b32 s52, s52, 0xff
  s_lshl_b32 s52, s52, 13
  s_add_u32 s52, s52, s51
  s_add_u32 s49, s49, s57
  s_add_u32 m0, s52, 0
  s_nop 0
  buffer_load_dwordx4 v248, s[32:35], s49 offen lds
  s_add_u32 m0, s52, 1024
  s_add_u32 s49, s49, 2048
  buffer_load_dwordx4 v249, s[32:35], s49 offen lds
  s_add_u32 m0, s52, 2048
  s_add_u32 s49, s49, 2048
  buffer_load_dwordx4 v250, s[32:35], s49 offen lds
  s_add_u32 m0, s52, 3072
  s_add_u32 s49, s49, 2048
  buffer_load_dwordx4 v251, s[32:35], s49 offen lds
  s_add_u32 s63, s63, 1
  s_waitcnt vmcnt(4)
  s_barrier
  s_sub_u32 s48, s48, 1
  s_cmp_lg_u32 s48, 0
  s_cbranch_scc1 L_TL_loop
  s_waitcnt vmcnt(0)
  s_barrier
  s_barrier
  s_mov_b32 s63, s20
  s_branch L_T_reduce
L_tail_mm:
  s_setprio 3
  s_add_u32 s36, s18, 0
  s_addc_u32 s37, s19, 0
  s_and_b32 s37, s37, 0xffff
  s_mov_b32 s38, 0x1800000
  s_mov_b32 s39, 0x20000
  s_lshl_b32 s55, s23, 4
  s_add_u32 s55, s55, s24
  s_add_u32 s64, s18, 27262976
  s_addc_u32 s65, s19, 0
  s_and_b32 s65, s65, 0xffff
  s_mov_b32 s66, 32768
  s_mov_b32 s67, 0x20000
  v_mbcnt_lo_u32_b32 v255, -1, 0
  v_mbcnt_hi_u32_b32 v255, -1, v255
  s_sub_u32 s51, s20, 4
  v_and_b32 v244, 15, v255
  v_lshrrev_b32 v245, 4, v255
  v_lshrrev_b32 v246, 2, v244
  v_lshl_add_u32 v247, v245, 2, v246
  v_lshlrev_b32 v248, 9, v247
  v_and_b32 v249, 3, v244
  v_lshl_add_u32 v248, v249, 3, v248
  s_lshr_b32 s49, s51, 1
  s_lshl_b32 s49, s49, 8
  v_add_u32 v248, s49, v248
  v_and_b32 v247, 7, v247
  s_and_b32 s49, s51, 1
  s_lshl_b32 s49, s49, 2
  s_add_u32 s50, s49, 0
  v_xor_b32 v249, s50, v247
  v_lshl_add_u32 v232, v249, 5, v248
  s_add_u32 s50, s49, 1
  v_xor_b32 v249, s50, v247
  v_lshl_add_u32 v233, v249, 5, v248
  s_add_u32 s50, s49, 2
  v_xor_b32 v249, s50, v247
  v_lshl_add_u32 v234, v249, 5, v248
  s_add_u32 s50, s49, 3
  v_xor_b32 v249, s50, v247
  v_lshl_add_u32 v235, v249, 5, v248
  v_lshlrev_b32 v242, 4, v255
  v_mov_b32 v0, 0
  v_mov_b32 v1, 0
  v_mov_b32 v2, 0
  v_mov_b32 v3, 0
  v_mov_b32 v4, 0
  v_mov_b32 v5, 0
  v_mov_b32 v6, 0
  v_mov_b32 v7, 0
  v_mov_b32 v8, 0
  v_mov_b32 v9, 0
  v_mov_b32 v10, 0
  v_mov_b32 v11, 0
  v_mov_b32 v12, 0
  v_mov_b32 v13, 0
  v_mov_b32 v14, 0
  v_mov_b32 v15, 0
  v_mov_b32 v16, 0
  v_mov_b32 v17, 0
  v_mov_b32 v18, 0
  v_mov_b32 v19, 0
  v_mov_b32 v20, 0
  v_mov_b32 v21, 0
  v_mov_b32 v22, 0
  v_mov_b32 v23, 0
  v_mov_b32 v24, 0
  v_mov_b32 v25, 0
  v_mov_b32 v26, 0
  v_mov_b32 v27, 0
  v_mov_b32 v28, 0
  v_mov_b32 v29, 0
  v_mov_b32 v30, 0
  v_mov_b32 v31, 0
  v_mov_b32 v32, 0
  v_mov_b32 v33, 0
  v_mov_b32 v34, 0
  v_mov_b32 v35, 0
  v_mov_b32 v36, 0
  v_mov_b32 v37, 0
  v_mov_b32 v38, 0
  v_mov_b32 v39, 0
  v_mov_b32 v40, 0
  v_mov_b32 v41, 0
  v_mov_b32 v42, 0
  v_mov_b32 v43, 0
  v_mov_b32 v44, 0
  v_mov_b32 v45, 0
  v_mov_b32 v46, 0
  v_mov_b32 v47, 0
  v_mov_b32 v48, 0
  v_mov_b32 v49, 0
  v_mov_b32 v50, 0
  v_mov_b32 v51, 0
  v_mov_b32 v52, 0
  v_mov_b32 v53, 0
  v_mov_b32 v54, 0
  v_mov_b32 v55, 0
  v_mov_b32 v56, 0
  v_mov_b32 v57, 0
  v_mov_b32 v58, 0
  v_mov_b32 v59, 0
  v_mov_b32 v60, 0
  v_mov_b32 v61, 0
  v_mov_b32 v62, 0
  v_mov_b32 v63, 0
  v_mov_b32 v64, 0
  v_mov_b32 v65, 0
  v_mov_b32 v66, 0
  v_mov_b32 v67, 0
  v_mov_b32 v68, 0
  v_mov_b32 v69, 0
  v_mov_b32 v70, 0
  v_mov_b32 v71, 0
  v_mov_b32 v72, 0
  v_mov_b32 v73, 0
  v_mov_b32 v74, 0
  v_mov_b32 v75, 0
  v_mov_b32 v76, 0
  v_mov_b32 v77, 0
  v_mov_b32 v78, 0
  v_mov_b32 v79, 0
  v_mov_b32 v80, 0
  v_mov_b32 v81, 0
  v_mov_b32 v82, 0
  v_mov_b32 v83, 0
  v_mov_b32 v84, 0
  v_mov_b32 v85, 0
  v_mov_b32 v86, 0
  v_mov_b32 v87, 0
  v_mov_b32 v88, 0
  v_mov_b32 v89, 0
  v_mov_b32 v90, 0
  v_mov_b32 v91, 0
  v_mov_b32 v92, 0
  v_mov_b32 v93, 0
  v_mov_b32 v94, 0
  v_mov_b32 v95, 0
  v_mov_b32 v96, 0
  v_mov_b32 v97, 0
  v_mov_b32 v98, 0
  v_mov_b32 v99, 0
  v_mov_b32 v100, 0
  v_mov_b32 v101, 0
  v_mov_b32 v102, 0
  v_mov_b32 v103, 0
  v_mov_b32 v104, 0
  v_mov_b32 v105, 0
  v_mov_b32 v106, 0
  v_mov_b32 v107, 0
  v_mov_b32 v108, 0
  v_mov_b32 v109, 0
  v_mov_b32 v110, 0
  v_mov_b32 v111, 0
  v_mov_b32 v112, 0
  v_mov_b32 v113, 0
  v_mov_b32 v114, 0
  v_mov_b32 v115, 0
  v_mov_b32 v116, 0
  v_mov_b32 v117, 0
  v_mov_b32 v118, 0
  v_mov_b32 v119, 0
  v_mov_b32 v120, 0
  v_mov_b32 v121, 0
  v_mov_b32 v122, 0
  v_mov_b32 v123, 0
  v_mov_b32 v124, 0
  v_mov_b32 v125, 0
  v_mov_b32 v126, 0
  v_mov_b32 v127, 0
  v_mov_b32 v128, 0
  v_mov_b32 v129, 0
  v_mov_b32 v130, 0
  v_mov_b32 v131, 0
  v_mov_b32 v132, 0
  v_mov_b32 v133, 0
  v_mov_b32 v134, 0
  v_mov_b32 v135, 0
  v_mov_b32 v136, 0
  v_mov_b32 v137, 0
  v_mov_b32 v138, 0
  v_mov_b32 v139, 0
  v_mov_b32 v140, 0
  v_mov_b32 v141, 0
  v_mov_b32 v142, 0
  v_mov_b32 v143, 0
  v_mov_b32 v144, 0
  v_mov_b32 v145, 0
  v_mov_b32 v146, 0
  v_mov_b32 v147, 0
  v_mov_b32 v148, 0
  v_mov_b32 v149, 0
  v_mov_b32 v150, 0
  v_mov_b32 v151, 0
  v_mov_b32 v152, 0
  v_mov_b32 v153, 0
  v_mov_b32 v154, 0
  v_mov_b32 v155, 0
  v_mov_b32 v156, 0
  v_mov_b32 v157, 0
  v_mov_b32 v158, 0
  v_mov_b32 v159, 0
  v_mov_b32 v160, 0
  v_mov_b32 v161, 0
  v_mov_b32 v162, 0
  v_mov_b32 v163, 0
  v_mov_b32 v164, 0
  v_mov_b32 v165, 0
  v_mov_b32 v166, 0
  v_mov_b32 v167, 0
  v_mov_b32 v168, 0
  v_mov_b32 v169, 0
  v_mov_b32 v170, 0
  v_mov_b32 v171, 0
  v_mov_b32 v172, 0
  v_mov_b32 v173, 0
  v_mov_b32 v174, 0
  v_mov_b32 v175, 0
  v_mov_b32 v176, 0
  v_mov_b32 v177, 0
  v_mov_b32 v178, 0
  v_mov_b32 v179, 0
  v_mov_b32 v180, 0
  v_mov_b32 v181, 0
  v_mov_b32 v182, 0
  v_mov_b32 v183, 0
  v_mov_b32 v184, 0
  v_mov_b32 v185, 0
  v_mov_b32 v186, 0
  v_mov_b32 v187, 0
  v_mov_b32 v188, 0
  v_mov_b32 v189, 0
  v_mov_b32 v190, 0
  v_mov_b32 v191, 0
  s_add_u32 s49, s24, 0
  s_and_b32 s49, s49, 15
  s_lshr_b32 s50, s49, 2
  s_lshl_b32 s50, s50, 3
  s_lshr_b32 s50, 0x80C11, s50
  s_and_b32 s50, s50, 0xff
  s_lshl_b32 s50, s50, 13
  s_and_b32 s49, s49, 3
  s_lshl_b32 s49, s49, 11
  s_add_u32 s68, s50, s49
  s_add_u32 s49, s24, 1
  s_and_b32 s49, s49, 15
  s_lshr_b32 s50, s49, 2
  s_lshl_b32 s50, s50, 3
  s_lshr_b32 s50, 0x80C11, s50
  s_and_b32 s50, s50, 0xff
  s_lshl_b32 s50, s50, 13
  s_and_b32 s49, s49, 3
  s_lshl_b32 s49, s49, 11
  s_add_u32 s69, s50, s49
  s_add_u32 s49, s24, 2
  s_and_b32 s49, s49, 15
  s_lshr_b32 s50, s49, 2
  s_lshl_b32 s50, s50, 3
  s_lshr_b32 s50, 0x80C11, s50
  s_and_b32 s50, s50, 0xff
  s_lshl_b32 s50, s50, 13
  s_and_b32 s49, s49, 3
  s_lshl_b32 s49, s49, 11
  s_add_u32 s70, s50, s49
  s_add_u32 s49, s24, 3
  s_and_b32 s49, s49, 15
  s_lshr_b32 s50, s49, 2
  s_lshl_b32 s50, s50, 3
  s_lshr_b32 s50, 0x80C11, s50
  s_and_b32 s50, s50, 0xff
  s_lshl_b32 s50, s50, 13
  s_and_b32 s49, s49, 3
  s_lshl_b32 s49, s49, 11
  s_add_u32 s71, s50, s49
  s_add_u32 s49, s24, 4
  s_and_b32 s49, s49, 15
  s_lshr_b32 s50, s49, 2
  s_lshl_b32 s50, s50, 3
  s_lshr_b32 s50, 0x80C11, s50
  s_and_b32 s50, s50, 0xff
  s_lshl_b32 s50, s50, 13
  s_and_b32 s49, s49, 3
  s_lshl_b32 s49, s49, 11
  s_add_u32 s72, s50, s49
  s_add_u32 s49, s24, 5
  s_and_b32 s49, s49, 15
  s_lshr_b32 s50, s49, 2
  s_lshl_b32 s50, s50, 3
  s_lshr_b32 s50, 0x80C11, s50
  s_and_b32 s50, s50, 0xff
  s_lshl_b32 s50, s50, 13
  s_and_b32 s49, s49, 3
  s_lshl_b32 s49, s49, 11
  s_add_u32 s73, s50, s49
  s_add_u32 s49, s24, 6
  s_and_b32 s49, s49, 15
  s_lshr_b32 s50, s49, 2
  s_lshl_b32 s50, s50, 3
  s_lshr_b32 s50, 0x80C11, s50
  s_and_b32 s50, s50, 0xff
  s_lshl_b32 s50, s50, 13
  s_and_b32 s49, s49, 3
  s_lshl_b32 s49, s49, 11
  s_add_u32 s74, s50, s49
  s_add_u32 s49, s24, 7
  s_and_b32 s49, s49, 15
  s_lshr_b32 s50, s49, 2
  s_lshl_b32 s50, s50, 3
  s_lshr_b32 s50, 0x80C11, s50
  s_and_b32 s50, s50, 0xff
  s_lshl_b32 s50, s50, 13
  s_and_b32 s49, s49, 3
  s_lshl_b32 s49, s49, 11
  s_add_u32 s75, s50, s49
  s_add_u32 s49, s24, 8
  s_and_b32 s49, s49, 15
  s_lshr_b32 s50, s49, 2
  s_lshl_b32 s50, s50, 3
  s_lshr_b32 s50, 0x80C11, s50
  s_and_b32 s50, s50, 0xff
  s_lshl_b32 s50, s50, 13
  s_and_b32 s49, s49, 3
  s_lshl_b32 s49, s49, 11
  s_add_u32 s76, s50, s49
  s_add_u32 s49, s24, 9
  s_and_b32 s49, s49, 15
  s_lshr_b32 s50, s49, 2
  s_lshl_b32 s50, s50, 3
  s_lshr_b32 s50, 0x80C11, s50
  s_and_b32 s50, s50, 0xff
  s_lshl_b32 s50, s50, 13
  s_and_b32 s49, s49, 3
  s_lshl_b32 s49, s49, 11
  s_add_u32 s77, s50, s49
  s_add_u32 s49, s24, 10
  s_and_b32 s49, s49, 15
  s_lshr_b32 s50, s49, 2
  s_lshl_b32 s50, s50, 3
  s_lshr_b32 s50, 0x80C11, s50
  s_and_b32 s50, s50, 0xff
  s_lshl_b32 s50, s50, 13
  s_and_b32 s49, s49, 3
  s_lshl_b32 s49, s49, 11
  s_add_u32 s78, s50, s49
  s_add_u32 s49, s24, 11
  s_and_b32 s49, s49, 15
  s_lshr_b32 s50, s49, 2
  s_lshl_b32 s50, s50, 3
  s_lshr_b32 s50, 0x80C11, s50
  s_and_b32 s50, s50, 0xff
  s_lshl_b32 s50, s50, 13
  s_and_b32 s49, s49, 3
  s_lshl_b32 s49, s49, 11
  s_add_u32 s79, s50, s49
  s_add_u32 s49, s24, 12
  s_and_b32 s49, s49, 15
  s_lshr_b32 s50, s49, 2
  s_lshl_b32 s50, s50, 3
  s_lshr_b32 s50, 0x80C11, s50
  s_and_b32 s50, s50, 0xff
  s_lshl_b32 s50, s50, 13
  s_and_b32 s49, s49, 3
  s_lshl_b32 s49, s49, 11
  s_add_u32 s80, s50, s49
  s_add_u32 s49, s24, 13
  s_and_b32 s49, s49, 15
  s_lshr_b32 s50, s49, 2
  s_lshl_b32 s50, s50, 3
  s_lshr_b32 s50, 0x80C11, s50
  s_and_b32 s50, s50, 0xff
  s_lshl_b32 s50, s50, 13
  s_and_b32 s49, s49, 3
  s_lshl_b32 s49, s49, 11
  s_add_u32 s81, s50, s49
  s_add_u32 s49, s24, 14
  s_and_b32 s49, s49, 15
  s_lshr_b32 s50, s49, 2
  s_lshl_b32 s50, s50, 3
  s_lshr_b32 s50, 0x80C11, s50
  s_and_b32 s50, s50, 0xff
  s_lshl_b32 s50, s50, 13
  s_and_b32 s49, s49, 3
  s_lshl_b32 s49, s49, 11
  s_add_u32 s82, s50, s49
  s_add_u32 s49, s24, 15
  s_and_b32 s49, s49, 15
  s_lshr_b32 s50, s49, 2
  s_lshl_b32 s50, s50, 3
  s_lshr_b32 s50, 0x80C11, s50
  s_and_b32 s50, s50, 0xff
  s_lshl_b32 s50, s50, 13
  s_and_b32 s49, s49, 3
  s_lshl_b32 s49, s49, 11
  s_add_u32 s83, s50, s49
  v_add_u32 v236, 90112, v232
  v_add_u32 v237, 90112, v233
  v_add_u32 v238, 90112, v234
  v_add_u32 v239, 90112, v235
  v_add_u32 v240, s68, v242
  v_add_u32 v241, s69, v242
L_T_idle:
  s_barrier
  s_sub_u32 s54, s54, 1
  s_cmp_lg_u32 s54, 0
  s_cbranch_scc1 L_T_idle
  s_barrier
  ds_read_b128 v[208:211], v240 offset:0
  ds_read_b128 v[212:215], v240 offset:1024
  ds_read_b128 v[216:219], v240 offset:8192
  ds_read_b128 v[220:223], v240 offset:9216
  ds_read_b128 v[224:227], v240 offset:16384
  ds_read_b128 v[228:231], v240 offset:17408
  ds_read_b64_tr_b16 v[192:193], v236 offset:32768
  ds_read_b64_tr_b16 v[194:195], v236 offset:40960
  ds_read_b64_tr_b16 v[196:197], v237 offset:32768
  ds_read_b64_tr_b16 v[198:199], v237 offset:40960
  ds_read_b64_tr_b16 v[200:201], v238 offset:32768
  ds_read_b64_tr_b16 v[202:203], v238 offset:40960
  ds_read_b64_tr_b16 v[204:205], v239 offset:32768
  ds_read_b64_tr_b16 v[206:207], v239 offset:40960
  s_waitcnt lgkmcnt(6)
  v_mfma_f32_16x16x32_bf16 v[0:3], v[192:195], v[208:211], v[0:3]
  v_add_u32 v240, s70, v242
  v_mfma_f32_16x16x32_bf16 v[16:19], v[192:195], v[212:215], v[16:19]
  v_mfma_f32_16x16x32_bf16 v[32:35], v[192:195], v[216:219], v[32:35]
  s_waitcnt lgkmcnt(4)
  v_mfma_f32_16x16x32_bf16 v[4:7], v[196:199], v[208:211], v[4:7]
  v_mfma_f32_16x16x32_bf16 v[20:23], v[196:199], v[212:215], v[20:23]
  v_mfma_f32_16x16x32_bf16 v[36:39], v[196:199], v[216:219], v[36:39]
  s_waitcnt lgkmcnt(2)
  v_mfma_f32_16x16x32_bf16 v[8:11], v[200:203], v[208:211], v[8:11]
  v_mfma_f32_16x16x32_bf16 v[24:27], v[200:203], v[212:215], v[24:27]
  v_mfma_f32_16x16x32_bf16 v[40:43], v[200:203], v[216:219], v[40:43]
  s_waitcnt lgkmcnt(0)
  v_mfma_f32_16x16x32_bf16 v[12:15], v[204:207], v[208:211], v[12:15]
  ds_read_b128 v[208:211], v241 offset:0
  v_mfma_f32_16x16x32_bf16 v[28:31], v[204:207], v[212:215], v[28:31]
  ds_read_b128 v[212:215], v241 offset:1024
  v_mfma_f32_16x16x32_bf16 v[44:47], v[204:207], v[216:219], v[44:47]
  ds_read_b128 v[216:219], v241 offset:8192
  v_mfma_f32_16x16x32_bf16 v[48:51], v[192:195], v[220:223], v[48:51]
  v_mfma_f32_16x16x32_bf16 v[64:67], v[192:195], v[224:227], v[64:67]
  v_mfma_f32_16x16x32_bf16 v[80:83], v[192:195], v[228:231], v[80:83]
  ds_read_b64_tr_b16 v[192:193], v232 offset:40960
  v_mfma_f32_16x16x32_bf16 v[52:55], v[196:199], v[220:223], v[52:55]
  ds_read_b64_tr_b16 v[194:195], v232 offset:49152
  v_mfma_f32_16x16x32_bf16 v[68:71], v[196:199], v[224:227], v[68:71]
  v_mfma_f32_16x16x32_bf16 v[84:87], v[196:199], v[228:231], v[84:87]
  ds_read_b64_tr_b16 v[196:197], v233 offset:40960
  v_mfma_f32_16x16x32_bf16 v[56:59], v[200:203], v[220:223], v[56:59]
  ds_read_b64_tr_b16 v[198:199], v233 offset:49152
  v_mfma_f32_16x16x32_bf16 v[72:75], v[200:203], v[224:227], v[72:75]
  v_mfma_f32_16x16x32_bf16 v[88:91], v[200:203], v[228:231], v[88:91]
  ds_read_b64_tr_b16 v[200:201], v234 offset:40960
  v_mfma_f32_16x16x32_bf16 v[60:63], v[204:207], v[220:223], v[60:63]
  ds_read_b64_tr_b16 v[202:203], v234 offset:49152
  v_mfma_f32_16x16x32_bf16 v[76:79], v[204:207], v[224:227], v[76:79]
  ds_read_b128 v[220:223], v241 offset:9216
  v_mfma_f32_16x16x32_bf16 v[92:95], v[204:207], v[228:231], v[92:95]
  ds_read_b128 v[224:227], v241 offset:16384
  ds_read_b128 v[228:231], v241 offset:17408
  ds_read_b64_tr_b16 v[204:205], v235 offset:40960
  ds_read_b64_tr_b16 v[206:207], v235 offset:49152
  s_barrier
  s_waitcnt lgkmcnt(9)
  v_mfma_f32_16x16x32_bf16 v[0:3], v[192:195], v[208:211], v[0:3]
  v_add_u32 v241, s71, v242
  v_mfma_f32_16x16x32_bf16 v[16:19], v[192:195], v[212:215], v[16:19]
  v_mfma_f32_16x16x32_bf16 v[32:35], v[192:195], v[216:219], v[32:35]
  s_waitcnt lgkmcnt(7)
  v_mfma_f32_16x16x32_bf16 v[4:7], v[196:199], v[208:211], v[4:7]
  v_mfma_f32_16x16x32_bf16 v[20:23], v[196:199], v[212:215], v[20:23]
  v_mfma_f32_16x16x32_bf16 v[36:39], v[196:199], v[216:219], v[36:39]
  s_waitcnt lgkmcnt(5)
  v_mfma_f32_16x16x32_bf16 v[8:11], v[200:203], v[208:211], v[8:11]
  v_mfma_f32_16x16x32_bf16 v[24:27], v[200:203], v[212:215], v[24:27]
  v_mfma_f32_16x16x32_bf16 v[40:43], v[200:203], v[216:219], v[40:43]
  s_waitcnt lgkmcnt(0)
  v_mfma_f32_16x16x32_bf16 v[12:15], v[204:207], v[208:211], v[12:15]
  ds_read_b128 v[208:211], v240 offset:0
  v_mfma_f32_16x16x32_bf16 v[28:31], v[204:207], v[212:215], v[28:31]
  ds_read_b128 v[212:215], v240 offset:1024
  v_mfma_f32_16x16x32_bf16 v[44:47], v[204:207], v[216:219], v[44:47]
  ds_read_b128 v[216:219], v240 offset:8192
  v_mfma_f32_16x16x32_bf16 v[48:51], v[192:195], v[220:223], v[48:51]
  v_mfma_f32_16x16x32_bf16 v[64:67], v[192:195], v[224:227], v[64:67]
  v_mfma_f32_16x16x32_bf16 v[80:83], v[192:195], v[228:231], v[80:83]
  ds_read_b64_tr_b16 v[192:193], v232 offset:24576
  v_mfma_f32_16x16x32_bf16 v[52:55], v[196:199], v[220:223], v[52:55]
  ds_read_b64_tr_b16 v[194:195], v232 offset:32768
  v_mfma_f32_16x16x32_bf16 v[68:71], v[196:199], v[224:227], v[68:71]
  v_mfma_f32_16x16x32_bf16 v[84:87], v[196:199], v[228:231], v[84:87]
  ds_read_b64_tr_b16 v[196:197], v233 offset:24576
  v_mfma_f32_16x16x32_bf16 v[56:59], v[200:203], v[220:223], v[56:59]
  ds_read_b64_tr_b16 v[198:199], v233 offset:32768
  v_mfma_f32_16x16x32_bf16 v[72:75], v[200:203], v[224:227], v[72:75]
  v_mfma_f32_16x16x32_bf16 v[88:91], v[200:203], v[228:231], v[88:91]
  ds_read_b64_tr_b16 v[200:201], v234 offset:24576
  v_mfma_f32_16x16x32_bf16 v[60:63], v[204:207], v[220:223], v[60:63]
  ds_read_b64_tr_b16 v[202:203], v234 offset:32768
  v_mfma_f32_16x16x32_bf16 v[76:79], v[204:207], v[224:227], v[76:79]
  ds_read_b128 v[220:223], v240 offset:9216
  v_mfma_f32_16x16x32_bf16 v[92:95], v[204:207], v[228:231], v[92:95]
  ds_read_b128 v[224:227], v240 offset:16384
  ds_read_b128 v[228:231], v240 offset:17408
  ds_read_b64_tr_b16 v[204:205], v235 offset:24576
  ds_read_b64_tr_b16 v[206:207], v235 offset:32768
  s_barrier
  s_waitcnt lgkmcnt(9)
  v_mfma_f32_16x16x32_bf16 v[0:3], v[192:195], v[208:211], v[0:3]
  v_add_u32 v240, s72, v242
  v_mfma_f32_16x16x32_bf16 v[16:19], v[192:195], v[212:215], v[16:19]
  v_mfma_f32_16x16x32_bf16 v[32:35], v[192:195], v[216:219], v[32:35]
  s_waitcnt lgkmcnt(7)
  v_mfma_f32_16x16x32_bf16 v[4:7], v[196:199], v[208:211], v[4:7]
  v_mfma_f32_16x16x32_bf16 v[20:23], v[196:199], v[212:215], v[20:23]
  v_mfma_f32_16x16x32_bf16 v[36:39], v[196:199], v[216:219], v[36:39]
  s_waitcnt lgkmcnt(5)
  v_mfma_f32_16x16x32_bf16 v[8:11], v[200:203], v[208:211], v[8:11]
  v_mfma_f32_16x16x32_bf16 v[24:27], v[200:203], v[212:215], v[24:27]
  v_mfma_f32_16x16x32_bf16 v[40:43], v[200:203], v[216:219], v[40:43]
  s_waitcnt lgkmcnt(0)
  v_mfma_f32_16x16x32_bf16 v[12:15], v[204:207], v[208:211], v[12:15]
  ds_read_b128 v[208:211], v241 offset:0
  v_mfma_f32_16x16x32_bf16 v[28:31], v[204:207], v[212:215], v[28:31]
  ds_read_b128 v[212:215], v241 offset:1024
  v_mfma_f32_16x16x32_bf16 v[44:47], v[204:207], v[216:219], v[44:47]
  ds_read_b128 v[216:219], v241 offset:8192
  v_mfma_f32_16x16x32_bf16 v[48:51], v[192:195], v[220:223], v[48:51]
  v_mfma_f32_16x16x32_bf16 v[64:67], v[192:195], v[224:227], v[64:67]
  v_mfma_f32_16x16x32_bf16 v[80:83], v[192:195], v[228:231], v[80:83]
  ds_read_b64_tr_b16 v[192:193], v232 offset:57344
  v_mfma_f32_16x16x32_bf16 v[52:55], v[196:199], v[220:223], v[52:55]
  ds_read_b64_tr_b16 v[194:195], v236 offset:0
  v_mfma_f32_16x16x32_bf16 v[68:71], v[196:199], v[224:227], v[68:71]
  v_mfma_f32_16x16x32_bf16 v[84:87], v[196:199], v[228:231], v[84:87]
  ds_read_b64_tr_b16 v[196:197], v233 offset:57344
  v_mfma_f32_16x16x32_bf16 v[56:59], v[200:203], v[220:223], v[56:59]
  ds_read_b64_tr_b16 v[198:199], v237 offset:0
  v_mfma_f32_16x16x32_bf16 v[72:75], v[200:203], v[224:227], v[72:75]
  v_mfma_f32_16x16x32_bf16 v[88:91], v[200:203], v[228:231], v[88:91]
  ds_read_b64_tr_b16 v[200:201], v234 offset:57344
  v_mfma_f32_16x16x32_bf16 v[60:63], v[204:207], v[220:223], v[60:63]
  ds_read_b64_tr_b16 v[202:203], v238 offset:0
  v_mfma_f32_16x16x32_bf16 v[76:79], v[204:207], v[224:227], v[76:79]
  ds_read_b128 v[220:223], v241 offset:9216
  v_mfma_f32_16x16x32_bf16 v[92:95], v[204:207], v[228:231], v[92:95]
  ds_read_b128 v[224:227], v241 offset:16384
  ds_read_b128 v[228:231], v241 offset:17408
  ds_read_b64_tr_b16 v[204:205], v235 offset:57344
  ds_read_b64_tr_b16 v[206:207], v239 offset:0
  s_barrier
  s_waitcnt lgkmcnt(9)
  v_mfma_f32_16x16x32_bf16 v[0:3], v[192:195], v[208:211], v[0:3]
  v_add_u32 v241, s73, v242
  v_mfma_f32_16x16x32_bf16 v[16:19], v[192:195], v[212:215], v[16:19]
  v_mfma_f32_16x16x32_bf16 v[32:35], v[192:195], v[216:219], v[32:35]
  s_waitcnt lgkmcnt(7)
  v_mfma_f32_16x16x32_bf16 v[4:7], v[196:199], v[208:211], v[4:7]
  v_mfma_f32_16x16x32_bf16 v[20:23], v[196:199], v[212:215], v[20:23]
  v_mfma_f32_16x16x32_bf16 v[36:39], v[196:199], v[216:219], v[36:39]
  s_waitcnt lgkmcnt(5)
  v_mfma_f32_16x16x32_bf16 v[8:11], v[200:203], v[208:211], v[8:11]
  v_mfma_f32_16x16x32_bf16 v[24:27], v[200:203], v[212:215], v[24:27]
  v_mfma_f32_16x16x32_bf16 v[40:43], v[200:203], v[216:219], v[40:43]
  s_waitcnt lgkmcnt(0)
  v_mfma_f32_16x16x32_bf16 v[12:15], v[204:207], v[208:211], v[12:15]
  ds_read_b128 v[208:211], v240 offset:0
  v_mfma_f32_16x16x32_bf16 v[28:31], v[204:207], v[212:215], v[28:31]
  ds_read_b128 v[212:215], v240 offset:1024
  v_mfma_f32_16x16x32_bf16 v[44:47], v[204:207], v[216:219], v[44:47]
  ds_read_b128 v[216:219], v240 offset:8192
  v_mfma_f32_16x16x32_bf16 v[48:51], v[192:195], v[220:223], v[48:51]
  v_mfma_f32_16x16x32_bf16 v[64:67], v[192:195], v[224:227], v[64:67]
  v_mfma_f32_16x16x32_bf16 v[80:83], v[192:195], v[228:231], v[80:83]
  ds_read_b64_tr_b16 v[192:193], v236 offset:32768
  v_mfma_f32_16x16x32_bf16 v[52:55], v[196:199], v[220:223], v[52:55]
  ds_read_b64_tr_b16 v[194:195], v236 offset:40960
  v_mfma_f32_16x16x32_bf16 v[68:71], v[196:199], v[224:227], v[68:71]
  v_mfma_f32_16x16x32_bf16 v[84:87], v[196:199], v[228:231], v[84:87]
  ds_read_b64_tr_b16 v[196:197], v237 offset:32768
  v_mfma_f32_16x16x32_bf16 v[56:59], v[200:203], v[220:223], v[56:59]
  ds_read_b64_tr_b16 v[198:199], v237 offset:40960
  v_mfma_f32_16x16x32_bf16 v[72:75], v[200:203], v[224:227], v[72:75]
  v_mfma_f32_16x16x32_bf16 v[88:91], v[200:203], v[228:231], v[88:91]
  ds_read_b64_tr_b16 v[200:201], v238 offset:32768
  v_mfma_f32_16x16x32_bf16 v[60:63], v[204:207], v[220:223], v[60:63]
  ds_read_b64_tr_b16 v[202:203], v238 offset:40960
  v_mfma_f32_16x16x32_bf16 v[76:79], v[204:207], v[224:227], v[76:79]
  ds_read_b128 v[220:223], v240 offset:9216
  v_mfma_f32_16x16x32_bf16 v[92:95], v[204:207], v[228:231], v[92:95]
  ds_read_b128 v[224:227], v240 offset:16384
  ds_read_b128 v[228:231], v240 offset:17408
  ds_read_b64_tr_b16 v[204:205], v239 offset:32768
  ds_read_b64_tr_b16 v[206:207], v239 offset:40960
  s_barrier
  s_waitcnt lgkmcnt(9)
  v_mfma_f32_16x16x32_bf16 v[0:3], v[192:195], v[208:211], v[0:3]
  v_add_u32 v240, s74, v242
  v_mfma_f32_16x16x32_bf16 v[16:19], v[192:195], v[212:215], v[16:19]
  v_mfma_f32_16x16x32_bf16 v[32:35], v[192:195], v[216:219], v[32:35]
  s_waitcnt lgkmcnt(7)
  v_mfma_f32_16x16x32_bf16 v[4:7], v[196:199], v[208:211], v[4:7]
  v_mfma_f32_16x16x32_bf16 v[20:23], v[196:199], v[212:215], v[20:23]
  v_mfma_f32_16x16x32_bf16 v[36:39], v[196:199], v[216:219], v[36:39]
  s_waitcnt lgkmcnt(5)
  v_mfma_f32_16x16x32_bf16 v[8:11], v[200:203], v[208:211], v[8:11]
  v_mfma_f32_16x16x32_bf16 v[24:27], v[200:203], v[212:215], v[24:27]
  v_mfma_f32_16x16x32_bf16 v[40:43], v[200:203], v[216:219], v[40:43]
  s_waitcnt lgkmcnt(0)
  v_mfma_f32_16x16x32_bf16 v[12:15], v[204:207], v[208:211], v[12:15]
  ds_read_b128 v[208:211], v241 offset:0
  v_mfma_f32_16x16x32_bf16 v[28:31], v[204:207], v[212:215], v[28:31]
  ds_read_b128 v[212:215], v241 offset:1024
  v_mfma_f32_16x16x32_bf16 v[44:47], v[204:207], v[216:219], v[44:47]
  ds_read_b128 v[216:219], v241 offset:8192
  v_mfma_f32_16x16x32_bf16 v[48:51], v[192:195], v[220:223], v[48:51]
  v_mfma_f32_16x16x32_bf16 v[64:67], v[192:195], v[224:227], v[64:67]
  v_mfma_f32_16x16x32_bf16 v[80:83], v[192:195], v[228:231], v[80:83]
  ds_read_b64_tr_b16 v[192:193], v232 offset:40960
  v_mfma_f32_16x16x32_bf16 v[52:55], v[196:199], v[220:223], v[52:55]
  ds_read_b64_tr_b16 v[194:195], v232 offset:49152
  v_mfma_f32_16x16x32_bf16 v[68:71], v[196:199], v[224:227], v[68:71]
  v_mfma_f32_16x16x32_bf16 v[84:87], v[196:199], v[228:231], v[84:87]
  ds_read_b64_tr_b16 v[196:197], v233 offset:40960
  v_mfma_f32_16x16x32_bf16 v[56:59], v[200:203], v[220:223], v[56:59]
  ds_read_b64_tr_b16 v[198:199], v233 offset:49152
  v_mfma_f32_16x16x32_bf16 v[72:75], v[200:203], v[224:227], v[72:75]
  v_mfma_f32_16x16x32_bf16 v[88:91], v[200:203], v[228:231], v[88:91]
  ds_read_b64_tr_b16 v[200:201], v234 offset:40960
  v_mfma_f32_16x16x32_bf16 v[60:63], v[204:207], v[220:223], v[60:63]
  ds_read_b64_tr_b16 v[202:203], v234 offset:49152
  v_mfma_f32_16x16x32_bf16 v[76:79], v[204:207], v[224:227], v[76:79]
  ds_read_b128 v[220:223], v241 offset:9216
  v_mfma_f32_16x16x32_bf16 v[92:95], v[204:207], v[228:231], v[92:95]
  ds_read_b128 v[224:227], v241 offset:16384
  ds_read_b128 v[228:231], v241 offset:17408
  ds_read_b64_tr_b16 v[204:205], v235 offset:40960
  ds_read_b64_tr_b16 v[206:207], v235 offset:49152
  s_barrier
  s_waitcnt lgkmcnt(9)
  v_mfma_f32_16x16x32_bf16 v[0:3], v[192:195], v[208:211], v[0:3]
  v_add_u32 v241, s75, v242
  v_mfma_f32_16x16x32_bf16 v[16:19], v[192:195], v[212:215], v[16:19]
  v_mfma_f32_16x16x32_bf16 v[32:35], v[192:195], v[216:219], v[32:35]
  s_waitcnt lgkmcnt(7)
  v_mfma_f32_16x16x32_bf16 v[4:7], v[196:199], v[208:211], v[4:7]
  v_mfma_f32_16x16x32_bf16 v[20:23], v[196:199], v[212:215], v[20:23]
  v_mfma_f32_16x16x32_bf16 v[36:39], v[196:199], v[216:219], v[36:39]
  s_waitcnt lgkmcnt(5)
  v_mfma_f32_16x16x32_bf16 v[8:11], v[200:203], v[208:211], v[8:11]
  v_mfma_f32_16x16x32_bf16 v[24:27], v[200:203], v[212:215], v[24:27]
  v_mfma_f32_16x16x32_bf16 v[40:43], v[200:203], v[216:219], v[40:43]
  s_waitcnt lgkmcnt(0)
  v_mfma_f32_16x16x32_bf16 v[12:15], v[204:207], v[208:211], v[12:15]
  ds_read_b128 v[208:211], v240 offset:0
  v_mfma_f32_16x16x32_bf16 v[28:31], v[204:207], v[212:215], v[28:31]
  ds_read_b128 v[212:215], v240 offset:1024
  v_mfma_f32_16x16x32_bf16 v[44:47], v[204:207], v[216:219], v[44:47]
  ds_read_b128 v[216:219], v240 offset:8192
  v_mfma_f32_16x16x32_bf16 v[48:51], v[192:195], v[220:223], v[48:51]
  v_mfma_f32_16x16x32_bf16 v[64:67], v[192:195], v[224:227], v[64:67]
  v_mfma_f32_16x16x32_bf16 v[80:83], v[192:195], v[228:231], v[80:83]
  ds_read_b64_tr_b16 v[192:193], v232 offset:24576
  v_mfma_f32_16x16x32_bf16 v[52:55], v[196:199], v[220:223], v[52:55]
  ds_read_b64_tr_b16 v[194:195], v232 offset:32768
  v_mfma_f32_16x16x32_bf16 v[68:71], v[196:199], v[224:227], v[68:71]
  v_mfma_f32_16x16x32_bf16 v[84:87], v[196:199], v[228:231], v[84:87]
  ds_read_b64_tr_b16 v[196:197], v233 offset:24576
  v_mfma_f32_16x16x32_bf16 v[56:59], v[200:203], v[220:223], v[56:59]
  ds_read_b64_tr_b16 v[198:199], v233 offset:32768
  v_mfma_f32_16x16x32_bf16 v[72:75], v[200:203], v[224:227], v[72:75]
  v_mfma_f32_16x16x32_bf16 v[88:91], v[200:203], v[228:231], v[88:91]
  ds_read_b64_tr_b16 v[200:201], v234 offset:24576
  v_mfma_f32_16x16x32_bf16 v[60:63], v[204:207], v[220:223], v[60:63]
  ds_read_b64_tr_b16 v[202:203], v234 offset:32768
  v_mfma_f32_16x16x32_bf16 v[76:79], v[204:207], v[224:227], v[76:79]
  ds_read_b128 v[220:223], v240 offset:9216
  v_mfma_f32_16x16x32_bf16 v[92:95], v[204:207], v[228:231], v[92:95]
  ds_read_b128 v[224:227], v240 offset:16384
  ds_read_b128 v[228:231], v240 offset:17408
  ds_read_b64_tr_b16 v[204:205], v235 offset:24576
  ds_read_b64_tr_b16 v[206:207], v235 offset:32768
  s_barrier
  s_waitcnt lgkmcnt(9)
  v_mfma_f32_16x16x32_bf16 v[0:3], v[192:195], v[208:211], v[0:3]
  v_add_u32 v240, s76, v242
  v_mfma_f32_16x16x32_bf16 v[16:19], v[192:195], v[212:215], v[16:19]
  v_mfma_f32_16x16x32_bf16 v[32:35], v[192:195], v[216:219], v[32:35]
  s_waitcnt lgkmcnt(7)
  v_mfma_f32_16x16x32_bf16 v[4:7], v[196:199], v[208:211], v[4:7]
  v_mfma_f32_16x16x32_bf16 v[20:23], v[196:199], v[212:215], v[20:23]
  v_mfma_f32_16x16x32_bf16 v[36:39], v[196:199], v[216:219], v[36:39]
  s_waitcnt lgkmcnt(5)
  v_mfma_f32_16x16x32_bf16 v[8:11], v[200:203], v[208:211], v[8:11]
  v_mfma_f32_16x16x32_bf16 v[24:27], v[200:203], v[212:215], v[24:27]
  v_mfma_f32_16x16x32_bf16 v[40:43], v[200:203], v[216:219], v[40:43]
  s_waitcnt lgkmcnt(0)
  v_mfma_f32_16x16x32_bf16 v[12:15], v[204:207], v[208:211], v[12:15]
  ds_read_b128 v[208:211], v241 offset:0
  v_mfma_f32_16x16x32_bf16 v[28:31], v[204:207], v[212:215], v[28:31]
  ds_read_b128 v[212:215], v241 offset:1024
  v_mfma_f32_16x16x32_bf16 v[44:47], v[204:207], v[216:219], v[44:47]
  ds_read_b128 v[216:219], v241 offset:8192
  v_mfma_f32_16x16x32_bf16 v[48:51], v[192:195], v[220:223], v[48:51]
  v_mfma_f32_16x16x32_bf16 v[64:67], v[192:195], v[224:227], v[64:67]
  v_mfma_f32_16x16x32_bf16 v[80:83], v[192:195], v[228:231], v[80:83]
  ds_read_b64_tr_b16 v[192:193], v232 offset:57344
  v_mfma_f32_16x16x32_bf16 v[52:55], v[196:199], v[220:223], v[52:55]
  ds_read_b64_tr_b16 v[194:195], v236 offset:0
  v_mfma_f32_16x16x32_bf16 v[68:71], v[196:199], v[224:227], v[68:71]
  v_mfma_f32_16x16x32_bf16 v[84:87], v[196:199], v[228:231], v[84:87]
  ds_read_b64_tr_b16 v[196:197], v233 offset:57344
  v_mfma_f32_16x16x32_bf16 v[56:59], v[200:203], v[220:223], v[56:59]
  ds_read_b64_tr_b16 v[198:199], v237 offset:0
  v_mfma_f32_16x16x32_bf16 v[72:75], v[200:203], v[224:227], v[72:75]
  v_mfma_f32_16x16x32_bf16 v[88:91], v[200:203], v[228:231], v[88:91]
  ds_read_b64_tr_b16 v[200:201], v234 offset:57344
  v_mfma_f32_16x16x32_bf16 v[60:63], v[204:207], v[220:223], v[60:63]
  ds_read_b64_tr_b16 v[202:203], v238 offset:0
  v_mfma_f32_16x16x32_bf16 v[76:79], v[204:207], v[224:227], v[76:79]
  ds_read_b128 v[220:223], v241 offset:9216
  v_mfma_f32_16x16x32_bf16 v[92:95], v[204:207], v[228:231], v[92:95]
  ds_read_b128 v[224:227], v241 offset:16384
  ds_read_b128 v[228:231], v241 offset:17408
  ds_read_b64_tr_b16 v[204:205], v235 offset:57344
  ds_read_b64_tr_b16 v[206:207], v239 offset:0
  s_barrier
  s_waitcnt lgkmcnt(9)
  v_mfma_f32_16x16x32_bf16 v[0:3], v[192:195], v[208:211], v[0:3]
  v_add_u32 v241, s77, v242
  v_mfma_f32_16x16x32_bf16 v[16:19], v[192:195], v[212:215], v[16:19]
  v_mfma_f32_16x16x32_bf16 v[32:35], v[192:195], v[216:219], v[32:35]
  s_waitcnt lgkmcnt(7)
  v_mfma_f32_16x16x32_bf16 v[4:7], v[196:199], v[208:211], v[4:7]
  v_mfma_f32_16x16x32_bf16 v[20:23], v[196:199], v[212:215], v[20:23]
  v_mfma_f32_16x16x32_bf16 v[36:39], v[196:199], v[216:219], v[36:39]
  s_waitcnt lgkmcnt(5)
  v_mfma_f32_16x16x32_bf16 v[8:11], v[200:203], v[208:211], v[8:11]
  v_mfma_f32_16x16x32_bf16 v[24:27], v[200:203], v[212:215], v[24:27]
  v_mfma_f32_16x16x32_bf16 v[40:43], v[200:203], v[216:219], v[40:43]
  s_waitcnt lgkmcnt(0)
  v_mfma_f32_16x16x32_bf16 v[12:15], v[204:207], v[208:211], v[12:15]
  ds_read_b128 v[208:211], v240 offset:0
  v_mfma_f32_16x16x32_bf16 v[28:31], v[204:207], v[212:215], v[28:31]
  ds_read_b128 v[212:215], v240 offset:1024
  v_mfma_f32_16x16x32_bf16 v[44:47], v[204:207], v[216:219], v[44:47]
  ds_read_b128 v[216:219], v240 offset:8192
  v_mfma_f32_16x16x32_bf16 v[48:51], v[192:195], v[220:223], v[48:51]
  v_mfma_f32_16x16x32_bf16 v[64:67], v[192:195], v[224:227], v[64:67]
  v_mfma_f32_16x16x32_bf16 v[80:83], v[192:195], v[228:231], v[80:83]
  ds_read_b64_tr_b16 v[192:193], v236 offset:32768
  v_mfma_f32_16x16x32_bf16 v[52:55], v[196:199], v[220:223], v[52:55]
  ds_read_b64_tr_b16 v[194:195], v236 offset:40960
  v_mfma_f32_16x16x32_bf16 v[68:71], v[196:199], v[224:227], v[68:71]
  v_mfma_f32_16x16x32_bf16 v[84:87], v[196:199], v[228:231], v[84:87]
  ds_read_b64_tr_b16 v[196:197], v237 offset:32768
  v_mfma_f32_16x16x32_bf16 v[56:59], v[200:203], v[220:223], v[56:59]
  ds_read_b64_tr_b16 v[198:199], v237 offset:40960
  v_mfma_f32_16x16x32_bf16 v[72:75], v[200:203], v[224:227], v[72:75]
  v_mfma_f32_16x16x32_bf16 v[88:91], v[200:203], v[228:231], v[88:91]
  ds_read_b64_tr_b16 v[200:201], v238 offset:32768
  v_mfma_f32_16x16x32_bf16 v[60:63], v[204:207], v[220:223], v[60:63]
  ds_read_b64_tr_b16 v[202:203], v238 offset:40960
  v_mfma_f32_16x16x32_bf16 v[76:79], v[204:207], v[224:227], v[76:79]
  ds_read_b128 v[220:223], v240 offset:9216
  v_mfma_f32_16x16x32_bf16 v[92:95], v[204:207], v[228:231], v[92:95]
  ds_read_b128 v[224:227], v240 offset:16384
  ds_read_b128 v[228:231], v240 offset:17408
  ds_read_b64_tr_b16 v[204:205], v239 offset:32768
  ds_read_b64_tr_b16 v[206:207], v239 offset:40960
  s_barrier
  s_waitcnt lgkmcnt(9)
  v_mfma_f32_16x16x32_bf16 v[0:3], v[192:195], v[208:211], v[0:3]
  v_add_u32 v240, s78, v242
  v_mfma_f32_16x16x32_bf16 v[16:19], v[192:195], v[212:215], v[16:19]
  v_mfma_f32_16x16x32_bf16 v[32:35], v[192:195], v[216:219], v[32:35]
  s_waitcnt lgkmcnt(7)
  v_mfma_f32_16x16x32_bf16 v[4:7], v[196:199], v[208:211], v[4:7]
  v_mfma_f32_16x16x32_bf16 v[20:23], v[196:199], v[212:215], v[20:23]
  v_mfma_f32_16x16x32_bf16 v[36:39], v[196:199], v[216:219], v[36:39]
  s_waitcnt lgkmcnt(5)
  v_mfma_f32_16x16x32_bf16 v[8:11], v[200:203], v[208:211], v[8:11]
  v_mfma_f32_16x16x32_bf16 v[24:27], v[200:203], v[212:215], v[24:27]
  v_mfma_f32_16x16x32_bf16 v[40:43], v[200:203], v[216:219], v[40:43]
  s_waitcnt lgkmcnt(0)
  v_mfma_f32_16x16x32_bf16 v[12:15], v[204:207], v[208:211], v[12:15]
  ds_read_b128 v[208:211], v241 offset:0
  v_mfma_f32_16x16x32_bf16 v[28:31], v[204:207], v[212:215], v[28:31]
  ds_read_b128 v[212:215], v241 offset:1024
  v_mfma_f32_16x16x32_bf16 v[44:47], v[204:207], v[216:219], v[44:47]
  ds_read_b128 v[216:219], v241 offset:8192
  v_mfma_f32_16x16x32_bf16 v[48:51], v[192:195], v[220:223], v[48:51]
  v_mfma_f32_16x16x32_bf16 v[64:67], v[192:195], v[224:227], v[64:67]
  v_mfma_f32_16x16x32_bf16 v[80:83], v[192:195], v[228:231], v[80:83]
  ds_read_b64_tr_b16 v[192:193], v232 offset:40960
  v_mfma_f32_16x16x32_bf16 v[52:55], v[196:199], v[220:223], v[52:55]
  ds_read_b64_tr_b16 v[194:195], v232 offset:49152
  v_mfma_f32_16x16x32_bf16 v[68:71], v[196:199], v[224:227], v[68:71]
  v_mfma_f32_16x16x32_bf16 v[84:87], v[196:199], v[228:231], v[84:87]
  ds_read_b64_tr_b16 v[196:197], v233 offset:40960
  v_mfma_f32_16x16x32_bf16 v[56:59], v[200:203], v[220:223], v[56:59]
  ds_read_b64_tr_b16 v[198:199], v233 offset:49152
  v_mfma_f32_16x16x32_bf16 v[72:75], v[200:203], v[224:227], v[72:75]
  v_mfma_f32_16x16x32_bf16 v[88:91], v[200:203], v[228:231], v[88:91]
  ds_read_b64_tr_b16 v[200:201], v234 offset:40960
  v_mfma_f32_16x16x32_bf16 v[60:63], v[204:207], v[220:223], v[60:63]
  ds_read_b64_tr_b16 v[202:203], v234 offset:49152
  v_mfma_f32_16x16x32_bf16 v[76:79], v[204:207], v[224:227], v[76:79]
  ds_read_b128 v[220:223], v241 offset:9216
  v_mfma_f32_16x16x32_bf16 v[92:95], v[204:207], v[228:231], v[92:95]
  ds_read_b128 v[224:227], v241 offset:16384
  ds_read_b128 v[228:231], v241 offset:17408
  ds_read_b64_tr_b16 v[204:205], v235 offset:40960
  ds_read_b64_tr_b16 v[206:207], v235 offset:49152
  s_barrier
  s_waitcnt lgkmcnt(9)
  v_mfma_f32_16x16x32_bf16 v[0:3], v[192:195], v[208:211], v[0:3]
  v_add_u32 v241, s79, v242
  v_mfma_f32_16x16x32_bf16 v[16:19], v[192:195], v[212:215], v[16:19]
  v_mfma_f32_16x16x32_bf16 v[32:35], v[192:195], v[216:219], v[32:35]
  s_waitcnt lgkmcnt(7)
  v_mfma_f32_16x16x32_bf16 v[4:7], v[196:199], v[208:211], v[4:7]
  v_mfma_f32_16x16x32_bf16 v[20:23], v[196:199], v[212:215], v[20:23]
  v_mfma_f32_16x16x32_bf16 v[36:39], v[196:199], v[216:219], v[36:39]
  s_waitcnt lgkmcnt(5)
  v_mfma_f32_16x16x32_bf16 v[8:11], v[200:203], v[208:211], v[8:11]
  v_mfma_f32_16x16x32_bf16 v[24:27], v[200:203], v[212:215], v[24:27]
  v_mfma_f32_16x16x32_bf16 v[40:43], v[200:203], v[216:219], v[40:43]
  s_waitcnt lgkmcnt(0)
  v_mfma_f32_16x16x32_bf16 v[12:15], v[204:207], v[208:211], v[12:15]
  ds_read_b128 v[208:211], v240 offset:0
  v_mfma_f32_16x16x32_bf16 v[28:31], v[204:207], v[212:215], v[28:31]
  ds_read_b128 v[212:215], v240 offset:1024
  v_mfma_f32_16x16x32_bf16 v[44:47], v[204:207], v[216:219], v[44:47]
  ds_read_b128 v[216:219], v240 offset:8192
  v_mfma_f32_16x16x32_bf16 v[48:51], v[192:195], v[220:223], v[48:51]
  v_mfma_f32_16x16x32_bf16 v[64:67], v[192:195], v[224:227], v[64:67]
  v_mfma_f32_16x16x32_bf16 v[80:83], v[192:195], v[228:231], v[80:83]
  ds_read_b64_tr_b16 v[192:193], v232 offset:24576
  v_mfma_f32_16x16x32_bf16 v[52:55], v[196:199], v[220:223], v[52:55]
  ds_read_b64_tr_b16 v[194:195], v232 offset:32768
  v_mfma_f32_16x16x32_bf16 v[68:71], v[196:199], v[224:227], v[68:71]
  v_mfma_f32_16x16x32_bf16 v[84:87], v[196:199], v[228:231], v[84:87]
  ds_read_b64_tr_b16 v[196:197], v233 offset:24576
  v_mfma_f32_16x16x32_bf16 v[56:59], v[200:203], v[220:223], v[56:59]
  ds_read_b64_tr_b16 v[198:199], v233 offset:32768
  v_mfma_f32_16x16x32_bf16 v[72:75], v[200:203], v[224:227], v[72:75]
  v_mfma_f32_16x16x32_bf16 v[88:91], v[200:203], v[228:231], v[88:91]
  ds_read_b64_tr_b16 v[200:201], v234 offset:24576
  v_mfma_f32_16x16x32_bf16 v[60:63], v[204:207], v[220:223], v[60:63]
  ds_read_b64_tr_b16 v[202:203], v234 offset:32768
  v_mfma_f32_16x16x32_bf16 v[76:79], v[204:207], v[224:227], v[76:79]
  ds_read_b128 v[220:223], v240 offset:9216
  v_mfma_f32_16x16x32_bf16 v[92:95], v[204:207], v[228:231], v[92:95]
  ds_read_b128 v[224:227], v240 offset:16384
  ds_read_b128 v[228:231], v240 offset:17408
  ds_read_b64_tr_b16 v[204:205], v235 offset:24576
  ds_read_b64_tr_b16 v[206:207], v235 offset:32768
  s_barrier
  s_waitcnt lgkmcnt(9)
  v_mfma_f32_16x16x32_bf16 v[0:3], v[192:195], v[208:211], v[0:3]
  v_add_u32 v240, s80, v242
  v_mfma_f32_16x16x32_bf16 v[16:19], v[192:195], v[212:215], v[16:19]
  v_mfma_f32_16x16x32_bf16 v[32:35], v[192:195], v[216:219], v[32:35]
  s_waitcnt lgkmcnt(7)
  v_mfma_f32_16x16x32_bf16 v[4:7], v[196:199], v[208:211], v[4:7]
  v_mfma_f32_16x16x32_bf16 v[20:23], v[196:199], v[212:215], v[20:23]
  v_mfma_f32_16x16x32_bf16 v[36:39], v[196:199], v[216:219], v[36:39]
  s_waitcnt lgkmcnt(5)
  v_mfma_f32_16x16x32_bf16 v[8:11], v[200:203], v[208:211], v[8:11]
  v_mfma_f32_16x16x32_bf16 v[24:27], v[200:203], v[212:215], v[24:27]
  v_mfma_f32_16x16x32_bf16 v[40:43], v[200:203], v[216:219], v[40:43]
  s_waitcnt lgkmcnt(0)
  v_mfma_f32_16x16x32_bf16 v[12:15], v[204:207], v[208:211], v[12:15]
  ds_read_b128 v[208:211], v241 offset:0
  v_mfma_f32_16x16x32_bf16 v[28:31], v[204:207], v[212:215], v[28:31]
  ds_read_b128 v[212:215], v241 offset:1024
  v_mfma_f32_16x16x32_bf16 v[44:47], v[204:207], v[216:219], v[44:47]
  ds_read_b128 v[216:219], v241 offset:8192
  v_mfma_f32_16x16x32_bf16 v[48:51], v[192:195], v[220:223], v[48:51]
  v_mfma_f32_16x16x32_bf16 v[64:67], v[192:195], v[224:227], v[64:67]
  v_mfma_f32_16x16x32_bf16 v[80:83], v[192:195], v[228:231], v[80:83]
  ds_read_b64_tr_b16 v[192:193], v232 offset:57344
  v_mfma_f32_16x16x32_bf16 v[52:55], v[196:199], v[220:223], v[52:55]
  ds_read_b64_tr_b16 v[194:195], v236 offset:0
  v_mfma_f32_16x16x32_bf16 v[68:71], v[196:199], v[224:227], v[68:71]
  v_mfma_f32_16x16x32_bf16 v[84:87], v[196:199], v[228:231], v[84:87]
  ds_read_b64_tr_b16 v[196:197], v233 offset:57344
  v_mfma_f32_16x16x32_bf16 v[56:59], v[200:203], v[220:223], v[56:59]
  ds_read_b64_tr_b16 v[198:199], v237 offset:0
  v_mfma_f32_16x16x32_bf16 v[72:75], v[200:203], v[224:227], v[72:75]
  v_mfma_f32_16x16x32_bf16 v[88:91], v[200:203], v[228:231], v[88:91]
  ds_read_b64_tr_b16 v[200:201], v234 offset:57344
  v_mfma_f32_16x16x32_bf16 v[60:63], v[204:207], v[220:223], v[60:63]
  ds_read_b64_tr_b16 v[202:203], v238 offset:0
  v_mfma_f32_16x16x32_bf16 v[76:79], v[204:207], v[224:227], v[76:79]
  ds_read_b128 v[220:223], v241 offset:9216
  v_mfma_f32_16x16x32_bf16 v[92:95], v[204:207], v[228:231], v[92:95]
  ds_read_b128 v[224:227], v241 offset:16384
  ds_read_b128 v[228:231], v241 offset:17408
  ds_read_b64_tr_b16 v[204:205], v235 offset:57344
  ds_read_b64_tr_b16 v[206:207], v239 offset:0
  s_barrier
  s_waitcnt lgkmcnt(9)
  v_mfma_f32_16x16x32_bf16 v[0:3], v[192:195], v[208:211], v[0:3]
  v_add_u32 v241, s81, v242
  v_mfma_f32_16x16x32_bf16 v[16:19], v[192:195], v[212:215], v[16:19]
  v_mfma_f32_16x16x32_bf16 v[32:35], v[192:195], v[216:219], v[32:35]
  s_waitcnt lgkmcnt(7)
  v_mfma_f32_16x16x32_bf16 v[4:7], v[196:199], v[208:211], v[4:7]
  v_mfma_f32_16x16x32_bf16 v[20:23], v[196:199], v[212:215], v[20:23]
  v_mfma_f32_16x16x32_bf16 v[36:39], v[196:199], v[216:219], v[36:39]
  s_waitcnt lgkmcnt(5)
  v_mfma_f32_16x16x32_bf16 v[8:11], v[200:203], v[208:211], v[8:11]
  v_mfma_f32_16x16x32_bf16 v[24:27], v[200:203], v[212:215], v[24:27]
  v_mfma_f32_16x16x32_bf16 v[40:43], v[200:203], v[216:219], v[40:43]
  s_waitcnt lgkmcnt(0)
  v_mfma_f32_16x16x32_bf16 v[12:15], v[204:207], v[208:211], v[12:15]
  ds_read_b128 v[208:211], v240 offset:0
  v_mfma_f32_16x16x32_bf16 v[28:31], v[204:207], v[212:215], v[28:31]
  ds_read_b128 v[212:215], v240 offset:1024
  v_mfma_f32_16x16x32_bf16 v[44:47], v[204:207], v[216:219], v[44:47]
  ds_read_b128 v[216:219], v240 offset:8192
  v_mfma_f32_16x16x32_bf16 v[48:51], v[192:195], v[220:223], v[48:51]
  v_mfma_f32_16x16x32_bf16 v[64:67], v[192:195], v[224:227], v[64:67]
  v_mfma_f32_16x16x32_bf16 v[80:83], v[192:195], v[228:231], v[80:83]
  ds_read_b64_tr_b16 v[192:193], v236 offset:32768
  v_mfma_f32_16x16x32_bf16 v[52:55], v[196:199], v[220:223], v[52:55]
  ds_read_b64_tr_b16 v[194:195], v236 offset:40960
  v_mfma_f32_16x16x32_bf16 v[68:71], v[196:199], v[224:227], v[68:71]
  v_mfma_f32_16x16x32_bf16 v[84:87], v[196:199], v[228:231], v[84:87]
  ds_read_b64_tr_b16 v[196:197], v237 offset:32768
  v_mfma_f32_16x16x32_bf16 v[56:59], v[200:203], v[220:223], v[56:59]
  ds_read_b64_tr_b16 v[198:199], v237 offset:40960
  v_mfma_f32_16x16x32_bf16 v[72:75], v[200:203], v[224:227], v[72:75]
  v_mfma_f32_16x16x32_bf16 v[88:91], v[200:203], v[228:231], v[88:91]
  ds_read_b64_tr_b16 v[200:201], v238 offset:32768
  v_mfma_f32_16x16x32_bf16 v[60:63], v[204:207], v[220:223], v[60:63]
  ds_read_b64_tr_b16 v[202:203], v238 offset:40960
  v_mfma_f32_16x16x32_bf16 v[76:79], v[204:207], v[224:227], v[76:79]
  ds_read_b128 v[220:223], v240 offset:9216
  v_mfma_f32_16x16x32_bf16 v[92:95], v[204:207], v[228:231], v[92:95]
  ds_read_b128 v[224:227], v240 offset:16384
  ds_read_b128 v[228:231], v240 offset:17408
  ds_read_b64_tr_b16 v[204:205], v239 offset:32768
  ds_read_b64_tr_b16 v[206:207], v239 offset:40960
  s_barrier
  s_waitcnt lgkmcnt(9)
  v_mfma_f32_16x16x32_bf16 v[0:3], v[192:195], v[208:211], v[0:3]
  v_add_u32 v240, s82, v242
  v_mfma_f32_16x16x32_bf16 v[16:19], v[192:195], v[212:215], v[16:19]
  v_mfma_f32_16x16x32_bf16 v[32:35], v[192:195], v[216:219], v[32:35]
  s_waitcnt lgkmcnt(7)
  v_mfma_f32_16x16x32_bf16 v[4:7], v[196:199], v[208:211], v[4:7]
  v_mfma_f32_16x16x32_bf16 v[20:23], v[196:199], v[212:215], v[20:23]
  v_mfma_f32_16x16x32_bf16 v[36:39], v[196:199], v[216:219], v[36:39]
  s_waitcnt lgkmcnt(5)
  v_mfma_f32_16x16x32_bf16 v[8:11], v[200:203], v[208:211], v[8:11]
  v_mfma_f32_16x16x32_bf16 v[24:27], v[200:203], v[212:215], v[24:27]
  v_mfma_f32_16x16x32_bf16 v[40:43], v[200:203], v[216:219], v[40:43]
  s_waitcnt lgkmcnt(0)
  v_mfma_f32_16x16x32_bf16 v[12:15], v[204:207], v[208:211], v[12:15]
  ds_read_b128 v[208:211], v241 offset:0
  v_mfma_f32_16x16x32_bf16 v[28:31], v[204:207], v[212:215], v[28:31]
  ds_read_b128 v[212:215], v241 offset:1024
  v_mfma_f32_16x16x32_bf16 v[44:47], v[204:207], v[216:219], v[44:47]
  ds_read_b128 v[216:219], v241 offset:8192
  v_mfma_f32_16x16x32_bf16 v[48:51], v[192:195], v[220:223], v[48:51]
  v_mfma_f32_16x16x32_bf16 v[64:67], v[192:195], v[224:227], v[64:67]
  v_mfma_f32_16x16x32_bf16 v[80:83], v[192:195], v[228:231], v[80:83]
  ds_read_b64_tr_b16 v[192:193], v232 offset:40960
  v_mfma_f32_16x16x32_bf16 v[52:55], v[196:199], v[220:223], v[52:55]
  ds_read_b64_tr_b16 v[194:195], v232 offset:49152
  v_mfma_f32_16x16x32_bf16 v[68:71], v[196:199], v[224:227], v[68:71]
  v_mfma_f32_16x16x32_bf16 v[84:87], v[196:199], v[228:231], v[84:87]
  ds_read_b64_tr_b16 v[196:197], v233 offset:40960
  v_mfma_f32_16x16x32_bf16 v[56:59], v[200:203], v[220:223], v[56:59]
  ds_read_b64_tr_b16 v[198:199], v233 offset:49152
  v_mfma_f32_16x16x32_bf16 v[72:75], v[200:203], v[224:227], v[72:75]
  v_mfma_f32_16x16x32_bf16 v[88:91], v[200:203], v[228:231], v[88:91]
  ds_read_b64_tr_b16 v[200:201], v234 offset:40960
  v_mfma_f32_16x16x32_bf16 v[60:63], v[204:207], v[220:223], v[60:63]
  ds_read_b64_tr_b16 v[202:203], v234 offset:49152
  v_mfma_f32_16x16x32_bf16 v[76:79], v[204:207], v[224:227], v[76:79]
  ds_read_b128 v[220:223], v241 offset:9216
  v_mfma_f32_16x16x32_bf16 v[92:95], v[204:207], v[228:231], v[92:95]
  ds_read_b128 v[224:227], v241 offset:16384
  ds_read_b128 v[228:231], v241 offset:17408
  ds_read_b64_tr_b16 v[204:205], v235 offset:40960
  ds_read_b64_tr_b16 v[206:207], v235 offset:49152
  s_barrier
  s_waitcnt lgkmcnt(9)
  v_mfma_f32_16x16x32_bf16 v[0:3], v[192:195], v[208:211], v[0:3]
  v_add_u32 v241, s83, v242
  v_mfma_f32_16x16x32_bf16 v[16:19], v[192:195], v[212:215], v[16:19]
  v_mfma_f32_16x16x32_bf16 v[32:35], v[192:195], v[216:219], v[32:35]
  s_waitcnt lgkmcnt(7)
  v_mfma_f32_16x16x32_bf16 v[4:7], v[196:199], v[208:211], v[4:7]
  v_mfma_f32_16x16x32_bf16 v[20:23], v[196:199], v[212:215], v[20:23]
  v_mfma_f32_16x16x32_bf16 v[36:39], v[196:199], v[216:219], v[36:39]
  s_waitcnt lgkmcnt(5)
  v_mfma_f32_16x16x32_bf16 v[8:11], v[200:203], v[208:211], v[8:11]
  v_mfma_f32_16x16x32_bf16 v[24:27], v[200:203], v[212:215], v[24:27]
  v_mfma_f32_16x16x32_bf16 v[40:43], v[200:203], v[216:219], v[40:43]
  s_waitcnt lgkmcnt(0)
  v_mfma_f32_16x16x32_bf16 v[12:15], v[204:207], v[208:211], v[12:15]
  ds_read_b128 v[208:211], v240 offset:0
  v_mfma_f32_16x16x32_bf16 v[28:31], v[204:207], v[212:215], v[28:31]
  ds_read_b128 v[212:215], v240 offset:1024
  v_mfma_f32_16x16x32_bf16 v[44:47], v[204:207], v[216:219], v[44:47]
  ds_read_b128 v[216:219], v240 offset:8192
  v_mfma_f32_16x16x32_bf16 v[48:51], v[192:195], v[220:223], v[48:51]
  v_mfma_f32_16x16x32_bf16 v[64:67], v[192:195], v[224:227], v[64:67]
  v_mfma_f32_16x16x32_bf16 v[80:83], v[192:195], v[228:231], v[80:83]
  ds_read_b64_tr_b16 v[192:193], v232 offset:24576
  v_mfma_f32_16x16x32_bf16 v[52:55], v[196:199], v[220:223], v[52:55]
  ds_read_b64_tr_b16 v[194:195], v232 offset:32768
  v_mfma_f32_16x16x32_bf16 v[68:71], v[196:199], v[224:227], v[68:71]
  v_mfma_f32_16x16x32_bf16 v[84:87], v[196:199], v[228:231], v[84:87]
  ds_read_b64_tr_b16 v[196:197], v233 offset:24576
  v_mfma_f32_16x16x32_bf16 v[56:59], v[200:203], v[220:223], v[56:59]
  ds_read_b64_tr_b16 v[198:199], v233 offset:32768
  v_mfma_f32_16x16x32_bf16 v[72:75], v[200:203], v[224:227], v[72:75]
  v_mfma_f32_16x16x32_bf16 v[88:91], v[200:203], v[228:231], v[88:91]
  ds_read_b64_tr_b16 v[200:201], v234 offset:24576
  v_mfma_f32_16x16x32_bf16 v[60:63], v[204:207], v[220:223], v[60:63]
  ds_read_b64_tr_b16 v[202:203], v234 offset:32768
  v_mfma_f32_16x16x32_bf16 v[76:79], v[204:207], v[224:227], v[76:79]
  ds_read_b128 v[220:223], v240 offset:9216
  v_mfma_f32_16x16x32_bf16 v[92:95], v[204:207], v[228:231], v[92:95]
  ds_read_b128 v[224:227], v240 offset:16384
  ds_read_b128 v[228:231], v240 offset:17408
  ds_read_b64_tr_b16 v[204:205], v235 offset:24576
  ds_read_b64_tr_b16 v[206:207], v235 offset:32768
  s_barrier
  s_waitcnt lgkmcnt(9)
  v_mfma_f32_16x16x32_bf16 v[0:3], v[192:195], v[208:211], v[0:3]
  v_add_u32 v240, s68, v242
  v_mfma_f32_16x16x32_bf16 v[16:19], v[192:195], v[212:215], v[16:19]
  v_mfma_f32_16x16x32_bf16 v[32:35], v[192:195], v[216:219], v[32:35]
  s_waitcnt lgkmcnt(7)
  v_mfma_f32_16x16x32_bf16 v[4:7], v[196:199], v[208:211], v[4:7]
  v_mfma_f32_16x16x32_bf16 v[20:23], v[196:199], v[212:215], v[20:23]
  v_mfma_f32_16x16x32_bf16 v[36:39], v[196:199], v[216:219], v[36:39]
  s_waitcnt lgkmcnt(5)
  v_mfma_f32_16x16x32_bf16 v[8:11], v[200:203], v[208:211], v[8:11]
  v_mfma_f32_16x16x32_bf16 v[24:27], v[200:203], v[212:215], v[24:27]
  v_mfma_f32_16x16x32_bf16 v[40:43], v[200:203], v[216:219], v[40:43]
  s_waitcnt lgkmcnt(0)
  v_mfma_f32_16x16x32_bf16 v[12:15], v[204:207], v[208:211], v[12:15]
  ds_read_b128 v[208:211], v241 offset:0
  v_mfma_f32_16x16x32_bf16 v[28:31], v[204:207], v[212:215], v[28:31]
  ds_read_b128 v[212:215], v241 offset:1024
  v_mfma_f32_16x16x32_bf16 v[44:47], v[204:207], v[216:219], v[44:47]
  ds_read_b128 v[216:219], v241 offset:8192
  v_mfma_f32_16x16x32_bf16 v[48:51], v[192:195], v[220:223], v[48:51]
  v_mfma_f32_16x16x32_bf16 v[64:67], v[192:195], v[224:227], v[64:67]
  v_mfma_f32_16x16x32_bf16 v[80:83], v[192:195], v[228:231], v[80:83]
  ds_read_b64_tr_b16 v[192:193], v232 offset:57344
  v_mfma_f32_16x16x32_bf16 v[52:55], v[196:199], v[220:223], v[52:55]
  ds_read_b64_tr_b16 v[194:195], v236 offset:0
  v_mfma_f32_16x16x32_bf16 v[68:71], v[196:199], v[224:227], v[68:71]
  v_mfma_f32_16x16x32_bf16 v[84:87], v[196:199], v[228:231], v[84:87]
  ds_read_b64_tr_b16 v[196:197], v233 offset:57344
  v_mfma_f32_16x16x32_bf16 v[56:59], v[200:203], v[220:223], v[56:59]
  ds_read_b64_tr_b16 v[198:199], v237 offset:0
  v_mfma_f32_16x16x32_bf16 v[72:75], v[200:203], v[224:227], v[72:75]
  v_mfma_f32_16x16x32_bf16 v[88:91], v[200:203], v[228:231], v[88:91]
  ds_read_b64_tr_b16 v[200:201], v234 offset:57344
  v_mfma_f32_16x16x32_bf16 v[60:63], v[204:207], v[220:223], v[60:63]
  ds_read_b64_tr_b16 v[202:203], v238 offset:0
  v_mfma_f32_16x16x32_bf16 v[76:79], v[204:207], v[224:227], v[76:79]
  ds_read_b128 v[220:223], v241 offset:9216
  v_mfma_f32_16x16x32_bf16 v[92:95], v[204:207], v[228:231], v[92:95]
  ds_read_b128 v[224:227], v241 offset:16384
  ds_read_b128 v[228:231], v241 offset:17408
  ds_read_b64_tr_b16 v[204:205], v235 offset:57344
  ds_read_b64_tr_b16 v[206:207], v239 offset:0
  s_barrier
  s_waitcnt lgkmcnt(9)
  v_mfma_f32_16x16x32_bf16 v[0:3], v[192:195], v[208:211], v[0:3]
  v_add_u32 v241, s69, v242
  v_mfma_f32_16x16x32_bf16 v[16:19], v[192:195], v[212:215], v[16:19]
  v_mfma_f32_16x16x32_bf16 v[32:35], v[192:195], v[216:219], v[32:35]
  s_waitcnt lgkmcnt(7)
  v_mfma_f32_16x16x32_bf16 v[4:7], v[196:199], v[208:211], v[4:7]
  v_mfma_f32_16x16x32_bf16 v[20:23], v[196:199], v[212:215], v[20:23]
  v_mfma_f32_16x16x32_bf16 v[36:39], v[196:199], v[216:219], v[36:39]
  s_waitcnt lgkmcnt(5)
  v_mfma_f32_16x16x32_bf16 v[8:11], v[200:203], v[208:211], v[8:11]
  v_mfma_f32_16x16x32_bf16 v[24:27], v[200:203], v[212:215], v[24:27]
  v_mfma_f32_16x16x32_bf16 v[40:43], v[200:203], v[216:219], v[40:43]
  s_waitcnt lgkmcnt(0)
  v_mfma_f32_16x16x32_bf16 v[12:15], v[204:207], v[208:211], v[12:15]
  ds_read_b128 v[208:211], v240 offset:0
  v_mfma_f32_16x16x32_bf16 v[28:31], v[204:207], v[212:215], v[28:31]
  ds_read_b128 v[212:215], v240 offset:1024
  v_mfma_f32_16x16x32_bf16 v[44:47], v[204:207], v[216:219], v[44:47]
  ds_read_b128 v[216:219], v240 offset:8192
  v_mfma_f32_16x16x32_bf16 v[48:51], v[192:195], v[220:223], v[48:51]
  v_mfma_f32_16x16x32_bf16 v[64:67], v[192:195], v[224:227], v[64:67]
  v_mfma_f32_16x16x32_bf16 v[80:83], v[192:195], v[228:231], v[80:83]
  ds_read_b64_tr_b16 v[192:193], v236 offset:32768
  v_mfma_f32_16x16x32_bf16 v[52:55], v[196:199], v[220:223], v[52:55]
  ds_read_b64_tr_b16 v[194:195], v236 offset:40960
  v_mfma_f32_16x16x32_bf16 v[68:71], v[196:199], v[224:227], v[68:71]
  v_mfma_f32_16x16x32_bf16 v[84:87], v[196:199], v[228:231], v[84:87]
  ds_read_b64_tr_b16 v[196:197], v237 offset:32768
  v_mfma_f32_16x16x32_bf16 v[56:59], v[200:203], v[220:223], v[56:59]
  ds_read_b64_tr_b16 v[198:199], v237 offset:40960
  v_mfma_f32_16x16x32_bf16 v[72:75], v[200:203], v[224:227], v[72:75]
  v_mfma_f32_16x16x32_bf16 v[88:91], v[200:203], v[228:231], v[88:91]
  ds_read_b64_tr_b16 v[200:201], v238 offset:32768
  v_mfma_f32_16x16x32_bf16 v[60:63], v[204:207], v[220:223], v[60:63]
  ds_read_b64_tr_b16 v[202:203], v238 offset:40960
  v_mfma_f32_16x16x32_bf16 v[76:79], v[204:207], v[224:227], v[76:79]
  ds_read_b128 v[220:223], v240 offset:9216
  v_mfma_f32_16x16x32_bf16 v[92:95], v[204:207], v[228:231], v[92:95]
  ds_read_b128 v[224:227], v240 offset:16384
  ds_read_b128 v[228:231], v240 offset:17408
  ds_read_b64_tr_b16 v[204:205], v239 offset:32768
  ds_read_b64_tr_b16 v[206:207], v239 offset:40960
  s_barrier
  s_lshl_b32 s63, s55, 2
  s_add_u32 s63, s63, s51
  s_lshl_b32 s63, s63, 1
  s_and_b32 s49, s24, 1
  s_xor_b32 s49, s49, 0
  s_add_u32 s63, s63, s49
  s_lshl_b32 s63, s63, 3
  s_add_u32 s63, s63, s28
  s_mul_i32 s63, s63, 12288
  s_waitcnt lgkmcnt(9)
  v_mfma_f32_16x16x32_bf16 v[96:99], v[192:195], v[208:211], v[96:99]
  v_add_u32 v240, s70, v242
  v_mfma_f32_16x16x32_bf16 v[112:115], v[192:195], v[212:215], v[112:115]
  v_cvt_pk_bf16_f32 v244, v0, v1
  v_cvt_pk_bf16_f32 v245, v2, v3
  v_mfma_f32_16x16x32_bf16 v[128:131], v[192:195], v[216:219], v[128:131]
  v_cvt_pk_bf16_f32 v246, v4, v5
  v_cvt_pk_bf16_f32 v247, v6, v7
  s_waitcnt lgkmcnt(7)
  v_mfma_f32_16x16x32_bf16 v[100:103], v[196:199], v[208:211], v[100:103]
  v_cvt_pk_bf16_f32 v248, v8, v9
  v_cvt_pk_bf16_f32 v249, v10, v11
  v_mfma_f32_16x16x32_bf16 v[116:119], v[196:199], v[212:215], v[116:119]
  v_cvt_pk_bf16_f32 v250, v12, v13
  v_cvt_pk_bf16_f32 v251, v14, v15
  v_mfma_f32_16x16x32_bf16 v[132:135], v[196:199], v[216:219], v[132:135]
  s_add_u32 s50, s63, 0
  s_waitcnt lgkmcnt(5)
  v_mfma_f32_16x16x32_bf16 v[104:107], v[200:203], v[208:211], v[104:107]
  v_mfma_f32_16x16x32_bf16 v[120:123], v[200:203], v[212:215], v[120:123]
  v_mfma_f32_16x16x32_bf16 v[136:139], v[200:203], v[216:219], v[136:139]
  s_waitcnt lgkmcnt(0)
  v_mfma_f32_16x16x32_bf16 v[108:111], v[204:207], v[208:211], v[108:111]
  ds_read_b128 v[208:211], v241 offset:0
  v_mfma_f32_16x16x32_bf16 v[124:127], v[204:207], v[212:215], v[124:127]
  ds_read_b128 v[212:215], v241 offset:1024
  v_mfma_f32_16x16x32_bf16 v[140:143], v[204:207], v[216:219], v[140:143]
  ds_read_b128 v[216:219], v241 offset:8192
  v_mfma_f32_16x16x32_bf16 v[144:147], v[192:195], v[220:223], v[144:147]
  v_mfma_f32_16x16x32_bf16 v[160:163], v[192:195], v[224:227], v[160:163]
  v_mfma_f32_16x16x32_bf16 v[176:179], v[192:195], v[228:231], v[176:179]
  ds_read_b64_tr_b16 v[192:193], v232 offset:40960
  v_mfma_f32_16x16x32_bf16 v[148:151], v[196:199], v[220:223], v[148:151]
  ds_read_b64_tr_b16 v[194:195], v232 offset:49152
  v_mfma_f32_16x16x32_bf16 v[164:167], v[196:199], v[224:227], v[164:167]
  buffer_store_dwordx4 v[244:247], v242, s[36:39], s50 offen sc1
  v_mfma_f32_16x16x32_bf16 v[180:183], v[196:199], v[228:231], v[180:183]
  ds_read_b64_tr_b16 v[196:197], v233 offset:40960
  v_mfma_f32_16x16x32_bf16 v[152:155], v[200:203], v[220:223], v[152:155]
  ds_read_b64_tr_b16 v[198:199], v233 offset:49152
  buffer_store_dwordx4 v[248:251], v242, s[36:39], s50 offen offset:1024 sc1
  v_mfma_f32_16x16x32_bf16 v[168:171], v[200:203], v[224:227], v[168:171]
  v_mfma_f32_16x16x32_bf16 v[184:187], v[200:203], v[228:231], v[184:187]
  ds_read_b64_tr_b16 v[200:201], v234 offset:40960
  v_mfma_f32_16x16x32_bf16 v[156:159], v[204:207], v[220:223], v[156:159]
  ds_read_b64_tr_b16 v[202:203], v234 offset:49152
  v_mfma_f32_16x16x32_bf16 v[172:175], v[204:207], v[224:227], v[172:175]
  ds_read_b128 v[220:223], v241 offset:9216
  v_mfma_f32_16x16x32_bf16 v[188:191], v[204:207], v[228:231], v[188:191]
  ds_read_b128 v[224:227], v241 offset:16384
  ds_read_b128 v[228:231], v241 offset:17408
  ds_read_b64_tr_b16 v[204:205], v235 offset:40960
  ds_read_b64_tr_b16 v[206:207], v235 offset:49152
  s_barrier
  s_waitcnt lgkmcnt(9)
  v_mfma_f32_16x16x32_bf16 v[96:99], v[192:195], v[208:211], v[96:99]
  v_add_u32 v241, s71, v242
  v_mfma_f32_16x16x32_bf16 v[112:115], v[192:195], v[212:215], v[112:115]
  v_cvt_pk_bf16_f32 v244, v16, v17
  v_cvt_pk_bf16_f32 v245, v18, v19
  v_mfma_f32_16x16x32_bf16 v[128:131], v[192:195], v[216:219], v[128:131]
  v_cvt_pk_bf16_f32 v246, v20, v21
  v_cvt_pk_bf16_f32 v247, v22, v23
  s_waitcnt lgkmcnt(7)
  v_mfma_f32_16x16x32_bf16 v[100:103], v[196:199], v[208:211], v[100:103]
  v_cvt_pk_bf16_f32 v248, v24, v25
  v_cvt_pk_bf16_f32 v249, v26, v27
  v_mfma_f32_16x16x32_bf16 v[116:119], v[196:199], v[212:215], v[116:119]
  v_cvt_pk_bf16_f32 v250, v28, v29
  v_cvt_pk_bf16_f32 v251, v30, v31
  v_mfma_f32_16x16x32_bf16 v[132:135], v[196:199], v[216:219], v[132:135]
  s_add_u32 s50, s63, 2048
  s_waitcnt lgkmcnt(5)
  v_mfma_f32_16x16x32_bf16 v[104:107], v[200:203], v[208:211], v[104:107]
  v_mfma_f32_16x16x32_bf16 v[120:123], v[200:203], v[212:215], v[120:123]
  v_mfma_f32_16x16x32_bf16 v[136:139], v[200:203], v[216:219], v[136:139]
  s_waitcnt lgkmcnt(0)
  v_mfma_f32_16x16x32_bf16 v[108:111], v[204:207], v[208:211], v[108:111]
  ds_read_b128 v[208:211], v240 offset:0
  v_mfma_f32_16x16x32_bf16 v[124:127], v[204:207], v[212:215], v[124:127]
  ds_read_b128 v[212:215], v240 offset:1024
  v_mfma_f32_16x16x32_bf16 v[140:143], v[204:207], v[216:219], v[140:143]
  ds_read_b128 v[216:219], v240 offset:8192
  v_mfma_f32_16x16x32_bf16 v[144:147], v[192:195], v[220:223], v[144:147]
  v_mfma_f32_16x16x32_bf16 v[160:163], v[192:195], v[224:227], v[160:163]
  v_mfma_f32_16x16x32_bf16 v[176:179], v[192:195], v[228:231], v[176:179]
  ds_read_b64_tr_b16 v[192:193], v232 offset:24576
  v_mfma_f32_16x16x32_bf16 v[148:151], v[196:199], v[220:223], v[148:151]
  ds_read_b64_tr_b16 v[194:195], v232 offset:32768
  v_mfma_f32_16x16x32_bf16 v[164:167], v[196:199], v[224:227], v[164:167]
  buffer_store_dwordx4 v[244:247], v242, s[36:39], s50 offen sc1
  v_mfma_f32_16x16x32_bf16 v[180:183], v[196:199], v[228:231], v[180:183]
  ds_read_b64_tr_b16 v[196:197], v233 offset:24576
  v_mfma_f32_16x16x32_bf16 v[152:155], v[200:203], v[220:223], v[152:155]
  ds_read_b64_tr_b16 v[198:199], v233 offset:32768
  buffer_store_dwordx4 v[248:251], v242, s[36:39], s50 offen offset:1024 sc1
  v_mfma_f32_16x16x32_bf16 v[168:171], v[200:203], v[224:227], v[168:171]
  v_mfma_f32_16x16x32_bf16 v[184:187], v[200:203], v[228:231], v[184:187]
  ds_read_b64_tr_b16 v[200:201], v234 offset:24576
  v_mfma_f32_16x16x32_bf16 v[156:159], v[204:207], v[220:223], v[156:159]
  ds_read_b64_tr_b16 v[202:203], v234 offset:32768
  v_mfma_f32_16x16x32_bf16 v[172:175], v[204:207], v[224:227], v[172:175]
  ds_read_b128 v[220:223], v240 offset:9216
  v_mfma_f32_16x16x32_bf16 v[188:191], v[204:207], v[228:231], v[188:191]
  ds_read_b128 v[224:227], v240 offset:16384
  ds_read_b128 v[228:231], v240 offset:17408
  ds_read_b64_tr_b16 v[204:205], v235 offset:24576
  ds_read_b64_tr_b16 v[206:207], v235 offset:32768
  s_barrier
  s_waitcnt lgkmcnt(9)
  v_mfma_f32_16x16x32_bf16 v[96:99], v[192:195], v[208:211], v[96:99]
  v_add_u32 v240, s72, v242
  v_mfma_f32_16x16x32_bf16 v[112:115], v[192:195], v[212:215], v[112:115]
  v_cvt_pk_bf16_f32 v244, v32, v33
  v_cvt_pk_bf16_f32 v245, v34, v35
  v_mfma_f32_16x16x32_bf16 v[128:131], v[192:195], v[216:219], v[128:131]
  v_cvt_pk_bf16_f32 v246, v36, v37
  v_cvt_pk_bf16_f32 v247, v38, v39
  s_waitcnt lgkmcnt(7)
  v_mfma_f32_16x16x32_bf16 v[100:103], v[196:199], v[208:211], v[100:103]
  v_cvt_pk_bf16_f32 v248, v40, v41
  v_cvt_pk_bf16_f32 v249, v42, v43
  v_mfma_f32_16x16x32_bf16 v[116:119], v[196:199], v[212:215], v[116:119]
  v_cvt_pk_bf16_f32 v250, v44, v45
  v_cvt_pk_bf16_f32 v251, v46, v47
  v_mfma_f32_16x16x32_bf16 v[132:135], v[196:199], v[216:219], v[132:135]
  s_add_u32 s50, s63, 4096
  s_waitcnt lgkmcnt(5)
  v_mfma_f32_16x16x32_bf16 v[104:107], v[200:203], v[208:211], v[104:107]
  v_mfma_f32_16x16x32_bf16 v[120:123], v[200:203], v[212:215], v[120:123]
  v_mfma_f32_16x16x32_bf16 v[136:139], v[200:203], v[216:219], v[136:139]
  s_waitcnt lgkmcnt(0)
  v_mfma_f32_16x16x32_bf16 v[108:111], v[204:207], v[208:211], v[108:111]
  ds_read_b128 v[208:211], v241 offset:0
  v_mfma_f32_16x16x32_bf16 v[124:127], v[204:207], v[212:215], v[124:127]
  ds_read_b128 v[212:215], v241 offset:1024
  v_mfma_f32_16x16x32_bf16 v[140:143], v[204:207], v[216:219], v[140:143]
  ds_read_b128 v[216:219], v241 offset:8192
  v_mfma_f32_16x16x32_bf16 v[144:147], v[192:195], v[220:223], v[144:147]
  v_mfma_f32_16x16x32_bf16 v[160:163], v[192:195], v[224:227], v[160:163]
  v_mfma_f32_16x16x32_bf16 v[176:179], v[192:195], v[228:231], v[176:179]
  ds_read_b64_tr_b16 v[192:193], v232 offset:57344
  v_mfma_f32_16x16x32_bf16 v[148:151], v[196:199], v[220:223], v[148:151]
  ds_read_b64_tr_b16 v[194:195], v236 offset:0
  v_mfma_f32_16x16x32_bf16 v[164:167], v[196:199], v[224:227], v[164:167]
  buffer_store_dwordx4 v[244:247], v242, s[36:39], s50 offen sc1
  v_mfma_f32_16x16x32_bf16 v[180:183], v[196:199], v[228:231], v[180:183]
  ds_read_b64_tr_b16 v[196:197], v233 offset:57344
  v_mfma_f32_16x16x32_bf16 v[152:155], v[200:203], v[220:223], v[152:155]
  ds_read_b64_tr_b16 v[198:199], v237 offset:0
  buffer_store_dwordx4 v[248:251], v242, s[36:39], s50 offen offset:1024 sc1
  v_mfma_f32_16x16x32_bf16 v[168:171], v[200:203], v[224:227], v[168:171]
  v_mfma_f32_16x16x32_bf16 v[184:187], v[200:203], v[228:231], v[184:187]
  ds_read_b64_tr_b16 v[200:201], v234 offset:57344
  v_mfma_f32_16x16x32_bf16 v[156:159], v[204:207], v[220:223], v[156:159]
  ds_read_b64_tr_b16 v[202:203], v238 offset:0
  v_mfma_f32_16x16x32_bf16 v[172:175], v[204:207], v[224:227], v[172:175]
  ds_read_b128 v[220:223], v241 offset:9216
  v_mfma_f32_16x16x32_bf16 v[188:191], v[204:207], v[228:231], v[188:191]
  ds_read_b128 v[224:227], v241 offset:16384
  ds_read_b128 v[228:231], v241 offset:17408
  ds_read_b64_tr_b16 v[204:205], v235 offset:57344
  ds_read_b64_tr_b16 v[206:207], v239 offset:0
  s_barrier
  s_waitcnt lgkmcnt(9)
  v_mfma_f32_16x16x32_bf16 v[96:99], v[192:195], v[208:211], v[96:99]
  v_add_u32 v241, s73, v242
  v_mfma_f32_16x16x32_bf16 v[112:115], v[192:195], v[212:215], v[112:115]
  v_cvt_pk_bf16_f32 v244, v48, v49
  v_cvt_pk_bf16_f32 v245, v50, v51
  v_mfma_f32_16x16x32_bf16 v[128:131], v[192:195], v[216:219], v[128:131]
  v_cvt_pk_bf16_f32 v246, v52, v53
  v_cvt_pk_bf16_f32 v247, v54, v55
  s_waitcnt lgkmcnt(7)
  v_mfma_f32_16x16x32_bf16 v[100:103], v[196:199], v[208:211], v[100:103]
  v_cvt_pk_bf16_f32 v248, v56, v57
  v_cvt_pk_bf16_f32 v249, v58, v59
  v_mfma_f32_16x16x32_bf16 v[116:119], v[196:199], v[212:215], v[116:119]
  v_cvt_pk_bf16_f32 v250, v60, v61
  v_cvt_pk_bf16_f32 v251, v62, v63
  v_mfma_f32_16x16x32_bf16 v[132:135], v[196:199], v[216:219], v[132:135]
  s_add_u32 s50, s63, 6144
  s_waitcnt lgkmcnt(5)
  v_mfma_f32_16x16x32_bf16 v[104:107], v[200:203], v[208:211], v[104:107]
  v_mfma_f32_16x16x32_bf16 v[120:123], v[200:203], v[212:215], v[120:123]
  v_mfma_f32_16x16x32_bf16 v[136:139], v[200:203], v[216:219], v[136:139]
  s_waitcnt lgkmcnt(0)
  v_mfma_f32_16x16x32_bf16 v[108:111], v[204:207], v[208:211], v[108:111]
  ds_read_b128 v[208:211], v240 offset:0
  v_mfma_f32_16x16x32_bf16 v[124:127], v[204:207], v[212:215], v[124:127]
  ds_read_b128 v[212:215], v240 offset:1024
  v_mfma_f32_16x16x32_bf16 v[140:143], v[204:207], v[216:219], v[140:143]
  ds_read_b128 v[216:219], v240 offset:8192
  v_mfma_f32_16x16x32_bf16 v[144:147], v[192:195], v[220:223], v[144:147]
  v_mfma_f32_16x16x32_bf16 v[160:163], v[192:195], v[224:227], v[160:163]
  v_mfma_f32_16x16x32_bf16 v[176:179], v[192:195], v[228:231], v[176:179]
  ds_read_b64_tr_b16 v[192:193], v236 offset:32768
  v_mfma_f32_16x16x32_bf16 v[148:151], v[196:199], v[220:223], v[148:151]
  ds_read_b64_tr_b16 v[194:195], v236 offset:40960
  v_mfma_f32_16x16x32_bf16 v[164:167], v[196:199], v[224:227], v[164:167]
  buffer_store_dwordx4 v[244:247], v242, s[36:39], s50 offen sc1
  v_mfma_f32_16x16x32_bf16 v[180:183], v[196:199], v[228:231], v[180:183]
  ds_read_b64_tr_b16 v[196:197], v237 offset:32768
  v_mfma_f32_16x16x32_bf16 v[152:155], v[200:203], v[220:223], v[152:155]
  ds_read_b64_tr_b16 v[198:199], v237 offset:40960
  buffer_store_dwordx4 v[248:251], v242, s[36:39], s50 offen offset:1024 sc1
  v_mfma_f32_16x16x32_bf16 v[168:171], v[200:203], v[224:227], v[168:171]
  v_mfma_f32_16x16x32_bf16 v[184:187], v[200:203], v[228:231], v[184:187]
  ds_read_b64_tr_b16 v[200:201], v238 offset:32768
  v_mfma_f32_16x16x32_bf16 v[156:159], v[204:207], v[220:223], v[156:159]
  ds_read_b64_tr_b16 v[202:203], v238 offset:40960
  v_mfma_f32_16x16x32_bf16 v[172:175], v[204:207], v[224:227], v[172:175]
  ds_read_b128 v[220:223], v240 offset:9216
  v_mfma_f32_16x16x32_bf16 v[188:191], v[204:207], v[228:231], v[188:191]
  ds_read_b128 v[224:227], v240 offset:16384
  ds_read_b128 v[228:231], v240 offset:17408
  ds_read_b64_tr_b16 v[204:205], v239 offset:32768
  ds_read_b64_tr_b16 v[206:207], v239 offset:40960
  s_barrier
  s_waitcnt lgkmcnt(9)
  v_mfma_f32_16x16x32_bf16 v[96:99], v[192:195], v[208:211], v[96:99]
  v_add_u32 v240, s74, v242
  v_mfma_f32_16x16x32_bf16 v[112:115], v[192:195], v[212:215], v[112:115]
  v_cvt_pk_bf16_f32 v244, v64, v65
  v_cvt_pk_bf16_f32 v245, v66, v67
  v_mfma_f32_16x16x32_bf16 v[128:131], v[192:195], v[216:219], v[128:131]
  v_cvt_pk_bf16_f32 v246, v68, v69
  v_cvt_pk_bf16_f32 v247, v70, v71
  s_waitcnt lgkmcnt(7)
  v_mfma_f32_16x16x32_bf16 v[100:103], v[196:199], v[208:211], v[100:103]
  v_cvt_pk_bf16_f32 v248, v72, v73
  v_cvt_pk_bf16_f32 v249, v74, v75
  v_mfma_f32_16x16x32_bf16 v[116:119], v[196:199], v[212:215], v[116:119]
  v_cvt_pk_bf16_f32 v250, v76, v77
  v_cvt_pk_bf16_f32 v251, v78, v79
  v_mfma_f32_16x16x32_bf16 v[132:135], v[196:199], v[216:219], v[132:135]
  s_add_u32 s50, s63, 8192
  s_waitcnt lgkmcnt(5)
  v_mfma_f32_16x16x32_bf16 v[104:107], v[200:203], v[208:211], v[104:107]
  v_mfma_f32_16x16x32_bf16 v[120:123], v[200:203], v[212:215], v[120:123]
  v_mfma_f32_16x16x32_bf16 v[136:139], v[200:203], v[216:219], v[136:139]
  s_waitcnt lgkmcnt(0)
  v_mfma_f32_16x16x32_bf16 v[108:111], v[204:207], v[208:211], v[108:111]
  ds_read_b128 v[208:211], v241 offset:0
  v_mfma_f32_16x16x32_bf16 v[124:127], v[204:207], v[212:215], v[124:127]
  ds_read_b128 v[212:215], v241 offset:1024
  v_mfma_f32_16x16x32_bf16 v[140:143], v[204:207], v[216:219], v[140:143]
  ds_read_b128 v[216:219], v241 offset:8192
  v_mfma_f32_16x16x32_bf16 v[144:147], v[192:195], v[220:223], v[144:147]
  v_mfma_f32_16x16x32_bf16 v[160:163], v[192:195], v[224:227], v[160:163]
  v_mfma_f32_16x16x32_bf16 v[176:179], v[192:195], v[228:231], v[176:179]
  ds_read_b64_tr_b16 v[192:193], v232 offset:40960
  v_mfma_f32_16x16x32_bf16 v[148:151], v[196:199], v[220:223], v[148:151]
  ds_read_b64_tr_b16 v[194:195], v232 offset:49152
  v_mfma_f32_16x16x32_bf16 v[164:167], v[196:199], v[224:227], v[164:167]
  buffer_store_dwordx4 v[244:247], v242, s[36:39], s50 offen sc1
  v_mfma_f32_16x16x32_bf16 v[180:183], v[196:199], v[228:231], v[180:183]
  ds_read_b64_tr_b16 v[196:197], v233 offset:40960
  v_mfma_f32_16x16x32_bf16 v[152:155], v[200:203], v[220:223], v[152:155]
  ds_read_b64_tr_b16 v[198:199], v233 offset:49152
  buffer_store_dwordx4 v[248:251], v242, s[36:39], s50 offen offset:1024 sc1
  v_mfma_f32_16x16x32_bf16 v[168:171], v[200:203], v[224:227], v[168:171]
  v_mfma_f32_16x16x32_bf16 v[184:187], v[200:203], v[228:231], v[184:187]
  ds_read_b64_tr_b16 v[200:201], v234 offset:40960
  v_mfma_f32_16x16x32_bf16 v[156:159], v[204:207], v[220:223], v[156:159]
  ds_read_b64_tr_b16 v[202:203], v234 offset:49152
  v_mfma_f32_16x16x32_bf16 v[172:175], v[204:207], v[224:227], v[172:175]
  ds_read_b128 v[220:223], v241 offset:9216
  v_mfma_f32_16x16x32_bf16 v[188:191], v[204:207], v[228:231], v[188:191]
  ds_read_b128 v[224:227], v241 offset:16384
  ds_read_b128 v[228:231], v241 offset:17408
  ds_read_b64_tr_b16 v[204:205], v235 offset:40960
  ds_read_b64_tr_b16 v[206:207], v235 offset:49152
  s_barrier
  s_waitcnt lgkmcnt(9)
  v_mfma_f32_16x16x32_bf16 v[96:99], v[192:195], v[208:211], v[96:99]
  v_add_u32 v241, s75, v242
  v_mfma_f32_16x16x32_bf16 v[112:115], v[192:195], v[212:215], v[112:115]
  v_cvt_pk_bf16_f32 v244, v80, v81
  v_cvt_pk_bf16_f32 v245, v82, v83
  v_mfma_f32_16x16x32_bf16 v[128:131], v[192:195], v[216:219], v[128:131]
  v_cvt_pk_bf16_f32 v246, v84, v85
  v_cvt_pk_bf16_f32 v247, v86, v87
  s_waitcnt lgkmcnt(7)
  v_mfma_f32_16x16x32_bf16 v[100:103], v[196:199], v[208:211], v[100:103]
  v_cvt_pk_bf16_f32 v248, v88, v89
  v_cvt_pk_bf16_f32 v249, v90, v91
  v_mfma_f32_16x16x32_bf16 v[116:119], v[196:199], v[212:215], v[116:119]
  v_cvt_pk_bf16_f32 v250, v92, v93
  v_cvt_pk_bf16_f32 v251, v94, v95
  v_mfma_f32_16x16x32_bf16 v[132:135], v[196:199], v[216:219], v[132:135]
  s_add_u32 s50, s63, 10240
  s_waitcnt lgkmcnt(5)
  v_mfma_f32_16x16x32_bf16 v[104:107], v[200:203], v[208:211], v[104:107]
  v_mfma_f32_16x16x32_bf16 v[120:123], v[200:203], v[212:215], v[120:123]
  v_mfma_f32_16x16x32_bf16 v[136:139], v[200:203], v[216:219], v[136:139]
  s_waitcnt lgkmcnt(0)
  v_mfma_f32_16x16x32_bf16 v[108:111], v[204:207], v[208:211], v[108:111]
  ds_read_b128 v[208:211], v240 offset:0
  v_mfma_f32_16x16x32_bf16 v[124:127], v[204:207], v[212:215], v[124:127]
  ds_read_b128 v[212:215], v240 offset:1024
  v_mfma_f32_16x16x32_bf16 v[140:143], v[204:207], v[216:219], v[140:143]
  ds_read_b128 v[216:219], v240 offset:8192
  v_mfma_f32_16x16x32_bf16 v[144:147], v[192:195], v[220:223], v[144:147]
  v_mfma_f32_16x16x32_bf16 v[160:163], v[192:195], v[224:227], v[160:163]
  v_mfma_f32_16x16x32_bf16 v[176:179], v[192:195], v[228:231], v[176:179]
  ds_read_b64_tr_b16 v[192:193], v232 offset:24576
  v_mfma_f32_16x16x32_bf16 v[148:151], v[196:199], v[220:223], v[148:151]
  ds_read_b64_tr_b16 v[194:195], v232 offset:32768
  v_mfma_f32_16x16x32_bf16 v[164:167], v[196:199], v[224:227], v[164:167]
  buffer_store_dwordx4 v[244:247], v242, s[36:39], s50 offen sc1
  v_mfma_f32_16x16x32_bf16 v[180:183], v[196:199], v[228:231], v[180:183]
  ds_read_b64_tr_b16 v[196:197], v233 offset:24576
  v_mfma_f32_16x16x32_bf16 v[152:155], v[200:203], v[220:223], v[152:155]
  ds_read_b64_tr_b16 v[198:199], v233 offset:32768
  buffer_store_dwordx4 v[248:251], v242, s[36:39], s50 offen offset:1024 sc1
  v_mfma_f32_16x16x32_bf16 v[168:171], v[200:203], v[224:227], v[168:171]
  v_mfma_f32_16x16x32_bf16 v[184:187], v[200:203], v[228:231], v[184:187]
  ds_read_b64_tr_b16 v[200:201], v234 offset:24576
  v_mfma_f32_16x16x32_bf16 v[156:159], v[204:207], v[220:223], v[156:159]
  ds_read_b64_tr_b16 v[202:203], v234 offset:32768
  v_mfma_f32_16x16x32_bf16 v[172:175], v[204:207], v[224:227], v[172:175]
  ds_read_b128 v[220:223], v240 offset:9216
  v_mfma_f32_16x16x32_bf16 v[188:191], v[204:207], v[228:231], v[188:191]
  ds_read_b128 v[224:227], v240 offset:16384
  ds_read_b128 v[228:231], v240 offset:17408
  ds_read_b64_tr_b16 v[204:205], v235 offset:24576
  ds_read_b64_tr_b16 v[206:207], v235 offset:32768
  s_barrier
  s_waitcnt lgkmcnt(9)
  v_mfma_f32_16x16x32_bf16 v[96:99], v[192:195], v[208:211], v[96:99]
  v_add_u32 v240, s76, v242
  v_mfma_f32_16x16x32_bf16 v[112:115], v[192:195], v[212:215], v[112:115]
  v_mfma_f32_16x16x32_bf16 v[128:131], v[192:195], v[216:219], v[128:131]
  s_waitcnt lgkmcnt(7)
  v_mfma_f32_16x16x32_bf16 v[100:103], v[196:199], v[208:211], v[100:103]
  v_mfma_f32_16x16x32_bf16 v[116:119], v[196:199], v[212:215], v[116:119]
  v_mfma_f32_16x16x32_bf16 v[132:135], v[196:199], v[216:219], v[132:135]
  s_waitcnt lgkmcnt(5)
  v_mfma_f32_16x16x32_bf16 v[104:107], v[200:203], v[208:211], v[104:107]
  v_mfma_f32_16x16x32_bf16 v[120:123], v[200:203], v[212:215], v[120:123]
  v_mfma_f32_16x16x32_bf16 v[136:139], v[200:203], v[216:219], v[136:139]
  s_waitcnt lgkmcnt(0)
  v_mfma_f32_16x16x32_bf16 v[108:111], v[204:207], v[208:211], v[108:111]
  ds_read_b128 v[208:211], v241 offset:0
  v_mfma_f32_16x16x32_bf16 v[124:127], v[204:207], v[212:215], v[124:127]
  ds_read_b128 v[212:215], v241 offset:1024
  v_mfma_f32_16x16x32_bf16 v[140:143], v[204:207], v[216:219], v[140:143]
  ds_read_b128 v[216:219], v241 offset:8192
  v_mfma_f32_16x16x32_bf16 v[144:147], v[192:195], v[220:223], v[144:147]
  v_mfma_f32_16x16x32_bf16 v[160:163], v[192:195], v[224:227], v[160:163]
  v_mfma_f32_16x16x32_bf16 v[176:179], v[192:195], v[228:231], v[176:179]
  ds_read_b64_tr_b16 v[192:193], v232 offset:57344
  v_mfma_f32_16x16x32_bf16 v[148:151], v[196:199], v[220:223], v[148:151]
  ds_read_b64_tr_b16 v[194:195], v236 offset:0
  v_mfma_f32_16x16x32_bf16 v[164:167], v[196:199], v[224:227], v[164:167]
  v_mfma_f32_16x16x32_bf16 v[180:183], v[196:199], v[228:231], v[180:183]
  ds_read_b64_tr_b16 v[196:197], v233 offset:57344
  v_mfma_f32_16x16x32_bf16 v[152:155], v[200:203], v[220:223], v[152:155]
  ds_read_b64_tr_b16 v[198:199], v237 offset:0
  v_mfma_f32_16x16x32_bf16 v[168:171], v[200:203], v[224:227], v[168:171]
  v_mfma_f32_16x16x32_bf16 v[184:187], v[200:203], v[228:231], v[184:187]
  ds_read_b64_tr_b16 v[200:201], v234 offset:57344
  v_mfma_f32_16x16x32_bf16 v[156:159], v[204:207], v[220:223], v[156:159]
  ds_read_b64_tr_b16 v[202:203], v238 offset:0
  v_mfma_f32_16x16x32_bf16 v[172:175], v[204:207], v[224:227], v[172:175]
  ds_read_b128 v[220:223], v241 offset:9216
  v_mfma_f32_16x16x32_bf16 v[188:191], v[204:207], v[228:231], v[188:191]
  ds_read_b128 v[224:227], v241 offset:16384
  ds_read_b128 v[228:231], v241 offset:17408
  ds_read_b64_tr_b16 v[204:205], v235 offset:57344
  ds_read_b64_tr_b16 v[206:207], v239 offset:0
  s_barrier
  s_waitcnt lgkmcnt(9)
  v_mfma_f32_16x16x32_bf16 v[96:99], v[192:195], v[208:211], v[96:99]
  v_add_u32 v241, s77, v242
  v_mfma_f32_16x16x32_bf16 v[112:115], v[192:195], v[212:215], v[112:115]
  v_mfma_f32_16x16x32_bf16 v[128:131], v[192:195], v[216:219], v[128:131]
  s_waitcnt lgkmcnt(7)
  v_mfma_f32_16x16x32_bf16 v[100:103], v[196:199], v[208:211], v[100:103]
  v_mfma_f32_16x16x32_bf16 v[116:119], v[196:199], v[212:215], v[116:119]
  v_mfma_f32_16x16x32_bf16 v[132:135], v[196:199], v[216:219], v[132:135]
  s_waitcnt lgkmcnt(5)
  v_mfma_f32_16x16x32_bf16 v[104:107], v[200:203], v[208:211], v[104:107]
  v_mfma_f32_16x16x32_bf16 v[120:123], v[200:203], v[212:215], v[120:123]
  v_mfma_f32_16x16x32_bf16 v[136:139], v[200:203], v[216:219], v[136:139]
  s_waitcnt lgkmcnt(0)
  v_mfma_f32_16x16x32_bf16 v[108:111], v[204:207], v[208:211], v[108:111]
  ds_read_b128 v[208:211], v240 offset:0
  v_mfma_f32_16x16x32_bf16 v[124:127], v[204:207], v[212:215], v[124:127]
  ds_read_b128 v[212:215], v240 offset:1024
  v_mfma_f32_16x16x32_bf16 v[140:143], v[204:207], v[216:219], v[140:143]
  ds_read_b128 v[216:219], v240 offset:8192
  v_mfma_f32_16x16x32_bf16 v[144:147], v[192:195], v[220:223], v[144:147]
  v_mfma_f32_16x16x32_bf16 v[160:163], v[192:195], v[224:227], v[160:163]
  v_mfma_f32_16x16x32_bf16 v[176:179], v[192:195], v[228:231], v[176:179]
  ds_read_b64_tr_b16 v[192:193], v236 offset:32768
  v_mfma_f32_16x16x32_bf16 v[148:151], v[196:199], v[220:223], v[148:151]
  ds_read_b64_tr_b16 v[194:195], v236 offset:40960
  v_mfma_f32_16x16x32_bf16 v[164:167], v[196:199], v[224:227], v[164:167]
  v_mfma_f32_16x16x32_bf16 v[180:183], v[196:199], v[228:231], v[180:183]
  ds_read_b64_tr_b16 v[196:197], v237 offset:32768
  v_mfma_f32_16x16x32_bf16 v[152:155], v[200:203], v[220:223], v[152:155]
  ds_read_b64_tr_b16 v[198:199], v237 offset:40960
  v_mfma_f32_16x16x32_bf16 v[168:171], v[200:203], v[224:227], v[168:171]
  v_mfma_f32_16x16x32_bf16 v[184:187], v[200:203], v[228:231], v[184:187]
  ds_read_b64_tr_b16 v[200:201], v238 offset:32768
  v_mfma_f32_16x16x32_bf16 v[156:159], v[204:207], v[220:223], v[156:159]
  ds_read_b64_tr_b16 v[202:203], v238 offset:40960
  v_mfma_f32_16x16x32_bf16 v[172:175], v[204:207], v[224:227], v[172:175]
  ds_read_b128 v[220:223], v240 offset:9216
  v_mfma_f32_16x16x32_bf16 v[188:191], v[204:207], v[228:231], v[188:191]
  ds_read_b128 v[224:227], v240 offset:16384
  ds_read_b128 v[228:231], v240 offset:17408
  ds_read_b64_tr_b16 v[204:205], v239 offset:32768
  ds_read_b64_tr_b16 v[206:207], v239 offset:40960
  s_barrier
  s_waitcnt lgkmcnt(9)
  v_mfma_f32_16x16x32_bf16 v[96:99], v[192:195], v[208:211], v[96:99]
  v_add_u32 v240, s78, v242
  v_mfma_f32_16x16x32_bf16 v[112:115], v[192:195], v[212:215], v[112:115]
  v_mfma_f32_16x16x32_bf16 v[128:131], v[192:195], v[216:219], v[128:131]
  s_waitcnt lgkmcnt(7)
  v_mfma_f32_16x16x32_bf16 v[100:103], v[196:199], v[208:211], v[100:103]
  v_mfma_f32_16x16x32_bf16 v[116:119], v[196:199], v[212:215], v[116:119]
  v_mfma_f32_16x16x32_bf16 v[132:135], v[196:199], v[216:219], v[132:135]
  s_waitcnt lgkmcnt(5)
  v_mfma_f32_16x16x32_bf16 v[104:107], v[200:203], v[208:211], v[104:107]
  v_mfma_f32_16x16x32_bf16 v[120:123], v[200:203], v[212:215], v[120:123]
  v_mfma_f32_16x16x32_bf16 v[136:139], v[200:203], v[216:219], v[136:139]
  s_waitcnt lgkmcnt(0)
  v_mfma_f32_16x16x32_bf16 v[108:111], v[204:207], v[208:211], v[108:111]
  ds_read_b128 v[208:211], v241 offset:0
  v_mfma_f32_16x16x32_bf16 v[124:127], v[204:207], v[212:215], v[124:127]
  ds_read_b128 v[212:215], v241 offset:1024
  v_mfma_f32_16x16x32_bf16 v[140:143], v[204:207], v[216:219], v[140:143]
  ds_read_b128 v[216:219], v241 offset:8192
  v_mfma_f32_16x16x32_bf16 v[144:147], v[192:195], v[220:223], v[144:147]
  v_mfma_f32_16x16x32_bf16 v[160:163], v[192:195], v[224:227], v[160:163]
  v_mfma_f32_16x16x32_bf16 v[176:179], v[192:195], v[228:231], v[176:179]
  ds_read_b64_tr_b16 v[192:193], v232 offset:40960
  v_mfma_f32_16x16x32_bf16 v[148:151], v[196:199], v[220:223], v[148:151]
  ds_read_b64_tr_b16 v[194:195], v232 offset:49152
  v_mfma_f32_16x16x32_bf16 v[164:167], v[196:199], v[224:227], v[164:167]
  v_mfma_f32_16x16x32_bf16 v[180:183], v[196:199], v[228:231], v[180:183]
  ds_read_b64_tr_b16 v[196:197], v233 offset:40960
  v_mfma_f32_16x16x32_bf16 v[152:155], v[200:203], v[220:223], v[152:155]
  ds_read_b64_tr_b16 v[198:199], v233 offset:49152
  v_mfma_f32_16x16x32_bf16 v[168:171], v[200:203], v[224:227], v[168:171]
  v_mfma_f32_16x16x32_bf16 v[184:187], v[200:203], v[228:231], v[184:187]
  ds_read_b64_tr_b16 v[200:201], v234 offset:40960
  v_mfma_f32_16x16x32_bf16 v[156:159], v[204:207], v[220:223], v[156:159]
  ds_read_b64_tr_b16 v[202:203], v234 offset:49152
  v_mfma_f32_16x16x32_bf16 v[172:175], v[204:207], v[224:227], v[172:175]
  ds_read_b128 v[220:223], v241 offset:9216
  v_mfma_f32_16x16x32_bf16 v[188:191], v[204:207], v[228:231], v[188:191]
  ds_read_b128 v[224:227], v241 offset:16384
  ds_read_b128 v[228:231], v241 offset:17408
  ds_read_b64_tr_b16 v[204:205], v235 offset:40960
  ds_read_b64_tr_b16 v[206:207], v235 offset:49152
  s_barrier
  s_waitcnt lgkmcnt(9)
  v_mfma_f32_16x16x32_bf16 v[96:99], v[192:195], v[208:211], v[96:99]
  v_add_u32 v241, s79, v242
  v_mfma_f32_16x16x32_bf16 v[112:115], v[192:195], v[212:215], v[112:115]
  v_mfma_f32_16x16x32_bf16 v[128:131], v[192:195], v[216:219], v[128:131]
  s_waitcnt lgkmcnt(7)
  v_mfma_f32_16x16x32_bf16 v[100:103], v[196:199], v[208:211], v[100:103]
  v_mfma_f32_16x16x32_bf16 v[116:119], v[196:199], v[212:215], v[116:119]
  v_mfma_f32_16x16x32_bf16 v[132:135], v[196:199], v[216:219], v[132:135]
  s_waitcnt lgkmcnt(5)
  v_mfma_f32_16x16x32_bf16 v[104:107], v[200:203], v[208:211], v[104:107]
  v_mfma_f32_16x16x32_bf16 v[120:123], v[200:203], v[212:215], v[120:123]
  v_mfma_f32_16x16x32_bf16 v[136:139], v[200:203], v[216:219], v[136:139]
  s_waitcnt lgkmcnt(0)
  v_mfma_f32_16x16x32_bf16 v[108:111], v[204:207], v[208:211], v[108:111]
  ds_read_b128 v[208:211], v240 offset:0
  v_mfma_f32_16x16x32_bf16 v[124:127], v[204:207], v[212:215], v[124:127]
  ds_read_b128 v[212:215], v240 offset:1024
  v_mfma_f32_16x16x32_bf16 v[140:143], v[204:207], v[216:219], v[140:143]
  ds_read_b128 v[216:219], v240 offset:8192
  v_mfma_f32_16x16x32_bf16 v[144:147], v[192:195], v[220:223], v[144:147]
  v_mfma_f32_16x16x32_bf16 v[160:163], v[192:195], v[224:227], v[160:163]
  v_mfma_f32_16x16x32_bf16 v[176:179], v[192:195], v[228:231], v[176:179]
  ds_read_b64_tr_b16 v[192:193], v232 offset:24576
  v_mfma_f32_16x16x32_bf16 v[148:151], v[196:199], v[220:223], v[148:151]
  ds_read_b64_tr_b16 v[194:195], v232 offset:32768
  v_mfma_f32_16x16x32_bf16 v[164:167], v[196:199], v[224:227], v[164:167]
  v_mfma_f32_16x16x32_bf16 v[180:183], v[196:199], v[228:231], v[180:183]
  ds_read_b64_tr_b16 v[196:197], v233 offset:24576
  v_mfma_f32_16x16x32_bf16 v[152:155], v[200:203], v[220:223], v[152:155]
  ds_read_b64_tr_b16 v[198:199], v233 offset:32768
  v_mfma_f32_16x16x32_bf16 v[168:171], v[200:203], v[224:227], v[168:171]
  v_mfma_f32_16x16x32_bf16 v[184:187], v[200:203], v[228:231], v[184:187]
  ds_read_b64_tr_b16 v[200:201], v234 offset:24576
  v_mfma_f32_16x16x32_bf16 v[156:159], v[204:207], v[220:223], v[156:159]
  ds_read_b64_tr_b16 v[202:203], v234 offset:32768
  v_mfma_f32_16x16x32_bf16 v[172:175], v[204:207], v[224:227], v[172:175]
  ds_read_b128 v[220:223], v240 offset:9216
  v_mfma_f32_16x16x32_bf16 v[188:191], v[204:207], v[228:231], v[188:191]
  ds_read_b128 v[224:227], v240 offset:16384
  ds_read_b128 v[228:231], v240 offset:17408
  ds_read_b64_tr_b16 v[204:205], v235 offset:24576
  ds_read_b64_tr_b16 v[206:207], v235 offset:32768
  s_barrier
  s_waitcnt lgkmcnt(9)
  v_mfma_f32_16x16x32_bf16 v[96:99], v[192:195], v[208:211], v[96:99]
  v_add_u32 v240, s80, v242
  v_mfma_f32_16x16x32_bf16 v[112:115], v[192:195], v[212:215], v[112:115]
  v_mfma_f32_16x16x32_bf16 v[128:131], v[192:195], v[216:219], v[128:131]
  s_waitcnt lgkmcnt(7)
  v_mfma_f32_16x16x32_bf16 v[100:103], v[196:199], v[208:211], v[100:103]
  v_mfma_f32_16x16x32_bf16 v[116:119], v[196:199], v[212:215], v[116:119]
  v_mfma_f32_16x16x32_bf16 v[132:135], v[196:199], v[216:219], v[132:135]
  s_waitcnt lgkmcnt(5)
  v_mfma_f32_16x16x32_bf16 v[104:107], v[200:203], v[208:211], v[104:107]
  v_mfma_f32_16x16x32_bf16 v[120:123], v[200:203], v[212:215], v[120:123]
  v_mfma_f32_16x16x32_bf16 v[136:139], v[200:203], v[216:219], v[136:139]
  s_waitcnt lgkmcnt(0)
  v_mfma_f32_16x16x32_bf16 v[108:111], v[204:207], v[208:211], v[108:111]
  ds_read_b128 v[208:211], v241 offset:0
  v_mfma_f32_16x16x32_bf16 v[124:127], v[204:207], v[212:215], v[124:127]
  ds_read_b128 v[212:215], v241 offset:1024
  v_mfma_f32_16x16x32_bf16 v[140:143], v[204:207], v[216:219], v[140:143]
  ds_read_b128 v[216:219], v241 offset:8192
  v_mfma_f32_16x16x32_bf16 v[144:147], v[192:195], v[220:223], v[144:147]
  v_mfma_f32_16x16x32_bf16 v[160:163], v[192:195], v[224:227], v[160:163]
  v_mfma_f32_16x16x32_bf16 v[176:179], v[192:195], v[228:231], v[176:179]
  ds_read_b64_tr_b16 v[192:193], v232 offset:57344
  v_mfma_f32_16x16x32_bf16 v[148:151], v[196:199], v[220:223], v[148:151]
  ds_read_b64_tr_b16 v[194:195], v236 offset:0
  v_mfma_f32_16x16x32_bf16 v[164:167], v[196:199], v[224:227], v[164:167]
  v_mfma_f32_16x16x32_bf16 v[180:183], v[196:199], v[228:231], v[180:183]
  ds_read_b64_tr_b16 v[196:197], v233 offset:57344
  v_mfma_f32_16x16x32_bf16 v[152:155], v[200:203], v[220:223], v[152:155]
  ds_read_b64_tr_b16 v[198:199], v237 offset:0
  v_mfma_f32_16x16x32_bf16 v[168:171], v[200:203], v[224:227], v[168:171]
  v_mfma_f32_16x16x32_bf16 v[184:187], v[200:203], v[228:231], v[184:187]
  ds_read_b64_tr_b16 v[200:201], v234 offset:57344
  v_mfma_f32_16x16x32_bf16 v[156:159], v[204:207], v[220:223], v[156:159]
  ds_read_b64_tr_b16 v[202:203], v238 offset:0
  v_mfma_f32_16x16x32_bf16 v[172:175], v[204:207], v[224:227], v[172:175]
  ds_read_b128 v[220:223], v241 offset:9216
  v_mfma_f32_16x16x32_bf16 v[188:191], v[204:207], v[228:231], v[188:191]
  ds_read_b128 v[224:227], v241 offset:16384
  ds_read_b128 v[228:231], v241 offset:17408
  ds_read_b64_tr_b16 v[204:205], v235 offset:57344
  ds_read_b64_tr_b16 v[206:207], v239 offset:0
  s_barrier
  s_waitcnt lgkmcnt(9)
  v_mfma_f32_16x16x32_bf16 v[96:99], v[192:195], v[208:211], v[96:99]
  v_add_u32 v241, s81, v242
  v_mfma_f32_16x16x32_bf16 v[112:115], v[192:195], v[212:215], v[112:115]
  v_mfma_f32_16x16x32_bf16 v[128:131], v[192:195], v[216:219], v[128:131]
  s_waitcnt lgkmcnt(7)
  v_mfma_f32_16x16x32_bf16 v[100:103], v[196:199], v[208:211], v[100:103]
  v_mfma_f32_16x16x32_bf16 v[116:119], v[196:199], v[212:215], v[116:119]
  v_mfma_f32_16x16x32_bf16 v[132:135], v[196:199], v[216:219], v[132:135]
  s_waitcnt lgkmcnt(5)
  v_mfma_f32_16x16x32_bf16 v[104:107], v[200:203], v[208:211], v[104:107]
  v_mfma_f32_16x16x32_bf16 v[120:123], v[200:203], v[212:215], v[120:123]
  v_mfma_f32_16x16x32_bf16 v[136:139], v[200:203], v[216:219], v[136:139]
  s_waitcnt lgkmcnt(0)
  v_mfma_f32_16x16x32_bf16 v[108:111], v[204:207], v[208:211], v[108:111]
  ds_read_b128 v[208:211], v240 offset:0
  v_mfma_f32_16x16x32_bf16 v[124:127], v[204:207], v[212:215], v[124:127]
  ds_read_b128 v[212:215], v240 offset:1024
  v_mfma_f32_16x16x32_bf16 v[140:143], v[204:207], v[216:219], v[140:143]
  ds_read_b128 v[216:219], v240 offset:8192
  v_mfma_f32_16x16x32_bf16 v[144:147], v[192:195], v[220:223], v[144:147]
  v_mfma_f32_16x16x32_bf16 v[160:163], v[192:195], v[224:227], v[160:163]
  v_mfma_f32_16x16x32_bf16 v[176:179], v[192:195], v[228:231], v[176:179]
  ds_read_b64_tr_b16 v[192:193], v236 offset:32768
  v_mfma_f32_16x16x32_bf16 v[148:151], v[196:199], v[220:223], v[148:151]
  ds_read_b64_tr_b16 v[194:195], v236 offset:40960
  v_mfma_f32_16x16x32_bf16 v[164:167], v[196:199], v[224:227], v[164:167]
  v_mfma_f32_16x16x32_bf16 v[180:183], v[196:199], v[228:231], v[180:183]
  ds_read_b64_tr_b16 v[196:197], v237 offset:32768
  v_mfma_f32_16x16x32_bf16 v[152:155], v[200:203], v[220:223], v[152:155]
  ds_read_b64_tr_b16 v[198:199], v237 offset:40960
  v_mfma_f32_16x16x32_bf16 v[168:171], v[200:203], v[224:227], v[168:171]
  v_mfma_f32_16x16x32_bf16 v[184:187], v[200:203], v[228:231], v[184:187]
  ds_read_b64_tr_b16 v[200:201], v238 offset:32768
  v_mfma_f32_16x16x32_bf16 v[156:159], v[204:207], v[220:223], v[156:159]
  ds_read_b64_tr_b16 v[202:203], v238 offset:40960
  v_mfma_f32_16x16x32_bf16 v[172:175], v[204:207], v[224:227], v[172:175]
  ds_read_b128 v[220:223], v240 offset:9216
  v_mfma_f32_16x16x32_bf16 v[188:191], v[204:207], v[228:231], v[188:191]
  ds_read_b128 v[224:227], v240 offset:16384
  ds_read_b128 v[228:231], v240 offset:17408
  ds_read_b64_tr_b16 v[204:205], v239 offset:32768
  ds_read_b64_tr_b16 v[206:207], v239 offset:40960
  s_barrier
  s_waitcnt vmcnt(0)
  s_lshl_b32 s49, s55, 2
  s_add_u32 s49, s49, s51
  s_lshl_b32 s49, s49, 1
  s_and_b32 s50, s24, 1
  s_xor_b32 s50, s50, 0
  s_add_u32 s49, s49, s50
  s_lshl_b32 s49, s49, 7
  s_lshl_b32 s50, s28, 2
  s_add_u32 s49, s49, s50
  v_mov_b32 v244, 1
  v_mov_b32 v245, 0
  s_mov_b64 s[60:61], exec
  s_mov_b64 exec, 1
  buffer_store_dword v244, v245, s[64:67], s49 offen sc1
  s_mov_b64 exec, s[60:61]
  s_waitcnt lgkmcnt(9)
  v_mfma_f32_16x16x32_bf16 v[96:99], v[192:195], v[208:211], v[96:99]
  v_add_u32 v240, s82, v242
  v_mfma_f32_16x16x32_bf16 v[112:115], v[192:195], v[212:215], v[112:115]
  v_mfma_f32_16x16x32_bf16 v[128:131], v[192:195], v[216:219], v[128:131]
  s_waitcnt lgkmcnt(7)
  v_mfma_f32_16x16x32_bf16 v[100:103], v[196:199], v[208:211], v[100:103]
  v_mfma_f32_16x16x32_bf16 v[116:119], v[196:199], v[212:215], v[116:119]
  v_mfma_f32_16x16x32_bf16 v[132:135], v[196:199], v[216:219], v[132:135]
  s_waitcnt lgkmcnt(5)
  v_mfma_f32_16x16x32_bf16 v[104:107], v[200:203], v[208:211], v[104:107]
  v_mfma_f32_16x16x32_bf16 v[120:123], v[200:203], v[212:215], v[120:123]
  v_mfma_f32_16x16x32_bf16 v[136:139], v[200:203], v[216:219], v[136:139]
  s_waitcnt lgkmcnt(0)
  v_mfma_f32_16x16x32_bf16 v[108:111], v[204:207], v[208:211], v[108:111]
  ds_read_b128 v[208:211], v241 offset:0
  v_mfma_f32_16x16x32_bf16 v[124:127], v[204:207], v[212:215], v[124:127]
  ds_read_b128 v[212:215], v241 offset:1024
  v_mfma_f32_16x16x32_bf16 v[140:143], v[204:207], v[216:219], v[140:143]
  ds_read_b128 v[216:219], v241 offset:8192
  v_mfma_f32_16x16x32_bf16 v[144:147], v[192:195], v[220:223], v[144:147]
  v_mfma_f32_16x16x32_bf16 v[160:163], v[192:195], v[224:227], v[160:163]
  v_mfma_f32_16x16x32_bf16 v[176:179], v[192:195], v[228:231], v[176:179]
  ds_read_b64_tr_b16 v[192:193], v232 offset:40960
  v_mfma_f32_16x16x32_bf16 v[148:151], v[196:199], v[220:223], v[148:151]
  ds_read_b64_tr_b16 v[194:195], v232 offset:49152
  v_mfma_f32_16x16x32_bf16 v[164:167], v[196:199], v[224:227], v[164:167]
  v_mfma_f32_16x16x32_bf16 v[180:183], v[196:199], v[228:231], v[180:183]
  ds_read_b64_tr_b16 v[196:197], v233 offset:40960
  v_mfma_f32_16x16x32_bf16 v[152:155], v[200:203], v[220:223], v[152:155]
  ds_read_b64_tr_b16 v[198:199], v233 offset:49152
  v_mfma_f32_16x16x32_bf16 v[168:171], v[200:203], v[224:227], v[168:171]
  v_mfma_f32_16x16x32_bf16 v[184:187], v[200:203], v[228:231], v[184:187]
  ds_read_b64_tr_b16 v[200:201], v234 offset:40960
  v_mfma_f32_16x16x32_bf16 v[156:159], v[204:207], v[220:223], v[156:159]
  ds_read_b64_tr_b16 v[202:203], v234 offset:49152
  v_mfma_f32_16x16x32_bf16 v[172:175], v[204:207], v[224:227], v[172:175]
  ds_read_b128 v[220:223], v241 offset:9216
  v_mfma_f32_16x16x32_bf16 v[188:191], v[204:207], v[228:231], v[188:191]
  ds_read_b128 v[224:227], v241 offset:16384
  ds_read_b128 v[228:231], v241 offset:17408
  ds_read_b64_tr_b16 v[204:205], v235 offset:40960
  ds_read_b64_tr_b16 v[206:207], v235 offset:49152
  s_barrier
  s_waitcnt lgkmcnt(9)
  v_mfma_f32_16x16x32_bf16 v[96:99], v[192:195], v[208:211], v[96:99]
  v_add_u32 v241, s83, v242
  v_mfma_f32_16x16x32_bf16 v[112:115], v[192:195], v[212:215], v[112:115]
  v_mfma_f32_16x16x32_bf16 v[128:131], v[192:195], v[216:219], v[128:131]
  s_waitcnt lgkmcnt(7)
  v_mfma_f32_16x16x32_bf16 v[100:103], v[196:199], v[208:211], v[100:103]
  v_mfma_f32_16x16x32_bf16 v[116:119], v[196:199], v[212:215], v[116:119]
  v_mfma_f32_16x16x32_bf16 v[132:135], v[196:199], v[216:219], v[132:135]
  s_waitcnt lgkmcnt(5)
  v_mfma_f32_16x16x32_bf16 v[104:107], v[200:203], v[208:211], v[104:107]
  v_mfma_f32_16x16x32_bf16 v[120:123], v[200:203], v[212:215], v[120:123]
  v_mfma_f32_16x16x32_bf16 v[136:139], v[200:203], v[216:219], v[136:139]
  s_waitcnt lgkmcnt(0)
  v_mfma_f32_16x16x32_bf16 v[108:111], v[204:207], v[208:211], v[108:111]
  ds_read_b128 v[208:211], v240 offset:0
  v_mfma_f32_16x16x32_bf16 v[124:127], v[204:207], v[212:215], v[124:127]
  ds_read_b128 v[212:215], v240 offset:1024
  v_mfma_f32_16x16x32_bf16 v[140:143], v[204:207], v[216:219], v[140:143]
  ds_read_b128 v[216:219], v240 offset:8192
  v_mfma_f32_16x16x32_bf16 v[144:147], v[192:195], v[220:223], v[144:147]
  v_mfma_f32_16x16x32_bf16 v[160:163], v[192:195], v[224:227], v[160:163]
  v_mfma_f32_16x16x32_bf16 v[176:179], v[192:195], v[228:231], v[176:179]
  ds_read_b64_tr_b16 v[192:193], v232 offset:24576
  v_mfma_f32_16x16x32_bf16 v[148:151], v[196:199], v[220:223], v[148:151]
  ds_read_b64_tr_b16 v[194:195], v232 offset:32768
  v_mfma_f32_16x16x32_bf16 v[164:167], v[196:199], v[224:227], v[164:167]
  v_mfma_f32_16x16x32_bf16 v[180:183], v[196:199], v[228:231], v[180:183]
  ds_read_b64_tr_b16 v[196:197], v233 offset:24576
  v_mfma_f32_16x16x32_bf16 v[152:155], v[200:203], v[220:223], v[152:155]
  ds_read_b64_tr_b16 v[198:199], v233 offset:32768
  v_mfma_f32_16x16x32_bf16 v[168:171], v[200:203], v[224:227], v[168:171]
  v_mfma_f32_16x16x32_bf16 v[184:187], v[200:203], v[228:231], v[184:187]
  ds_read_b64_tr_b16 v[200:201], v234 offset:24576
  v_mfma_f32_16x16x32_bf16 v[156:159], v[204:207], v[220:223], v[156:159]
  ds_read_b64_tr_b16 v[202:203], v234 offset:32768
  v_mfma_f32_16x16x32_bf16 v[172:175], v[204:207], v[224:227], v[172:175]
  ds_read_b128 v[220:223], v240 offset:9216
  v_mfma_f32_16x16x32_bf16 v[188:191], v[204:207], v[228:231], v[188:191]
  ds_read_b128 v[224:227], v240 offset:16384
  ds_read_b128 v[228:231], v240 offset:17408
  ds_read_b64_tr_b16 v[204:205], v235 offset:24576
  ds_read_b64_tr_b16 v[206:207], v235 offset:32768
  s_barrier
  s_waitcnt lgkmcnt(9)
  v_mfma_f32_16x16x32_bf16 v[96:99], v[192:195], v[208:211], v[96:99]
  v_mfma_f32_16x16x32_bf16 v[112:115], v[192:195], v[212:215], v[112:115]
  v_mfma_f32_16x16x32_bf16 v[128:131], v[192:195], v[216:219], v[128:131]
  s_waitcnt lgkmcnt(7)
  v_mfma_f32_16x16x32_bf16 v[100:103], v[196:199], v[208:211], v[100:103]
  v_mfma_f32_16x16x32_bf16 v[116:119], v[196:199], v[212:215], v[116:119]
  v_mfma_f32_16x16x32_bf16 v[132:135], v[196:199], v[216:219], v[132:135]
  s_waitcnt lgkmcnt(5)
  v_mfma_f32_16x16x32_bf16 v[104:107], v[200:203], v[208:211], v[104:107]
  v_mfma_f32_16x16x32_bf16 v[120:123], v[200:203], v[212:215], v[120:123]
  v_mfma_f32_16x16x32_bf16 v[136:139], v[200:203], v[216:219], v[136:139]
  s_waitcnt lgkmcnt(0)
  v_mfma_f32_16x16x32_bf16 v[108:111], v[204:207], v[208:211], v[108:111]
  ds_read_b128 v[208:211], v241 offset:0
  v_mfma_f32_16x16x32_bf16 v[124:127], v[204:207], v[212:215], v[124:127]
  ds_read_b128 v[212:215], v241 offset:1024
  v_mfma_f32_16x16x32_bf16 v[140:143], v[204:207], v[216:219], v[140:143]
  ds_read_b128 v[216:219], v241 offset:8192
  v_mfma_f32_16x16x32_bf16 v[144:147], v[192:195], v[220:223], v[144:147]
  v_mfma_f32_16x16x32_bf16 v[160:163], v[192:195], v[224:227], v[160:163]
  v_mfma_f32_16x16x32_bf16 v[176:179], v[192:195], v[228:231], v[176:179]
  ds_read_b64_tr_b16 v[192:193], v232 offset:57344
  v_mfma_f32_16x16x32_bf16 v[148:151], v[196:199], v[220:223], v[148:151]
  ds_read_b64_tr_b16 v[194:195], v236 offset:0
  v_mfma_f32_16x16x32_bf16 v[164:167], v[196:199], v[224:227], v[164:167]
  v_mfma_f32_16x16x32_bf16 v[180:183], v[196:199], v[228:231], v[180:183]
  ds_read_b64_tr_b16 v[196:197], v233 offset:57344
  v_mfma_f32_16x16x32_bf16 v[152:155], v[200:203], v[220:223], v[152:155]
  ds_read_b64_tr_b16 v[198:199], v237 offset:0
  v_mfma_f32_16x16x32_bf16 v[168:171], v[200:203], v[224:227], v[168:171]
  v_mfma_f32_16x16x32_bf16 v[184:187], v[200:203], v[228:231], v[184:187]
  ds_read_b64_tr_b16 v[200:201], v234 offset:57344
  v_mfma_f32_16x16x32_bf16 v[156:159], v[204:207], v[220:223], v[156:159]
  ds_read_b64_tr_b16 v[202:203], v238 offset:0
  v_mfma_f32_16x16x32_bf16 v[172:175], v[204:207], v[224:227], v[172:175]
  ds_read_b128 v[220:223], v241 offset:9216
  v_mfma_f32_16x16x32_bf16 v[188:191], v[204:207], v[228:231], v[188:191]
  ds_read_b128 v[224:227], v241 offset:16384
  ds_read_b128 v[228:231], v241 offset:17408
  ds_read_b64_tr_b16 v[204:205], v235 offset:57344
  ds_read_b64_tr_b16 v[206:207], v239 offset:0
  s_barrier
  s_waitcnt lgkmcnt(9)
  v_mfma_f32_16x16x32_bf16 v[96:99], v[192:195], v[208:211], v[96:99]
  v_mfma_f32_16x16x32_bf16 v[112:115], v[192:195], v[212:215], v[112:115]
  v_mfma_f32_16x16x32_bf16 v[128:131], v[192:195], v[216:219], v[128:131]
  s_waitcnt lgkmcnt(7)
  v_mfma_f32_16x16x32_bf16 v[100:103], v[196:199], v[208:211], v[100:103]
  v_mfma_f32_16x16x32_bf16 v[116:119], v[196:199], v[212:215], v[116:119]
  v_mfma_f32_16x16x32_bf16 v[132:135], v[196:199], v[216:219], v[132:135]
  s_waitcnt lgkmcnt(5)
  v_mfma_f32_16x16x32_bf16 v[104:107], v[200:203], v[208:211], v[104:107]
  v_mfma_f32_16x16x32_bf16 v[120:123], v[200:203], v[212:215], v[120:123]
  v_mfma_f32_16x16x32_bf16 v[136:139], v[200:203], v[216:219], v[136:139]
  s_waitcnt lgkmcnt(0)
  v_mfma_f32_16x16x32_bf16 v[108:111], v[204:207], v[208:211], v[108:111]
  v_mfma_f32_16x16x32_bf16 v[124:127], v[204:207], v[212:215], v[124:127]
  v_mfma_f32_16x16x32_bf16 v[140:143], v[204:207], v[216:219], v[140:143]
  v_mfma_f32_16x16x32_bf16 v[144:147], v[192:195], v[220:223], v[144:147]
  v_mfma_f32_16x16x32_bf16 v[160:163], v[192:195], v[224:227], v[160:163]
  v_mfma_f32_16x16x32_bf16 v[176:179], v[192:195], v[228:231], v[176:179]
  v_mfma_f32_16x16x32_bf16 v[148:151], v[196:199], v[220:223], v[148:151]
  v_mfma_f32_16x16x32_bf16 v[164:167], v[196:199], v[224:227], v[164:167]
  v_mfma_f32_16x16x32_bf16 v[180:183], v[196:199], v[228:231], v[180:183]
  v_mfma_f32_16x16x32_bf16 v[152:155], v[200:203], v[220:223], v[152:155]
  v_mfma_f32_16x16x32_bf16 v[168:171], v[200:203], v[224:227], v[168:171]
  v_mfma_f32_16x16x32_bf16 v[184:187], v[200:203], v[228:231], v[184:187]
  v_mfma_f32_16x16x32_bf16 v[156:159], v[204:207], v[220:223], v[156:159]
  v_mfma_f32_16x16x32_bf16 v[172:175], v[204:207], v[224:227], v[172:175]
  v_mfma_f32_16x16x32_bf16 v[188:191], v[204:207], v[228:231], v[188:191]
  s_lshl_b32 s63, s55, 2
  s_add_u32 s63, s63, s51
  s_lshl_b32 s63, s63, 1
  s_and_b32 s49, s24, 1
  s_xor_b32 s49, s49, 1
  s_add_u32 s63, s63, s49
  s_lshl_b32 s63, s63, 3
  s_add_u32 s63, s63, s28
  s_mul_i32 s63, s63, 12288
  v_cvt_pk_bf16_f32 v244, v96, v97
  v_cvt_pk_bf16_f32 v245, v98, v99
  v_cvt_pk_bf16_f32 v246, v100, v101
  v_cvt_pk_bf16_f32 v247, v102, v103
  v_cvt_pk_bf16_f32 v248, v104, v105
  v_cvt_pk_bf16_f32 v249, v106, v107
  v_cvt_pk_bf16_f32 v250, v108, v109
  v_cvt_pk_bf16_f32 v251, v110, v111
  s_add_u32 s50, s63, 0
  buffer_store_dwordx4 v[244:247], v242, s[36:39], s50 offen sc1
  buffer_store_dwordx4 v[248:251], v242, s[36:39], s50 offen offset:1024 sc1
  s_nop 1
  v_cvt_pk_bf16_f32 v192, v112, v113
  v_cvt_pk_bf16_f32 v193, v114, v115
  v_cvt_pk_bf16_f32 v194, v116, v117
  v_cvt_pk_bf16_f32 v195, v118, v119
  v_cvt_pk_bf16_f32 v196, v120, v121
  v_cvt_pk_bf16_f32 v197, v122, v123
  v_cvt_pk_bf16_f32 v198, v124, v125
  v_cvt_pk_bf16_f32 v199, v126, v127
  s_add_u32 s50, s63, 2048
  buffer_store_dwordx4 v[192:195], v242, s[36:39], s50 offen sc1
  buffer_store_dwordx4 v[196:199], v242, s[36:39], s50 offen offset:1024 sc1
  s_nop 1
  v_cvt_pk_bf16_f32 v200, v128, v129
  v_cvt_pk_bf16_f32 v201, v130, v131
  v_cvt_pk_bf16_f32 v202, v132, v133
  v_cvt_pk_bf16_f32 v203, v134, v135
  v_cvt_pk_bf16_f32 v204, v136, v137
  v_cvt_pk_bf16_f32 v205, v138, v139
  v_cvt_pk_bf16_f32 v206, v140, v141
  v_cvt_pk_bf16_f32 v207, v142, v143
  s_add_u32 s50, s63, 4096
  buffer_store_dwordx4 v[200:203], v242, s[36:39], s50 offen sc1
  buffer_store_dwordx4 v[204:207], v242, s[36:39], s50 offen offset:1024 sc1
  s_nop 1
  v_cvt_pk_bf16_f32 v208, v144, v145
  v_cvt_pk_bf16_f32 v209, v146, v147
  v_cvt_pk_bf16_f32 v210, v148, v149
  v_cvt_pk_bf16_f32 v211, v150, v151
  v_cvt_pk_bf16_f32 v212, v152, v153
  v_cvt_pk_bf16_f32 v213, v154, v155
  v_cvt_pk_bf16_f32 v214, v156, v157
  v_cvt_pk_bf16_f32 v215, v158, v159
  s_add_u32 s50, s63, 6144
  buffer_store_dwordx4 v[208:211], v242, s[36:39], s50 offen sc1
  buffer_store_dwordx4 v[212:215], v242, s[36:39], s50 offen offset:1024 sc1
  s_nop 1
  v_cvt_pk_bf16_f32 v244, v160, v161
  v_cvt_pk_bf16_f32 v245, v162, v163
  v_cvt_pk_bf16_f32 v246, v164, v165
  v_cvt_pk_bf16_f32 v247, v166, v167
  v_cvt_pk_bf16_f32 v248, v168, v169
  v_cvt_pk_bf16_f32 v249, v170, v171
  v_cvt_pk_bf16_f32 v250, v172, v173
  v_cvt_pk_bf16_f32 v251, v174, v175
  s_add_u32 s50, s63, 8192
  buffer_store_dwordx4 v[244:247], v242, s[36:39], s50 offen sc1
  buffer_store_dwordx4 v[248:251], v242, s[36:39], s50 offen offset:1024 sc1
  s_nop 1
  v_cvt_pk_bf16_f32 v192, v176, v177
  v_cvt_pk_bf16_f32 v193, v178, v179
  v_cvt_pk_bf16_f32 v194, v180, v181
  v_cvt_pk_bf16_f32 v195, v182, v183
  v_cvt_pk_bf16_f32 v196, v184, v185
  v_cvt_pk_bf16_f32 v197, v186, v187
  v_cvt_pk_bf16_f32 v198, v188, v189
  v_cvt_pk_bf16_f32 v199, v190, v191
  s_add_u32 s50, s63, 10240
  buffer_store_dwordx4 v[192:195], v242, s[36:39], s50 offen sc1
  buffer_store_dwordx4 v[196:199], v242, s[36:39], s50 offen offset:1024 sc1
  s_nop 1
  s_waitcnt vmcnt(0)
  s_lshl_b32 s49, s55, 2
  s_add_u32 s49, s49, s51
  s_lshl_b32 s49, s49, 1
  s_and_b32 s50, s24, 1
  s_xor_b32 s50, s50, 1
  s_add_u32 s49, s49, s50
  s_lshl_b32 s49, s49, 7
  s_lshl_b32 s50, s28, 2
  s_add_u32 s49, s49, s50
  v_mov_b32 v244, 1
  v_mov_b32 v245, 0
  s_mov_b64 s[60:61], exec
  s_mov_b64 exec, 1
  buffer_store_dword v244, v245, s[64:67], s49 offen sc1
  s_mov_b64 exec, s[60:61]
  s_cmp_ge_u32 s20, 6
  s_cbranch_scc1 L_k1_end
  s_mov_b32 s63, s20
L_T_reduce:
  v_lshlrev_b32 v242, 4, v255
  s_load_dwordx2 s[58:59], s[0:1], 80
  s_lshl_b32 s51, s55, 3
  s_add_u32 s51, s51, s28
  s_lshl_b32 s51, s51, 7
  v_lshlrev_b32 v2, 2, v255
  s_lshl_b32 s49, s55, 3
  s_add_u32 s49, s49, s28
  s_mul_i32 s49, s49, 98304
  s_lshl_b32 s50, s63, 11
  s_add_u32 s49, s49, s50
  s_mov_b64 s[60:61], exec
  s_mov_b32 s52, 0
  s_mov_b32 s62, 0
L_T_w0:
  s_bitcmp1_b32 s62, 0
  s_cbranch_scc1 L_T_h0
  s_mov_b64 exec, 0xff
  buffer_load_dword v3, v2, s[64:67], s51 offen sc1
  s_waitcnt vmcnt(0)
  v_cmp_eq_u32 vcc, 1, v3
  s_add_u32 s52, s52, 1
  s_mov_b64 exec, s[60:61]
  s_and_b32 s62, vcc_lo, 0xff
  s_cmp_lt_u32 s52, 0x8000
  s_cselect_b32 s62, s62, 0xff
  s_bitcmp1_b32 s62, 0
  s_cbranch_scc1 L_T_h0
  s_sleep 1
  s_branch L_T_w0
L_T_h0:
  s_add_u32 s50, s49, 0
  buffer_load_dwordx4 v[8:11], v242, s[36:39], s50 offen sc1
  buffer_load_dwordx4 v[12:15], v242, s[36:39], s50 offen offset:1024 sc1
L_T_w1:
  s_bitcmp1_b32 s62, 1
  s_cbranch_scc1 L_T_h1
  s_mov_b64 exec, 0xff
  buffer_load_dword v3, v2, s[64:67], s51 offen sc1
  s_waitcnt vmcnt(0)
  v_cmp_eq_u32 vcc, 1, v3
  s_add_u32 s52, s52, 1
  s_mov_b64 exec, s[60:61]
  s_and_b32 s62, vcc_lo, 0xff
  s_cmp_lt_u32 s52, 0x8000
  s_cselect_b32 s62, s62, 0xff
  s_bitcmp1_b32 s62, 1
  s_cbranch_scc1 L_T_h1
  s_sleep 1
  s_branch L_T_w1
L_T_h1:
  s_add_u32 s50, s49, 12288
  buffer_load_dwordx4 v[16:19], v242, s[36:39], s50 offen sc1
  buffer_load_dwordx4 v[20:23], v242, s[36:39], s50 offen offset:1024 sc1
L_T_w2:
  s_bitcmp1_b32 s62, 2
  s_cbranch_scc1 L_T_h2
  s_mov_b64 exec, 0xff
  buffer_load_dword v3, v2, s[64:67], s51 offen sc1
  s_waitcnt vmcnt(0)
  v_cmp_eq_u32 vcc, 1, v3
  s_add_u32 s52, s52, 1
  s_mov_b64 exec, s[60:61]
  s_and_b32 s62, vcc_lo, 0xff
  s_cmp_lt_u32 s52, 0x8000
  s_cselect_b32 s62, s62, 0xff
  s_bitcmp1_b32 s62, 2
  s_cbranch_scc1 L_T_h2
  s_sleep 1
  s_branch L_T_w2
L_T_h2:
  s_add_u32 s50, s49, 24576
  buffer_load_dwordx4 v[24:27], v242, s[36:39], s50 offen sc1
  buffer_load_dwordx4 v[28:31], v242, s[36:39], s50 offen offset:1024 sc1
L_T_w3:
  s_bitcmp1_b32 s62, 3
  s_cbranch_scc1 L_T_h3
  s_mov_b64 exec, 0xff
  buffer_load_dword v3, v2, s[64:67], s51 offen sc1
  s_waitcnt vmcnt(0)
  v_cmp_eq_u32 vcc, 1, v3
  s_add_u32 s52, s52, 1
  s_mov_b64 exec, s[60:61]
  s_and_b32 s62, vcc_lo, 0xff
  s_cmp_lt_u32 s52, 0x8000
  s_cselect_b32 s62, s62, 0xff
  s_bitcmp1_b32 s62, 3
  s_cbranch_scc1 L_T_h3
  s_sleep 1
  s_branch L_T_w3
L_T_h3:
  s_add_u32 s50, s49, 36864
  buffer_load_dwordx4 v[32:35], v242, s[36:39], s50 offen sc1
  buffer_load_dwordx4 v[36:39], v242, s[36:39], s50 offen offset:1024 sc1
L_T_w4:
  s_bitcmp1_b32 s62, 4
  s_cbranch_scc1 L_T_h4
  s_mov_b64 exec, 0xff
  buffer_load_dword v3, v2, s[64:67], s51 offen sc1
  s_waitcnt vmcnt(0)
  v_cmp_eq_u32 vcc, 1, v3
  s_add_u32 s52, s52, 1
  s_mov_b64 exec, s[60:61]
  s_and_b32 s62, vcc_lo, 0xff
  s_cmp_lt_u32 s52, 0x8000
  s_cselect_b32 s62, s62, 0xff
  s_bitcmp1_b32 s62, 4
  s_cbranch_scc1 L_T_h4
  s_sleep 1
  s_branch L_T_w4
L_T_h4:
  s_add_u32 s50, s49, 49152
  buffer_load_dwordx4 v[40:43], v242, s[36:39], s50 offen sc1
  buffer_load_dwordx4 v[44:47], v242, s[36:39], s50 offen offset:1024 sc1
L_T_w5:
  s_bitcmp1_b32 s62, 5
  s_cbranch_scc1 L_T_h5
  s_mov_b64 exec, 0xff
  buffer_load_dword v3, v2, s[64:67], s51 offen sc1
  s_waitcnt vmcnt(0)
  v_cmp_eq_u32 vcc, 1, v3
  s_add_u32 s52, s52, 1
  s_mov_b64 exec, s[60:61]
  s_and_b32 s62, vcc_lo, 0xff
  s_cmp_lt_u32 s52, 0x8000
  s_cselect_b32 s62, s62, 0xff
  s_bitcmp1_b32 s62, 5
  s_cbranch_scc1 L_T_h5
  s_sleep 1
  s_branch L_T_w5
L_T_h5:
  s_add_u32 s50, s49, 61440
  buffer_load_dwordx4 v[48:51], v242, s[36:39], s50 offen sc1
  buffer_load_dwordx4 v[52:55], v242, s[36:39], s50 offen offset:1024 sc1
L_T_w6:
  s_bitcmp1_b32 s62, 6
  s_cbranch_scc1 L_T_h6
  s_mov_b64 exec, 0xff
  buffer_load_dword v3, v2, s[64:67], s51 offen sc1
  s_waitcnt vmcnt(0)
  v_cmp_eq_u32 vcc, 1, v3
  s_add_u32 s52, s52, 1
  s_mov_b64 exec, s[60:61]
  s_and_b32 s62, vcc_lo, 0xff
  s_cmp_lt_u32 s52, 0x8000
  s_cselect_b32 s62, s62, 0xff
  s_bitcmp1_b32 s62, 6
  s_cbranch_scc1 L_T_h6
  s_sleep 1
  s_branch L_T_w6
L_T_h6:
  s_add_u32 s50, s49, 73728
  buffer_load_dwordx4 v[56:59], v242, s[36:39], s50 offen sc1
  buffer_load_dwordx4 v[60:63], v242, s[36:39], s50 offen offset:1024 sc1
L_T_w7:
  s_bitcmp1_b32 s62, 7
  s_cbranch_scc1 L_T_h7
  s_mov_b64 exec, 0xff
  buffer_load_dword v3, v2, s[64:67], s51 offen sc1
  s_waitcnt vmcnt(0)
  v_cmp_eq_u32 vcc, 1, v3
  s_add_u32 s52, s52, 1
  s_mov_b64 exec, s[60:61]
  s_and_b32 s62, vcc_lo, 0xff
  s_cmp_lt_u32 s52, 0x8000
  s_cselect_b32 s62, s62, 0xff
  s_bitcmp1_b32 s62, 7
  s_cbranch_scc1 L_T_h7
  s_sleep 1
  s_branch L_T_w7
L_T_h7:
  s_add_u32 s50, s49, 86016
  buffer_load_dwordx4 v[64:67], v242, s[36:39], s50 offen sc1
  buffer_load_dwordx4 v[68:71], v242, s[36:39], s50 offen offset:1024 sc1
  s_waitcnt lgkmcnt(0)
  s_mov_b32 s44, s58
  s_and_b32 s45, s59, 0xffff
  s_mov_b32 s46, 0x300000
  s_mov_b32 s47, 0x20000
  s_lshl_b32 s50, s63, 4
  s_mul_i32 s49, s24, 96
  s_add_u32 s49, s49, s50
  s_lshl_b32 s49, s49, 11
  s_lshl_b32 s50, s23, 10
  s_add_u32 s49, s49, s50
  s_lshl_b32 s50, s28, 7
  s_add_u32 s49, s49, s50
  v_and_b32 v2, 15, v255
  v_lshlrev_b32 v2, 11, v2
  v_lshrrev_b32 v3, 4, v255
  v_lshl_add_u32 v2, v3, 3, v2
  s_waitcnt vmcnt(14)
  v_lshlrev_b32 v80, 16, v8
  v_and_b32 v81, 0xffff0000, v8
  v_lshlrev_b32 v82, 16, v9
  v_and_b32 v83, 0xffff0000, v9
  v_lshlrev_b32 v84, 16, v10
  v_and_b32 v85, 0xffff0000, v10
  v_lshlrev_b32 v86, 16, v11
  v_and_b32 v87, 0xffff0000, v11
  v_lshlrev_b32 v88, 16, v12
  v_and_b32 v89, 0xffff0000, v12
  v_lshlrev_b32 v90, 16, v13
  v_and_b32 v91, 0xffff0000, v13
  v_lshlrev_b32 v92, 16, v14
  v_and_b32 v93, 0xffff0000, v14
  v_lshlrev_b32 v94, 16, v15
  v_and_b32 v95, 0xffff0000, v15
  s_waitcnt vmcnt(12)
  v_lshlrev_b32 v4, 16, v16
  v_and_b32 v5, 0xffff0000, v16
  v_pk_add_f32 v[80:81], v[80:81], v[4:5]
  v_lshlrev_b32 v6, 16, v17
  v_and_b32 v7, 0xffff0000, v17
  v_pk_add_f32 v[82:83], v[82:83], v[6:7]
  v_lshlrev_b32 v4, 16, v18
  v_and_b32 v5, 0xffff0000, v18
  v_pk_add_f32 v[84:85], v[84:85], v[4:5]
  v_lshlrev_b32 v6, 16, v19
  v_and_b32 v7, 0xffff0000, v19
  v_pk_add_f32 v[86:87], v[86:87], v[6:7]
  v_lshlrev_b32 v4, 16, v20
  v_and_b32 v5, 0xffff0000, v20
  v_pk_add_f32 v[88:89], v[88:89], v[4:5]
  v_lshlrev_b32 v6, 16, v21
  v_and_b32 v7, 0xffff0000, v21
  v_pk_add_f32 v[90:91], v[90:91], v[6:7]
  v_lshlrev_b32 v4, 16, v22
  v_and_b32 v5, 0xffff0000, v22
  v_pk_add_f32 v[92:93], v[92:93], v[4:5]
  v_lshlrev_b32 v6, 16, v23
  v_and_b32 v7, 0xffff0000, v23
  v_pk_add_f32 v[94:95], v[94:95], v[6:7]
  s_waitcnt vmcnt(10)
  v_lshlrev_b32 v4, 16, v24
  v_and_b32 v5, 0xffff0000, v24
  v_pk_add_f32 v[80:81], v[80:81], v[4:5]
  v_lshlrev_b32 v6, 16, v25
  v_and_b32 v7, 0xffff0000, v25
  v_pk_add_f32 v[82:83], v[82:83], v[6:7]
  v_lshlrev_b32 v4, 16, v26
  v_and_b32 v5, 0xffff0000, v26
  v_pk_add_f32 v[84:85], v[84:85], v[4:5]
  v_lshlrev_b32 v6, 16, v27
  v_and_b32 v7, 0xffff0000, v27
  v_pk_add_f32 v[86:87], v[86:87], v[6:7]
  v_lshlrev_b32 v4, 16, v28
  v_and_b32 v5, 0xffff0000, v28
  v_pk_add_f32 v[88:89], v[88:89], v[4:5]
  v_lshlrev_b32 v6, 16, v29
  v_and_b32 v7, 0xffff0000, v29
  v_pk_add_f32 v[90:91], v[90:91], v[6:7]
  v_lshlrev_b32 v4, 16, v30
  v_and_b32 v5, 0xffff0000, v30
  v_pk_add_f32 v[92:93], v[92:93], v[4:5]
  v_lshlrev_b32 v6, 16, v31
  v_and_b32 v7, 0xffff0000, v31
  v_pk_add_f32 v[94:95], v[94:95], v[6:7]
  s_waitcnt vmcnt(8)
  v_lshlrev_b32 v4, 16, v32
  v_and_b32 v5, 0xffff0000, v32
  v_pk_add_f32 v[80:81], v[80:81], v[4:5]
  v_lshlrev_b32 v6, 16, v33
  v_and_b32 v7, 0xffff0000, v33
  v_pk_add_f32 v[82:83], v[82:83], v[6:7]
  v_lshlrev_b32 v4, 16, v34
  v_and_b32 v5, 0xffff0000, v34
  v_pk_add_f32 v[84:85], v[84:85], v[4:5]
  v_lshlrev_b32 v6, 16, v35
  v_and_b32 v7, 0xffff0000, v35
  v_pk_add_f32 v[86:87], v[86:87], v[6:7]
  v_lshlrev_b32 v4, 16, v36
  v_and_b32 v5, 0xffff0000, v36
  v_pk_add_f32 v[88:89], v[88:89], v[4:5]
  v_lshlrev_b32 v6, 16, v37
  v_and_b32 v7, 0xffff0000, v37
  v_pk_add_f32 v[90:91], v[90:91], v[6:7]
  v_lshlrev_b32 v4, 16, v38
  v_and_b32 v5, 0xffff0000, v38
  v_pk_add_f32 v[92:93], v[92:93], v[4:5]
  v_lshlrev_b32 v6, 16, v39
  v_and_b32 v7, 0xffff0000, v39
  v_pk_add_f32 v[94:95], v[94:95], v[6:7]
  s_waitcnt vmcnt(6)
  v_lshlrev_b32 v4, 16, v40
  v_and_b32 v5, 0xffff0000, v40
  v_pk_add_f32 v[80:81], v[80:81], v[4:5]
  v_lshlrev_b32 v6, 16, v41
  v_and_b32 v7, 0xffff0000, v41
  v_pk_add_f32 v[82:83], v[82:83], v[6:7]
  v_lshlrev_b32 v4, 16, v42
  v_and_b32 v5, 0xffff0000, v42
  v_pk_add_f32 v[84:85], v[84:85], v[4:5]
  v_lshlrev_b32 v6, 16, v43
  v_and_b32 v7, 0xffff0000, v43
  v_pk_add_f32 v[86:87], v[86:87], v[6:7]
  v_lshlrev_b32 v4, 16, v44
  v_and_b32 v5, 0xffff0000, v44
  v_pk_add_f32 v[88:89], v[88:89], v[4:5]
  v_lshlrev_b32 v6, 16, v45
  v_and_b32 v7, 0xffff0000, v45
  v_pk_add_f32 v[90:91], v[90:91], v[6:7]
  v_lshlrev_b32 v4, 16, v46
  v_and_b32 v5, 0xffff0000, v46
  v_pk_add_f32 v[92:93], v[92:93], v[4:5]
  v_lshlrev_b32 v6, 16, v47
  v_and_b32 v7, 0xffff0000, v47
  v_pk_add_f32 v[94:95], v[94:95], v[6:7]
  s_waitcnt vmcnt(4)
  v_lshlrev_b32 v4, 16, v48
  v_and_b32 v5, 0xffff0000, v48
  v_pk_add_f32 v[80:81], v[80:81], v[4:5]
  v_lshlrev_b32 v6, 16, v49
  v_and_b32 v7, 0xffff0000, v49
  v_pk_add_f32 v[82:83], v[82:83], v[6:7]
  v_lshlrev_b32 v4, 16, v50
  v_and_b32 v5, 0xffff0000, v50
  v_pk_add_f32 v[84:85], v[84:85], v[4:5]
  v_lshlrev_b32 v6, 16, v51
  v_and_b32 v7, 0xffff0000, v51
  v_pk_add_f32 v[86:87], v[86:87], v[6:7]
  v_lshlrev_b32 v4, 16, v52
  v_and_b32 v5, 0xffff0000, v52
  v_pk_add_f32 v[88:89], v[88:89], v[4:5]
  v_lshlrev_b32 v6, 16, v53
  v_and_b32 v7, 0xffff0000, v53
  v_pk_add_f32 v[90:91], v[90:91], v[6:7]
  v_lshlrev_b32 v4, 16, v54
  v_and_b32 v5, 0xffff0000, v54
  v_pk_add_f32 v[92:93], v[92:93], v[4:5]
  v_lshlrev_b32 v6, 16, v55
  v_and_b32 v7, 0xffff0000, v55
  v_pk_add_f32 v[94:95], v[94:95], v[6:7]
  s_waitcnt vmcnt(2)
  v_lshlrev_b32 v4, 16, v56
  v_and_b32 v5, 0xffff0000, v56
  v_pk_add_f32 v[80:81], v[80:81], v[4:5]
  v_lshlrev_b32 v6, 16, v57
  v_and_b32 v7, 0xffff0000, v57
  v_pk_add_f32 v[82:83], v[82:83], v[6:7]
  v_lshlrev_b32 v4, 16, v58
  v_and_b32 v5, 0xffff0000, v58
  v_pk_add_f32 v[84:85], v[84:85], v[4:5]
  v_lshlrev_b32 v6, 16, v59
  v_and_b32 v7, 0xffff0000, v59
  v_pk_add_f32 v[86:87], v[86:87], v[6:7]
  v_lshlrev_b32 v4, 16, v60
  v_and_b32 v5, 0xffff0000, v60
  v_pk_add_f32 v[88:89], v[88:89], v[4:5]
  v_lshlrev_b32 v6, 16, v61
  v_and_b32 v7, 0xffff0000, v61
  v_pk_add_f32 v[90:91], v[90:91], v[6:7]
  v_lshlrev_b32 v4, 16, v62
  v_and_b32 v5, 0xffff0000, v62
  v_pk_add_f32 v[92:93], v[92:93], v[4:5]
  v_lshlrev_b32 v6, 16, v63
  v_and_b32 v7, 0xffff0000, v63
  v_pk_add_f32 v[94:95], v[94:95], v[6:7]
  s_waitcnt vmcnt(0)
  v_lshlrev_b32 v4, 16, v64
  v_and_b32 v5, 0xffff0000, v64
  v_pk_add_f32 v[80:81], v[80:81], v[4:5]
  v_lshlrev_b32 v6, 16, v65
  v_and_b32 v7, 0xffff0000, v65
  v_pk_add_f32 v[82:83], v[82:83], v[6:7]
  v_lshlrev_b32 v4, 16, v66
  v_and_b32 v5, 0xffff0000, v66
  v_pk_add_f32 v[84:85], v[84:85], v[4:5]
  v_lshlrev_b32 v6, 16, v67
  v_and_b32 v7, 0xffff0000, v67
  v_pk_add_f32 v[86:87], v[86:87], v[6:7]
  v_lshlrev_b32 v4, 16, v68
  v_and_b32 v5, 0xffff0000, v68
  v_pk_add_f32 v[88:89], v[88:89], v[4:5]
  v_lshlrev_b32 v6, 16, v69
  v_and_b32 v7, 0xffff0000, v69
  v_pk_add_f32 v[90:91], v[90:91], v[6:7]
  v_lshlrev_b32 v4, 16, v70
  v_and_b32 v5, 0xffff0000, v70
  v_pk_add_f32 v[92:93], v[92:93], v[4:5]
  v_lshlrev_b32 v6, 16, v71
  v_and_b32 v7, 0xffff0000, v71
  v_pk_add_f32 v[94:95], v[94:95], v[6:7]
  v_cvt_pk_bf16_f32 v8, v80, v81
  v_cvt_pk_bf16_f32 v9, v82, v83
  v_cvt_pk_bf16_f32 v10, v84, v85
  v_cvt_pk_bf16_f32 v11, v86, v87
  v_cvt_pk_bf16_f32 v12, v88, v89
  v_cvt_pk_bf16_f32 v13, v90, v91
  v_cvt_pk_bf16_f32 v14, v92, v93
  v_cvt_pk_bf16_f32 v15, v94, v95
  buffer_store_dwordx2 v[8:9], v2, s[44:47], s49 offen offset:0
  buffer_store_dwordx2 v[10:11], v2, s[44:47], s49 offen offset:32
  buffer_store_dwordx2 v[12:13], v2, s[44:47], s49 offen offset:64
  buffer_store_dwordx2 v[14:15], v2, s[44:47], s49 offen offset:96
  s_waitcnt vmcnt(0)
  s_waitcnt vmcnt(0)
L_k1_end:
  s_endpgm
.section .rodata,"a"
.p2align 6
.amdhsa_kernel concat_heads__mha_block_cached__gqa_block_cached__near_ridge_kernel
  .amdhsa_next_free_vgpr 256
  .amdhsa_next_free_sgpr 84
  .amdhsa_accum_offset 256
  .amdhsa_group_segment_fixed_size 0
  .amdhsa_kernarg_size 104
  .amdhsa_user_sgpr_count 2
  .amdhsa_user_sgpr_kernarg_segment_ptr 1
  .amdhsa_system_sgpr_workgroup_id_x 1
.end_amdhsa_kernel
```
